```python
import torch

def _softmax(x, axis=-1):
    return torch.softmax(x, dim=axis)
def _gelu(x):
    return torch.nn.functional.gelu(x, approximate="tanh")
def _silu(x):
    return torch.nn.functional.silu(x)
def _sigmoid(x):
    return torch.sigmoid(x)
def _layernorm(x, axis=-1, eps=1e-5):
    m = x.mean(dim=axis, keepdim=True)
    v = x.var(dim=axis, keepdim=True, unbiased=False)
    return (x - m) / torch.sqrt(v + eps)
def _scatter_add(tgt, idx, src, axis=0):
    return tgt.clone().index_add_(axis, idx, src)
def _segment_sum(src, seg, n):
    out = torch.zeros((n,) + src.shape[1:], dtype=src.dtype)
    return out.index_add_(0, seg, src)
def _pad(x, pw):
    flat = tuple(v for pair in reversed(pw) for v in pair)
    return torch.nn.functional.pad(x, flat)

kernel_name = 'parallel_sum__sliding_local_dilated__dense_activation_squared_relu__prompt'

def setup_inputs():

    _w = (lambda a: (lambda t: t.to(torch.bfloat16) if t.is_floating_point() else t)(torch.as_tensor(a)))
    def _A_setup():
        B, S, D = 1, 2048, 576
        return {
            "x": _w((lambda *s: torch.randn(*s, dtype=torch.bfloat16) * 0.05)(B, S, D)),
            "wqkv": _w((lambda *s: torch.randn(*s, dtype=torch.bfloat16) * 0.1)(D, 3 * D)),
            "wo": _w((lambda *s: torch.randn(*s, dtype=torch.bfloat16) * 0.05)(D, D)),
        }
    _A_in = _A_setup()

    def _B_setup():
        B, S, D, F = 1, 2048, 576, 4608
        return {
            "x": _w((lambda *s: torch.randn(*s, dtype=torch.bfloat16) * 0.05)(B, S, D)),
            "w1": _w((lambda *s: torch.randn(*s, dtype=torch.bfloat16) * 0.05)(D, F)),
            "b1": _w((lambda *s: torch.randn(*s, dtype=torch.bfloat16) * 0.2)(F)),
            "w2": _w((lambda *s: torch.randn(*s, dtype=torch.bfloat16) * 0.05)(F, D)),
            "b2": _w((lambda *s: torch.randn(*s, dtype=torch.bfloat16) * 1.6)(D)),
        }
    _B_in = _B_setup()

    return {
        "A_x": _A_in["x"],
        "A_wqkv": _A_in["wqkv"],
        "A_wo": _A_in["wo"],
        "B_x": _B_in["x"],
        "B_w1": _B_in["w1"],
        "B_b1": _B_in["b1"],
        "B_w2": _B_in["w2"],
        "B_b2": _B_in["b2"],
    }

def reference(A_x, A_wqkv, A_wo, B_x, B_w1, B_b1, B_w2, B_b2):
    def _A_ref(x, wqkv, wo):
        B, S, D = x.shape
        H = 32; Dh = D // H
        W, dil = 8, 2
        qkv = (lambda x, *d: x.permute(*d))((x @ wqkv).reshape(B, S, 3, H, Dh), 2, 0, 3, 1, 4)
        q, k, v = qkv[0], qkv[1], qkv[2]
        scale = Dh ** -0.5
        pos = torch.arange(S)
        off = torch.arange(W) * dil
        idx = pos[:, None] - off[None, :]
        mask = idx >= 0
        idx_c = torch.where(mask, idx, 0).reshape(-1)
        kg = k[:, :, idx_c, :].reshape(B, H, S, W, Dh)
        vg = v[:, :, idx_c, :].reshape(B, H, S, W, Dh)
        logits = torch.einsum("bhsd,bhswd->bhsw", q, kg) * scale
        logits = torch.where(mask[None, None, :, :], logits, -1e9)
        attn = _softmax(logits, axis=-1)
        o = torch.einsum("bhsw,bhswd->bhsd", attn, vg)
        return (lambda x, *d: x.permute(*d))(o, 0, 2, 1, 3).reshape(B, S, D) @ wo

    def _B_ref(x, w1, b1, w2, b2):
        h = torch.einsum("bsd,df->bsf", x, w1) + b1
        zero = torch.zeros_like(h)
        r = torch.where(h > zero, h, zero)
        h = r * r
        out = torch.einsum("bsf,fd->bsd", h, w2) + b2
        return out

    x = A_x
    xn = _layernorm(x, axis=-1)
    return x + _A_ref(xn, A_wqkv, A_wo) + _B_ref(xn, B_w1, B_b1, B_w2, B_b2)
```

```asm
; @launch grid=(256,1,1) block=(256,1,1) lds=163840
.amdgcn_target "amdgcn-amd-amdhsa--gfx950"
.text
.globl parallel_sum__sliding_local_dilated__dense_activation_squared_relu__prompt_kernel
.p2align 8
.type parallel_sum__sliding_local_dilated__dense_activation_squared_relu__prompt_kernel,@function
parallel_sum__sliding_local_dilated__dense_activation_squared_relu__prompt_kernel:
    s_cmp_ge_u32 s2, 256
    s_cbranch_scc1 L_END
    s_load_dwordx16 s[16:31], s[0:1], 0
    s_load_dwordx4 s[32:35], s[0:1], 64
    s_load_dwordx2 s[36:37], s[0:1], 80
    s_memrealtime s[82:83]
    s_mov_b32 s99, 0
    s_getpc_b64 s[68:69]
L_PCREF:
    s_mov_b32 s70, L_CODE_END-L_PCREF
    s_mov_b32 s71, 0x20000
    v_lshlrev_b32 v2, 7, v0
    s_lshr_b32 s3, s2, 3
    s_and_b32 s3, s3, 15
    s_lshl_b32 s3, s3, 12
    v_lshrrev_b32 v3, 12, v2
    v_lshl_or_b32 v2, v3, 30, v2
    buffer_load_dword v10, v2, s[68:71], s3 offen
    v_lshrrev_b32 v1, 6, v0
    s_nop 0
    v_readfirstlane_b32 s4, v1
    v_and_b32 v1, 63, v0
    s_and_b32 s84, s2, 7
    s_lshr_b32 s85, s2, 3
    s_lshr_b32 s6, s84, 1
    s_and_b32 s7, s85, 3
    s_and_b32 s84, s84, 1
    s_lshl_b32 s84, s84, 3
    s_lshr_b32 s85, s85, 2
    s_add_u32 s5, s84, s85
    s_lshl_b32 s8, s6, 2
    s_add_u32 s8, s8, s7
    v_bfe_u32 v2, v1, 2, 3
    v_mul_u32_u24 v2, 4608, v2
    v_lshrrev_b32 v3, 5, v1
    v_lshl_add_u32 v2, v3, 6, v2
    v_and_b32 v4, 3, v1
    v_lshl_add_u32 v212, v4, 4, v2
    v_mul_u32_u24 v5, 1152, v3
    v_and_b32 v6, 31, v1
    v_lshl_add_u32 v5, v6, 4, v5
    v_mov_b32 v7, 0x40000000
    v_cmp_gt_u32 vcc, 8, v6
    s_nop 1
    v_cndmask_b32 v6, v7, v5, vcc
    v_lshlrev_b32 v209, 4, v1
    s_lshl_b32 s86, s5, 2
    s_add_u32 s86, s86, s4
    s_mul_i32 s86, s86, 36864
    s_lshl_b32 s87, s5, 4
    s_add_u32 s87, s87, s8
    s_lshl_b32 s87, s87, 2
    s_add_u32 s87, s87, s4
    s_mul_i32 s88, s87, 2304
    v_add_u32 v8, 0, v1
    v_mul_u32_u24 v9, 3277, v8
    v_lshrrev_b32 v9, 16, v9
    v_mul_u32_u24 v11, 20, v9
    v_sub_u32 v11, v8, v11
    v_mul_u32_u24 v9, 9216, v9
    v_lshl_add_u32 v196, v11, 4, v9
    v_add_u32 v8, 64, v1
    v_mul_u32_u24 v9, 3277, v8
    v_lshrrev_b32 v9, 16, v9
    v_mul_u32_u24 v11, 20, v9
    v_sub_u32 v11, v8, v11
    v_mul_u32_u24 v9, 9216, v9
    v_lshl_add_u32 v197, v11, 4, v9
    v_subrev_u32 v197, 1024, v197
    v_add_u32 v8, 128, v1
    v_mul_u32_u24 v9, 3277, v8
    v_lshrrev_b32 v9, 16, v9
    v_mul_u32_u24 v11, 20, v9
    v_sub_u32 v11, v8, v11
    v_mul_u32_u24 v9, 9216, v9
    v_lshl_add_u32 v198, v11, 4, v9
    v_subrev_u32 v198, 2048, v198
    v_add_u32 v8, 192, v1
    v_mul_u32_u24 v9, 3277, v8
    v_lshrrev_b32 v9, 16, v9
    v_mul_u32_u24 v11, 20, v9
    v_sub_u32 v11, v8, v11
    v_mul_u32_u24 v9, 9216, v9
    v_lshl_add_u32 v199, v11, 4, v9
    v_subrev_u32 v199, 3072, v199
    v_add_u32 v8, 256, v1
    v_mul_u32_u24 v9, 3277, v8
    v_lshrrev_b32 v9, 16, v9
    v_mul_u32_u24 v11, 20, v9
    v_sub_u32 v11, v8, v11
    v_mul_u32_u24 v9, 9216, v9
    v_lshl_add_u32 v200, v11, 4, v9
    s_mul_i32 s89, s8, 576
    s_and_b32 s84, s8, 1
    s_cmp_eq_u32 s84, 0
    s_cselect_b32 s90, 256, 0
    s_cselect_b32 s91, 0, 320
    s_and_b32 s92, s4, 3
    s_mul_i32 s92, s92, 294912
    s_add_u32 s92, s92, s89
    s_add_u32 s93, s92, s90
    s_mul_i32 s72, s4, 10240
    s_waitcnt lgkmcnt(0)
    s_mov_b32 s40, s16
    s_mov_b32 s41, s17
    s_mov_b32 s42, 2359296
    s_mov_b32 s43, 0x20000
    s_mov_b32 s44, s24
    s_mov_b32 s45, s25
    s_mov_b32 s46, 5308416
    s_mov_b32 s47, 0x20000
    buffer_load_dwordx4 v[234:237], v5, s[40:43], s88 offen offset:0
    buffer_load_dwordx4 v[238:241], v5, s[40:43], s88 offen offset:512
    buffer_load_dwordx4 v[242:245], v6, s[40:43], s88 offen offset:1024
    buffer_load_dwordx4 v[16:19], v212, s[40:43], s86 offen offset:0
    buffer_load_dwordx4 v[20:23], v212, s[40:43], s86 offen offset:1152
    buffer_load_dwordx4 v[24:27], v212, s[40:43], s86 offen offset:2304
    buffer_load_dwordx4 v[28:31], v212, s[40:43], s86 offen offset:3456
    s_add_u32 s84, s93, 0
    s_add_u32 m0, s72, 0
    s_nop 0
    buffer_load_dwordx4 v196, s[44:47], s84 offen offset:0 lds
    buffer_load_dwordx4 v197, s[44:47], s84 offen offset:1024 lds
    buffer_load_dwordx4 v198, s[44:47], s84 offen offset:2048 lds
    buffer_load_dwordx4 v199, s[44:47], s84 offen offset:3072 lds
    s_add_u32 m0, s72, 4096
    s_nop 0
    buffer_load_dwordx4 v200, s[44:47], s84 offen offset:0 lds
    s_mov_b32 s97, s84
    s_mov_b32 s64, s34
    s_mov_b32 s65, s35
    s_mov_b32 s66, 256
    s_mov_b32 s67, 0x20000
    s_or_b32 s82, s82, 1
    v_mov_b32 v8, s82
    v_mov_b32 v9, s83
    v_mov_b32 v14, 0
    v_cmp_eq_u32 vcc, 0, v1
    s_nop 1
    v_cndmask_b32 v207, v7, v14, vcc
    s_or_b32 s85, s2, s4
    s_cmp_eq_u32 s85, 0
    s_cselect_b32 s85, 0, 0x40000000
    buffer_store_dwordx2 v[8:9], v207, s[64:67], s85 offen sc1
    s_mov_b32 s48, s36
    s_mov_b32 s49, s37
    s_mov_b32 s50, 268435456
    s_mov_b32 s51, 0x20000
    s_mov_b32 s56, s26
    s_mov_b32 s57, s27
    s_mov_b32 s58, 9216
    s_mov_b32 s59, 0x20000
    s_mov_b32 s60, s32
    s_mov_b32 s61, s33
    s_mov_b32 s62, 2359296
    s_mov_b32 s63, 0x20000
    s_sub_u32 s84, s2, 92
    s_cmp_lt_u32 s84, 144
    s_cselect_b32 s52, s28, s20
    s_cselect_b32 s53, s29, s21
    s_mov_b32 s54, 5308416
    s_cselect_b32 s54, s54, 663552
    s_mov_b32 s55, 0x20000
    s_lshr_b32 s85, s2, 3
    s_and_b32 s84, s2, 1
    s_lshl_b32 s84, s84, 1
    s_cmp_ge_u32 s85, 9
    s_cselect_b32 s94, 9, 0
    s_cselect_b32 s95, 1, 0
    s_sub_u32 s94, s85, s94
    s_mul_i32 s96, s6, 9
    s_add_u32 s94, s94, s96
    s_lshl_b32 s94, s94, 2
    s_add_u32 s94, s94, s84
    s_add_u32 s94, s94, s95
    s_add_u32 s98, s94, 64
    s_sub_u32 s94, s85, 18
    s_and_b32 s95, s94, 3
    s_lshl_b32 s96, s6, 2
    s_add_u32 s95, s95, s96
    s_lshl_b32 s95, s95, 2
    s_add_u32 s95, s95, s84
    s_lshr_b32 s94, s94, 2
    s_add_u32 s95, s95, s94
    s_cmp_ge_u32 s85, 18
    s_cselect_b32 s98, s95, s98
    s_cmp_ge_u32 s85, 26
    s_cselect_b32 s98, 255, s98
    s_mov_b32 s98, s2
    s_and_b32 s84, s98, 3
    s_lshr_b32 s85, s4, 1
    s_lshl_b32 s85, s85, 5
    s_and_b32 s94, s4, 1
    s_lshl_b32 s94, s94, 2
    s_add_u32 s85, s85, s94
    s_lshl_b32 s94, s84, 3
    s_add_u32 s85, s85, s94
    v_lshrrev_b32 v8, 4, v1
    v_and_b32 v9, 15, v1
    v_bfe_u32 v11, v1, 4, 1
    v_lshrrev_b32 v3, 5, v1
    v_lshlrev_b32 v3, 3, v3
    v_bfe_u32 v15, v1, 2, 2
    v_add_u32 v3, v3, v15
    v_lshlrev_b32 v3, 8, v3
    v_add_u32 v3, 122880, v3
    s_cmp_ge_u32 s98, 64
    s_cbranch_scc1 L_EU_W1
    s_lshr_b32 s94, s98, 2
    s_mov_b32 s68, s18
    s_mov_b32 s69, s19
    s_mov_b32 s70, 1990656
    s_mov_b32 s15, 221184
    s_mul_i32 s38, s85, 3456
    s_mul_i32 s95, s94, 72
    s_add_u32 s38, s38, s95
    s_mul_i32 s39, s94, 147456
    s_lshl_b32 s95, s84, 2
    s_add_u32 s95, s95, s4
    s_lshl_b32 s95, s95, 10
    s_add_u32 s39, s39, s95
    s_add_u32 s39, s39, 1048576
    s_lshl_b32 s3, s94, 12
    s_add_u32 s3, s3, 786432
    s_mov_b32 s96, 0x40000000
    v_mul_u32_u24 v8, 3456, v8
    v_mul_u32_u24 v15, 13, v9
    v_lshrrev_b32 v15, 6, v15
    v_mul_u32_u24 v2, 5, v15
    v_sub_u32 v9, v9, v2
    v_mul_u32_u24 v15, 1152, v15
    v_add_u32 v8, v8, v15
    v_lshl_add_u32 v2, v9, 4, v8
    v_lshlrev_b32 v11, 2, v11
    v_and_b32 v8, 1, v1
    v_lshl_add_u32 v11, v8, 1, v11
    v_bfe_u32 v8, v1, 1, 1
    v_add_u32 v11, v11, v8
    s_lshl_b32 s95, s4, 3
    v_add_u32 v11, s95, v11
    v_min_u32 v11, 26, v11
    v_mul_u32_u24 v8, 57, v11
    v_lshrrev_b32 v8, 9, v8
    v_lshl_add_u32 v11, v11, 3, v3
    v_lshl_add_u32 v3, v8, 3, v11
    s_branch L_EU_DONE
L_EU_W1:
    s_sub_u32 s94, s98, 64
    s_lshr_b32 s94, s94, 2
    s_mov_b32 s68, s24
    s_mov_b32 s69, s25
    s_mov_b32 s70, 5308416
    s_mov_b32 s15, 589824
    s_mul_i32 s38, s85, 9216
    s_lshl_b32 s95, s94, 8
    s_add_u32 s38, s38, s95
    s_mov_b32 s39, 0x40000000
    s_lshl_b32 s3, s94, 12
    s_add_u32 s3, s3, 524288
    s_lshl_b32 s96, s4, 6
    s_add_u32 s96, s96, s95
    s_cmp_eq_u32 s84, 0
    s_cselect_b32 s96, s96, 0x40000000
    s_cmp_lt_u32 s98, 208
    s_cselect_b32 s38, s38, 0x40000000
    s_cselect_b32 s3, s3, 0x40000000
    v_mul_u32_u24 v8, 9216, v8
    v_lshl_add_u32 v2, v9, 4, v8
    v_lshl_add_u32 v3, v11, 5, v3
    v_lshl_add_u32 v3, v4, 3, v3
    s_lshl_b32 s95, s4, 6
    v_add_u32 v3, s95, v3
L_EU_DONE:
    s_lshl_b32 s95, s4, 10
    s_add_u32 s3, s3, s95
    s_lshl_b32 s94, s84, 2
    s_add_u32 s3, s3, s94
    v_and_b32 v8, 31, v1
    v_lshlrev_b32 v8, 1, v8
    s_nop 2
    s_mov_b32 s84, s97
    s_add_u32 s84, s84, 147456
    s_add_u32 m0, s72, 5120
    s_nop 0
    buffer_load_dwordx4 v196, s[44:47], s84 offen offset:0 lds
    buffer_load_dwordx4 v197, s[44:47], s84 offen offset:1024 lds
    buffer_load_dwordx4 v198, s[44:47], s84 offen offset:2048 lds
    buffer_load_dwordx4 v199, s[44:47], s84 offen offset:3072 lds
    s_add_u32 m0, s72, 9216
    s_nop 0
    buffer_load_dwordx4 v200, s[44:47], s84 offen offset:0 lds
    buffer_load_dwordx4 v[32:35], v212, s[40:43], s86 offen offset:128
    buffer_load_dwordx4 v[36:39], v212, s[40:43], s86 offen offset:1280
    buffer_load_dwordx4 v[40:43], v212, s[40:43], s86 offen offset:2432
    buffer_load_dwordx4 v[44:47], v212, s[40:43], s86 offen offset:3584
    buffer_load_ushort v250, v8, s[56:59], s96 offen
    s_mov_b32 s56, s30
    s_mov_b32 s57, s31
    s_mov_b32 s58, 1152
    s_mov_b32 s59, 0x20000
    s_mov_b32 s29, s86
    s_add_u32 s30, s86, 640
    s_mov_b32 s16, s93
    s_add_u32 s18, s92, s91
    s_mul_i32 s84, s4, 147456
    s_add_u32 s84, s84, 4718592
    s_add_u32 s84, s84, s89
    s_add_u32 s17, s84, s90
    s_add_u32 s19, s84, s91
    s_lshl_b32 s73, s4, 13
    s_mul_i32 s74, s4, 9216
    s_lshl_b32 s76, s4, 11
    s_sub_u32 s76, 30720, s76
    s_cmp_eq_u32 s4, 3
    s_cselect_b32 s75, 10240, s76
    s_mul_i32 s0, s4, 6144
    s_mul_i32 s84, s8, 147456
    s_add_u32 s84, s84, 1048576
    s_and_b32 s85, s73, 65535
    s_add_u32 s20, s84, s85
    s_lshl_b32 s85, s4, 12
    s_add_u32 s21, s84, s85
    s_add_u32 s21, s21, 131072
    s_mul_i32 s84, s8, 9216
    s_add_u32 s84, s84, 524288
    s_lshl_b32 s90, s90, 4
    s_lshl_b32 s91, s91, 4
    s_add_u32 s12, s84, s90
    s_add_u32 s13, s84, s91
    s_mul_i32 s14, s87, 20480
    s_add_u32 s14, s14, 10485760
    s_mul_i32 s9, s8, 375808
    s_add_u32 s9, s9, 4194304
    s_add_u32 s84, s7, 0
    s_and_b32 s84, s84, 3
    s_mul_i32 s85, s84, 61440
    s_add_u32 s85, s85, s72
    s_lshr_b32 s90, s84, 1
    s_mul_i32 s90, s90, 20480
    s_add_u32 s90, s90, 248832
    s_cmp_eq_u32 s4, 3
    s_cselect_b32 s85, s90, s85
    s_add_u32 s22, s85, s9
    s_add_u32 s84, s7, 1
    s_and_b32 s84, s84, 3
    s_mul_i32 s85, s84, 61440
    s_add_u32 s85, s85, s73
    s_add_u32 s23, s85, s9
    s_sub_u32 s84, s84, s7
    s_mul_i32 s84, s84, 81920
    s_add_u32 s26, s84, s14
    s_add_u32 s84, s7, 2
    s_and_b32 s84, s84, 3
    s_mul_i32 s85, s84, 61440
    s_add_u32 s85, s85, s72
    s_lshr_b32 s90, s84, 1
    s_mul_i32 s90, s90, 20480
    s_add_u32 s90, s90, 248832
    s_cmp_eq_u32 s4, 3
    s_cselect_b32 s85, s90, s85
    s_add_u32 s24, s85, s9
    s_sub_u32 s84, s84, s7
    s_mul_i32 s84, s84, 81920
    s_add_u32 s27, s84, s14
    s_add_u32 s84, s7, 3
    s_and_b32 s84, s84, 3
    s_mul_i32 s85, s84, 61440
    s_add_u32 s85, s85, s73
    s_add_u32 s25, s85, s9
    s_sub_u32 s84, s84, s7
    s_mul_i32 s84, s84, 81920
    s_add_u32 s28, s84, s14
    s_lshr_b32 s84, s4, 1
    s_add_u32 s84, s84, s7
    s_add_u32 s84, s84, 2
    s_and_b32 s84, s84, 3
    s_mul_i32 s84, s84, 20480
    s_and_b32 s85, s4, 1
    s_mul_i32 s85, s85, 10240
    s_add_u32 s84, s84, s85
    s_add_u32 s84, s84, s9
    s_add_u32 s80, s84, 290816
    s_lshr_b32 s84, s4, 1
    s_add_u32 s84, s84, s7
    s_add_u32 s84, s84, 0
    s_and_b32 s84, s84, 3
    s_mul_i32 s84, s84, 20480
    s_and_b32 s85, s4, 1
    s_mul_i32 s85, s85, 10240
    s_add_u32 s84, s84, s85
    s_add_u32 s84, s84, s9
    s_add_u32 s81, s84, 290816
    s_lshl_b32 s10, s5, 2
    s_add_u32 s10, s10, s6
    s_lshl_b32 s10, s10, 2
    s_add_u32 s10, s10, s4
    s_lshl_b32 s10, s10, 7
    s_add_u32 s10, s10, 131072
    s_lshl_b32 s31, s5, 2
    s_add_u32 s31, s31, s4
    s_lshl_b32 s31, s31, 7
    s_add_u32 s31, s31, 32768
    s_mov_b64 s[32:33], 0xffff
    s_mov_b32 s34, 0x55555555
    s_mov_b32 s35, 0x55555555
    s_mov_b32 s36, 0x33333333
    s_mov_b32 s37, 0x33333333
    s_add_u32 m0, s95, 122880
    s_nop 0
    buffer_load_dwordx4 v2, s[68:71], s38 offen lds
    s_add_u32 s38, s38, s15
    s_add_u32 m0, s95, 126976
    s_nop 0
    buffer_load_dwordx4 v2, s[68:71], s38 offen lds
    s_add_u32 s38, s38, s15
    s_add_u32 m0, s95, 131072
    s_nop 0
    buffer_load_dwordx4 v2, s[68:71], s38 offen lds
    s_add_u32 s38, s38, s15
    s_add_u32 m0, s95, 135168
    s_nop 0
    buffer_load_dwordx4 v2, s[68:71], s38 offen lds
    s_add_u32 s38, s38, s15
    s_add_u32 m0, s95, 139264
    s_nop 0
    buffer_load_dwordx4 v2, s[68:71], s38 offen lds
    s_add_u32 s38, s38, s15
    s_add_u32 m0, s95, 143360
    s_nop 0
    buffer_load_dwordx4 v2, s[68:71], s38 offen lds
    s_add_u32 s38, s38, s15
    s_add_u32 m0, s95, 147456
    s_nop 0
    buffer_load_dwordx4 v2, s[68:71], s38 offen lds
    s_add_u32 s38, s38, s15
    s_add_u32 m0, s95, 151552
    s_nop 0
    buffer_load_dwordx4 v2, s[68:71], s38 offen lds
    s_add_u32 s38, s38, s15
    s_add_u32 m0, s95, 155648
    s_nop 0
    buffer_load_dwordx4 v2, s[68:71], s38 offen lds
    s_and_b32 s84, s5, 7
    v_mul_u32_u24 v8, 86, v1
    v_lshrrev_b32 v8, 8, v8
    v_mul_u32_u24 v9, 3, v8
    v_sub_u32 v9, v1, v9
    s_lshl_b32 s85, s84, 2
    v_add_u32 v8, s85, v8
    v_mul_u32_u24 v8, 9216, v8
    v_lshl_add_u32 v8, v9, 7, v8
    v_cmp_gt_u32 vcc, 12, v1
    s_nop 1
    v_cndmask_b32 v0, v7, v8, vcc
    v_lshlrev_b32 v208, 7, v1
    s_mul_i32 s85, s84, 1280
    v_add_u32 v8, s85, v208
    v_cmp_gt_u32 vcc, 10, v1
    s_nop 1
    v_cndmask_b32 v210, v7, v8, vcc
    v_lshrrev_b32 v8, 5, v1
    v_lshlrev_b32 v8, 5, v8
    v_bfe_u32 v9, v1, 2, 2
    v_add_u32 v8, v8, v9
    v_bfe_u32 v11, v1, 4, 1
    v_lshlrev_b32 v11, 5, v11
    v_lshl_add_u32 v11, v4, 3, v11
    v_mul_u32_u24 v15, 320, v8
    v_add_u32 v205, v15, v11
    v_lshl_add_u32 v15, v8, 8, v11
    v_add_u32 v15, 40960, v15
    v_lshrrev_b32 v8, 4, v1
    v_xor_b32 v11, v9, v8
    v_mul_u32_u24 v8, 9216, v8
    v_lshl_add_u32 v8, v11, 6, v8
    v_lshl_add_u32 v201, v4, 4, v8
    v_add_u32 v202, 35840, v201
    v_add_u32 v203, 71680, v201
    v_add_u32 v204, 107520, v201
    v_mov_b32 v254, 0xffff0000
    v_cndmask_b32 v213, v7, v209, s[32:33]
    v_mov_b32 v251, v7
    v_xor_b32 v8, 0, v9
    v_lshl_add_u32 v218, v8, 6, v15
    v_xor_b32 v8, 1, v9
    v_lshl_add_u32 v219, v8, 6, v15
    v_xor_b32 v8, 2, v9
    v_lshl_add_u32 v220, v8, 6, v15
    v_xor_b32 v8, 3, v9
    v_lshl_add_u32 v221, v8, 6, v15
    v_and_b32 v8, 15, v1
    v_lshrrev_b32 v9, 4, v1
    v_lshlrev_b32 v9, 2, v9
    v_sub_u32 v8, v8, v9
    v_mov_b32 v15, 0xf149f2ca
    v_mov_b32 v9, 0x3f803f80
    v_accvgpr_write_b32 a220, v9
    v_subrev_u32 v11, 0, v8
    v_and_b32 v11, 0x80000001, v11
    v_cmp_eq_u32 vcc, 0, v11
    s_nop 1
    v_cndmask_b32 v192, v15, v14, vcc
    v_xor_b32 v11, 0x80000000, v11
    v_cmp_eq_u32 vcc, 0, v11
    s_nop 1
    v_cndmask_b32 v188, v15, v14, vcc
    v_accvgpr_write_b32 a221, v9
    v_subrev_u32 v11, 1, v8
    v_and_b32 v11, 0x80000001, v11
    v_cmp_eq_u32 vcc, 0, v11
    s_nop 1
    v_cndmask_b32 v193, v15, v14, vcc
    v_xor_b32 v11, 0x80000000, v11
    v_cmp_eq_u32 vcc, 0, v11
    s_nop 1
    v_cndmask_b32 v189, v15, v14, vcc
    v_accvgpr_write_b32 a222, v9
    v_subrev_u32 v11, 2, v8
    v_and_b32 v11, 0x80000001, v11
    v_cmp_eq_u32 vcc, 0, v11
    s_nop 1
    v_cndmask_b32 v194, v15, v14, vcc
    v_xor_b32 v11, 0x80000000, v11
    v_cmp_eq_u32 vcc, 0, v11
    s_nop 1
    v_cndmask_b32 v190, v15, v14, vcc
    v_accvgpr_write_b32 a223, v9
    v_subrev_u32 v11, 3, v8
    v_and_b32 v11, 0x80000001, v11
    v_cmp_eq_u32 vcc, 0, v11
    s_nop 1
    v_cndmask_b32 v195, v15, v14, vcc
    v_xor_b32 v11, 0x80000000, v11
    v_cmp_eq_u32 vcc, 0, v11
    s_nop 1
    v_cndmask_b32 v191, v15, v14, vcc
    v_and_b32 v8, 31, v1
    s_lshl_b32 s85, s8, 2
    v_add_u32 v11, s85, v8
    s_mul_i32 s85, s8, 9
    s_andn2_b32 s85, s85, 3
    s_add_u32 s85, s85, 60
    v_add_u32 v15, s85, v8
    v_min_u32 v15, 207, v15
    v_cmp_gt_u32 vcc, 4, v8
    s_nop 1
    v_cndmask_b32 v11, v15, v11, vcc
    v_bfe_u32 v15, v1, 2, 2
    v_lshlrev_b32 v15, 1, v15
    v_lshl_add_u32 v15, v4, 3, v15
    s_lshl_b32 s85, s84, 5
    s_lshr_b32 s84, s5, 3
    s_add_u32 s85, s85, s84
    v_add_u32 v15, s85, v15
    v_add_u32 v11, 512, v11
    v_cmp_gt_u32 vcc, 16, v8
    s_nop 1
    v_cndmask_b32 v11, v15, v11, vcc
    v_lshlrev_b32 v11, 3, v11
    v_add_u32 v15, 4096, v11
    v_mov_b32 v4, v218
    v_mov_b32 v5, v219
    v_mov_b32 v6, v220
    v_mov_b32 v7, v221
    v_mov_b32 v218, 0
    v_mov_b32 v219, 0
    v_mov_b32 v220, 0
    v_mov_b32 v221, 0
    s_waitcnt vmcnt(31)
    v_dot2_f32_bf16 v218, v234, v9, v218
    v_dot2_f32_bf16 v220, v234, v234, v220
    v_dot2_f32_bf16 v219, v235, v9, v219
    v_dot2_f32_bf16 v221, v235, v235, v221
    v_dot2_f32_bf16 v218, v236, v9, v218
    v_dot2_f32_bf16 v220, v236, v236, v220
    v_dot2_f32_bf16 v219, v237, v9, v219
    v_dot2_f32_bf16 v221, v237, v237, v221
    s_waitcnt vmcnt(30)
    v_dot2_f32_bf16 v218, v238, v9, v218
    v_dot2_f32_bf16 v220, v238, v238, v220
    v_dot2_f32_bf16 v219, v239, v9, v219
    v_dot2_f32_bf16 v221, v239, v239, v221
    v_dot2_f32_bf16 v218, v240, v9, v218
    v_dot2_f32_bf16 v220, v240, v240, v220
    v_dot2_f32_bf16 v219, v241, v9, v219
    v_dot2_f32_bf16 v221, v241, v241, v221
    s_waitcnt vmcnt(29)
    v_dot2_f32_bf16 v218, v242, v9, v218
    v_dot2_f32_bf16 v220, v242, v242, v220
    v_dot2_f32_bf16 v219, v243, v9, v219
    v_dot2_f32_bf16 v221, v243, v243, v221
    v_dot2_f32_bf16 v218, v244, v9, v218
    v_dot2_f32_bf16 v220, v244, v244, v220
    v_dot2_f32_bf16 v219, v245, v9, v219
    v_dot2_f32_bf16 v221, v245, v245, v221
    s_nop 1
    v_add_f32 v218, v218, v219
    v_add_f32 v220, v220, v221
    s_nop 0
    v_add_f32_dpp v218, v218, v218 row_shr:1 row_mask:0xf bank_mask:0xf bound_ctrl:0
    v_add_f32_dpp v220, v220, v220 row_shr:1 row_mask:0xf bank_mask:0xf bound_ctrl:0
    s_nop 0
    v_add_f32_dpp v218, v218, v218 row_shr:2 row_mask:0xf bank_mask:0xf bound_ctrl:0
    v_add_f32_dpp v220, v220, v220 row_shr:2 row_mask:0xf bank_mask:0xf bound_ctrl:0
    s_nop 0
    v_add_f32_dpp v218, v218, v218 row_shr:4 row_mask:0xf bank_mask:0xf bound_ctrl:0
    v_add_f32_dpp v220, v220, v220 row_shr:4 row_mask:0xf bank_mask:0xf bound_ctrl:0
    s_nop 0
    v_add_f32_dpp v218, v218, v218 row_shr:8 row_mask:0xf bank_mask:0xf bound_ctrl:0
    v_add_f32_dpp v220, v220, v220 row_shr:8 row_mask:0xf bank_mask:0xf bound_ctrl:0
    s_nop 0
    v_add_f32_dpp v218, v218, v218 row_bcast:15 row_mask:0xa bank_mask:0xf
    v_add_f32_dpp v220, v220, v220 row_bcast:15 row_mask:0xa bank_mask:0xf
    v_mul_f32 v218, 0x3ae38e39, v218
    v_mul_f32 v220, 0x3ae38e39, v220
    v_fma_f32 v220, -v218, v218, v220
    v_max_f32 v220, 0, v220
    v_cvt_pk_bf16_f32 v220, v220, v220
    v_lshlrev_b32 v220, 16, v220
    v_add_f32 v220, 0x3727c5ac, v220
    v_cvt_pk_bf16_f32 v220, v220, v220
    v_lshlrev_b32 v220, 16, v220
    v_sqrt_f32 v220, v220
    v_and_b32 v219, 31, v1
    v_cvt_pk_bf16_f32 v218, v218, v220
    v_lshrrev_b32 v221, 5, v1
    v_lshlrev_b32 v221, 2, v221
    v_cmp_eq_u32 vcc, 31, v219
    s_nop 1
    v_cndmask_b32 v221, v251, v221, vcc
    s_lshl_b32 s84, s87, 3
    s_add_u32 s84, s84, 32768
    buffer_store_dword v218, v221, s[48:51], s84 offen sc1
    s_mov_b64 vcc, s[34:35]
    s_waitcnt vmcnt(28)
    v_cndmask_b32_dpp v218, v20, v16, vcc quad_perm:[1,0,3,2] row_mask:0xf bank_mask:0xf
    v_cndmask_b32_dpp v219, v21, v17, vcc quad_perm:[1,0,3,2] row_mask:0xf bank_mask:0xf
    v_nop
    v_cndmask_b32_dpp v220, v22, v18, vcc quad_perm:[1,0,3,2] row_mask:0xf bank_mask:0xf
    v_cndmask_b32_dpp v221, v23, v19, vcc quad_perm:[1,0,3,2] row_mask:0xf bank_mask:0xf
    s_waitcnt vmcnt(26)
    v_cndmask_b32_dpp v226, v28, v24, vcc quad_perm:[1,0,3,2] row_mask:0xf bank_mask:0xf
    v_nop
    v_cndmask_b32_dpp v227, v29, v25, vcc quad_perm:[1,0,3,2] row_mask:0xf bank_mask:0xf
    v_cndmask_b32_dpp v228, v30, v26, vcc quad_perm:[1,0,3,2] row_mask:0xf bank_mask:0xf
    v_cndmask_b32_dpp v229, v31, v27, vcc quad_perm:[1,0,3,2] row_mask:0xf bank_mask:0xf
    v_nop
    s_not_b64 vcc, vcc
    v_cndmask_b32_dpp v222, v16, v20, vcc quad_perm:[1,0,3,2] row_mask:0xf bank_mask:0xf
    v_cndmask_b32_dpp v223, v17, v21, vcc quad_perm:[1,0,3,2] row_mask:0xf bank_mask:0xf
    v_nop
    v_cndmask_b32_dpp v224, v18, v22, vcc quad_perm:[1,0,3,2] row_mask:0xf bank_mask:0xf
    v_cndmask_b32_dpp v225, v19, v23, vcc quad_perm:[1,0,3,2] row_mask:0xf bank_mask:0xf
    v_cndmask_b32_dpp v230, v24, v28, vcc quad_perm:[1,0,3,2] row_mask:0xf bank_mask:0xf
    v_nop
    v_cndmask_b32_dpp v231, v25, v29, vcc quad_perm:[1,0,3,2] row_mask:0xf bank_mask:0xf
    v_cndmask_b32_dpp v232, v26, v30, vcc quad_perm:[1,0,3,2] row_mask:0xf bank_mask:0xf
    v_cndmask_b32_dpp v233, v27, v31, vcc quad_perm:[1,0,3,2] row_mask:0xf bank_mask:0xf
    v_nop
    s_mov_b64 vcc, s[36:37]
    v_cndmask_b32_dpp v16, v226, v218, vcc quad_perm:[2,3,0,1] row_mask:0xf bank_mask:0xf
    v_cndmask_b32_dpp v17, v227, v219, vcc quad_perm:[2,3,0,1] row_mask:0xf bank_mask:0xf
    v_nop
    v_cndmask_b32_dpp v18, v228, v220, vcc quad_perm:[2,3,0,1] row_mask:0xf bank_mask:0xf
    v_cndmask_b32_dpp v19, v229, v221, vcc quad_perm:[2,3,0,1] row_mask:0xf bank_mask:0xf
    v_cndmask_b32_dpp v20, v230, v222, vcc quad_perm:[2,3,0,1] row_mask:0xf bank_mask:0xf
    v_nop
    v_cndmask_b32_dpp v21, v231, v223, vcc quad_perm:[2,3,0,1] row_mask:0xf bank_mask:0xf
    v_cndmask_b32_dpp v22, v232, v224, vcc quad_perm:[2,3,0,1] row_mask:0xf bank_mask:0xf
    v_cndmask_b32_dpp v23, v233, v225, vcc quad_perm:[2,3,0,1] row_mask:0xf bank_mask:0xf
    v_nop
    s_not_b64 vcc, vcc
    v_cndmask_b32_dpp v24, v218, v226, vcc quad_perm:[2,3,0,1] row_mask:0xf bank_mask:0xf
    v_cndmask_b32_dpp v25, v219, v227, vcc quad_perm:[2,3,0,1] row_mask:0xf bank_mask:0xf
    v_nop
    v_cndmask_b32_dpp v26, v220, v228, vcc quad_perm:[2,3,0,1] row_mask:0xf bank_mask:0xf
    v_cndmask_b32_dpp v27, v221, v229, vcc quad_perm:[2,3,0,1] row_mask:0xf bank_mask:0xf
    v_cndmask_b32_dpp v28, v222, v230, vcc quad_perm:[2,3,0,1] row_mask:0xf bank_mask:0xf
    v_nop
    v_cndmask_b32_dpp v29, v223, v231, vcc quad_perm:[2,3,0,1] row_mask:0xf bank_mask:0xf
    v_cndmask_b32_dpp v30, v224, v232, vcc quad_perm:[2,3,0,1] row_mask:0xf bank_mask:0xf
    v_cndmask_b32_dpp v31, v225, v233, vcc quad_perm:[2,3,0,1] row_mask:0xf bank_mask:0xf
    v_nop
    s_waitcnt vmcnt(15)
    s_barrier
    ds_read_b64_tr_b16 v[160:161], v205 offset:0
    ds_read_b64_tr_b16 v[162:163], v205 offset:1280
    ds_read_b64_tr_b16 v[164:165], v205 offset:64
    ds_read_b64_tr_b16 v[166:167], v205 offset:1344
    ds_read_b64_tr_b16 v[168:169], v205 offset:128
    ds_read_b64_tr_b16 v[170:171], v205 offset:1408
    ds_read_b64_tr_b16 v[172:173], v205 offset:192
    ds_read_b64_tr_b16 v[174:175], v205 offset:1472
    ds_read_b64_tr_b16 v[176:177], v205 offset:256
    ds_read_b64_tr_b16 v[178:179], v205 offset:1536
    ds_read_b64_tr_b16 v[180:181], v205 offset:2560
    ds_read_b64_tr_b16 v[182:183], v205 offset:3840
    s_waitcnt lgkmcnt(6)
    v_mfma_f32_32x32x16_bf16 a[0:15], v[160:163], v[16:19], 0
    ds_read_b64_tr_b16 v[184:185], v205 offset:2624
    ds_read_b64_tr_b16 v[186:187], v205 offset:3904
    buffer_load_dwordx2 v[12:13], v14, s[64:67], 0 offen sc1
    v_mfma_f32_32x32x16_bf16 a[16:31], v[164:167], v[16:19], 0
    ds_read_b64_tr_b16 v[160:161], v205 offset:2688
    ds_read_b64_tr_b16 v[162:163], v205 offset:3968
    buffer_load_dwordx4 v[48:51], v212, s[40:43], s29 offen offset:256
    s_mov_b64 vcc, s[34:35]
    s_waitcnt vmcnt(15)
    v_cndmask_b32_dpp v218, v36, v32, vcc quad_perm:[1,0,3,2] row_mask:0xf bank_mask:0xf
    v_cndmask_b32_dpp v219, v37, v33, vcc quad_perm:[1,0,3,2] row_mask:0xf bank_mask:0xf
    v_mfma_f32_32x32x16_bf16 a[32:47], v[168:171], v[16:19], 0
    ds_read_b64_tr_b16 v[164:165], v205 offset:2752
    ds_read_b64_tr_b16 v[166:167], v205 offset:4032
    buffer_load_dwordx4 v[52:55], v212, s[40:43], s29 offen offset:1408
    v_cndmask_b32_dpp v220, v38, v34, vcc quad_perm:[1,0,3,2] row_mask:0xf bank_mask:0xf
    v_cndmask_b32_dpp v221, v39, v35, vcc quad_perm:[1,0,3,2] row_mask:0xf bank_mask:0xf
    s_waitcnt vmcnt(14)
    v_cndmask_b32_dpp v226, v44, v40, vcc quad_perm:[1,0,3,2] row_mask:0xf bank_mask:0xf
    s_waitcnt lgkmcnt(6)
    v_mfma_f32_32x32x16_bf16 a[48:63], v[172:175], v[16:19], 0
    ds_read_b64_tr_b16 v[168:169], v205 offset:2816
    ds_read_b64_tr_b16 v[170:171], v205 offset:4096
    buffer_load_dwordx4 v[56:59], v212, s[40:43], s29 offen offset:2560
    v_cndmask_b32_dpp v227, v45, v41, vcc quad_perm:[1,0,3,2] row_mask:0xf bank_mask:0xf
    v_cndmask_b32_dpp v228, v46, v42, vcc quad_perm:[1,0,3,2] row_mask:0xf bank_mask:0xf
    v_mfma_f32_32x32x16_bf16 a[64:79], v[176:179], v[16:19], 0
    ds_read_b64_tr_b16 v[172:173], v205 offset:5120
    ds_read_b64_tr_b16 v[174:175], v205 offset:6400
    buffer_load_dwordx4 v[60:63], v212, s[40:43], s29 offen offset:3712
    s_add_u32 s84, s16, 1179648
    s_add_u32 m0, s72, 40960
    v_cndmask_b32_dpp v229, v47, v43, vcc quad_perm:[1,0,3,2] row_mask:0xf bank_mask:0xf
    v_mfma_f32_32x32x16_bf16 a[0:15], v[180:183], v[20:23], a[0:15]
    ds_read_b64_tr_b16 v[176:177], v205 offset:5184
    ds_read_b64_tr_b16 v[178:179], v205 offset:6464
    buffer_load_dwordx4 v196, s[44:47], s84 offen offset:0 lds
    s_not_b64 vcc, vcc
    v_cndmask_b32_dpp v222, v32, v36, vcc quad_perm:[1,0,3,2] row_mask:0xf bank_mask:0xf
    s_waitcnt lgkmcnt(6)
    v_mfma_f32_32x32x16_bf16 a[16:31], v[184:187], v[20:23], a[16:31]
    ds_read_b64_tr_b16 v[180:181], v205 offset:5248
    ds_read_b64_tr_b16 v[182:183], v205 offset:6528
    buffer_load_dwordx4 v197, s[44:47], s84 offen offset:1024 lds
    v_cndmask_b32_dpp v223, v33, v37, vcc quad_perm:[1,0,3,2] row_mask:0xf bank_mask:0xf
    v_cndmask_b32_dpp v224, v34, v38, vcc quad_perm:[1,0,3,2] row_mask:0xf bank_mask:0xf
    v_cndmask_b32_dpp v225, v35, v39, vcc quad_perm:[1,0,3,2] row_mask:0xf bank_mask:0xf
    v_mfma_f32_32x32x16_bf16 a[32:47], v[160:163], v[20:23], a[32:47]
    ds_read_b64_tr_b16 v[184:185], v205 offset:5312
    ds_read_b64_tr_b16 v[186:187], v205 offset:6592
    buffer_load_dwordx4 v198, s[44:47], s84 offen offset:2048 lds
    v_cndmask_b32_dpp v230, v40, v44, vcc quad_perm:[1,0,3,2] row_mask:0xf bank_mask:0xf
    v_cndmask_b32_dpp v231, v41, v45, vcc quad_perm:[1,0,3,2] row_mask:0xf bank_mask:0xf
    v_mfma_f32_32x32x16_bf16 a[48:63], v[164:167], v[20:23], a[48:63]
    ds_read_b64_tr_b16 v[160:161], v205 offset:5376
    ds_read_b64_tr_b16 v[162:163], v205 offset:6656
    buffer_load_dwordx4 v199, s[44:47], s84 offen offset:3072 lds
    s_add_u32 m0, s72, 45056
    v_cndmask_b32_dpp v232, v42, v46, vcc quad_perm:[1,0,3,2] row_mask:0xf bank_mask:0xf
    v_cndmask_b32_dpp v233, v43, v47, vcc quad_perm:[1,0,3,2] row_mask:0xf bank_mask:0xf
    s_waitcnt lgkmcnt(6)
    v_mfma_f32_32x32x16_bf16 a[64:79], v[168:171], v[20:23], a[64:79]
    ds_read_b64_tr_b16 v[164:165], v205 offset:7680
    ds_read_b64_tr_b16 v[166:167], v205 offset:8960
    buffer_load_dwordx4 v200, s[44:47], s84 offen offset:0 lds
    s_add_u32 s84, s84, 147456
    s_add_u32 m0, s72, 46080
    v_mfma_f32_32x32x16_bf16 a[0:15], v[172:175], v[24:27], a[0:15]
    s_waitcnt vmcnt(11)
    s_barrier
    ds_read_b64_tr_b16 v[168:169], v205 offset:7744
    ds_read_b64_tr_b16 v[170:171], v205 offset:9024
    ds_read_b64_tr_b16 v[234:235], v3 offset:0
    ds_read_b64_tr_b16 v[236:237], v3 offset:1024
    s_mov_b64 vcc, s[36:37]
    v_cndmask_b32_dpp v32, v226, v218, vcc quad_perm:[2,3,0,1] row_mask:0xf bank_mask:0xf
    v_mfma_f32_32x32x16_bf16 a[16:31], v[176:179], v[24:27], a[16:31]
    ds_read_b64_tr_b16 v[172:173], v205 offset:7808
    ds_read_b64_tr_b16 v[174:175], v205 offset:9088
    ds_read_b64_tr_b16 v[238:239], v3 offset:4096
    s_waitcnt lgkmcnt(14)
    ds_read_b64_tr_b16 v[240:241], v3 offset:5120
    v_cndmask_b32_dpp v33, v227, v219, vcc quad_perm:[2,3,0,1] row_mask:0xf bank_mask:0xf
    s_waitcnt lgkmcnt(10)
    v_mfma_f32_32x32x16_bf16 a[32:47], v[180:183], v[24:27], a[32:47]
    ds_read_b64_tr_b16 v[176:177], v205 offset:7872
    ds_read_b64_tr_b16 v[178:179], v205 offset:9152
    ds_read_b64_tr_b16 v[242:243], v3 offset:8192
    ds_read_b64_tr_b16 v[244:245], v3 offset:9216
    v_cndmask_b32_dpp v34, v228, v220, vcc quad_perm:[2,3,0,1] row_mask:0xf bank_mask:0xf
    v_cndmask_b32_dpp v35, v229, v221, vcc quad_perm:[2,3,0,1] row_mask:0xf bank_mask:0xf
    v_mfma_f32_32x32x16_bf16 a[48:63], v[184:187], v[24:27], a[48:63]
    ds_read_b64_tr_b16 v[180:181], v205 offset:7936
    s_waitcnt lgkmcnt(14)
    ds_read_b64_tr_b16 v[182:183], v205 offset:9216
    s_waitcnt lgkmcnt(10)
    buffer_store_dwordx4 v[234:237], v209, s[48:51], s39 offen sc1
    v_mfma_f32_32x32x16_bf16 a[144:159], a[220:223], v[234:237], 0
    s_add_u32 s39, s39, 16384
    v_cndmask_b32_dpp v36, v230, v222, vcc quad_perm:[2,3,0,1] row_mask:0xf bank_mask:0xf
    v_cndmask_b32_dpp v37, v231, v223, vcc quad_perm:[2,3,0,1] row_mask:0xf bank_mask:0xf
    v_cndmask_b32_dpp v38, v232, v224, vcc quad_perm:[2,3,0,1] row_mask:0xf bank_mask:0xf
    v_mfma_f32_32x32x16_bf16 a[64:79], v[160:163], v[24:27], a[64:79]
    ds_read_b64_tr_b16 v[184:185], v205 offset:20480
    ds_read_b64_tr_b16 v[186:187], v205 offset:21760
    ds_read_b64_tr_b16 v[246:247], v3 offset:12288
    ds_read_b64_tr_b16 v[248:249], v3 offset:13312
    v_cndmask_b32_dpp v39, v233, v225, vcc quad_perm:[2,3,0,1] row_mask:0xf bank_mask:0xf
    s_not_b64 vcc, vcc
    s_waitcnt lgkmcnt(12)
    v_mfma_f32_32x32x16_bf16 a[0:15], v[164:167], v[28:31], a[0:15]
    ds_read_b64_tr_b16 v[160:161], v205 offset:20544
    ds_read_b64_tr_b16 v[162:163], v205 offset:21824
    s_waitcnt lgkmcnt(12)
    buffer_store_dwordx4 v[238:241], v209, s[48:51], s39 offen sc1
    v_mfma_f32_32x32x16_bf16 a[144:159], a[220:223], v[238:241], a[144:159]
    s_add_u32 s39, s39, 16384
    v_cndmask_b32_dpp v40, v218, v226, vcc quad_perm:[2,3,0,1] row_mask:0xf bank_mask:0xf
    v_cndmask_b32_dpp v41, v219, v227, vcc quad_perm:[2,3,0,1] row_mask:0xf bank_mask:0xf
    v_cndmask_b32_dpp v42, v220, v228, vcc quad_perm:[2,3,0,1] row_mask:0xf bank_mask:0xf
    v_mfma_f32_32x32x16_bf16 a[16:31], v[168:171], v[28:31], a[16:31]
    ds_read_b64_tr_b16 v[164:165], v205 offset:20608
    ds_read_b64_tr_b16 v[166:167], v205 offset:21888
    ds_read_b64_tr_b16 v[234:235], v3 offset:16384
    s_waitcnt lgkmcnt(14)
    ds_read_b64_tr_b16 v[236:237], v3 offset:17408
    v_cndmask_b32_dpp v43, v221, v229, vcc quad_perm:[2,3,0,1] row_mask:0xf bank_mask:0xf
    v_cndmask_b32_dpp v44, v222, v230, vcc quad_perm:[2,3,0,1] row_mask:0xf bank_mask:0xf
    v_mfma_f32_32x32x16_bf16 a[32:47], v[172:175], v[28:31], a[32:47]
    s_waitcnt lgkmcnt(14)
    ds_read_b64_tr_b16 v[168:169], v205 offset:20672
    s_waitcnt lgkmcnt(14)
    ds_read_b64_tr_b16 v[170:171], v205 offset:21952
    s_waitcnt lgkmcnt(14)
    buffer_store_dwordx4 v[242:245], v209, s[48:51], s39 offen sc1
    v_mfma_f32_32x32x16_bf16 a[144:159], a[220:223], v[242:245], a[144:159]
    s_add_u32 s39, s39, 16384
    v_cndmask_b32_dpp v45, v223, v231, vcc quad_perm:[2,3,0,1] row_mask:0xf bank_mask:0xf
    v_cndmask_b32_dpp v46, v224, v232, vcc quad_perm:[2,3,0,1] row_mask:0xf bank_mask:0xf
    v_cndmask_b32_dpp v47, v225, v233, vcc quad_perm:[2,3,0,1] row_mask:0xf bank_mask:0xf
    s_waitcnt lgkmcnt(10)
    v_mfma_f32_32x32x16_bf16 a[48:63], v[176:179], v[28:31], a[48:63]
    ds_read_b64_tr_b16 v[172:173], v205 offset:20736
    ds_read_b64_tr_b16 v[174:175], v205 offset:22016
    ds_read_b64_tr_b16 v[238:239], v3 offset:20480
    ds_read_b64_tr_b16 v[240:241], v3 offset:21504
    v_mfma_f32_32x32x16_bf16 a[64:79], v[180:183], v[28:31], a[64:79]
    ds_read_b64_tr_b16 v[176:177], v205 offset:23040
    s_waitcnt lgkmcnt(14)
    ds_read_b64_tr_b16 v[178:179], v205 offset:24320
    s_waitcnt lgkmcnt(14)
    buffer_store_dwordx4 v[246:249], v209, s[48:51], s39 offen sc1
    v_mfma_f32_32x32x16_bf16 a[144:159], a[220:223], v[246:249], a[144:159]
    s_add_u32 s39, s39, 16384
    v_mfma_f32_32x32x16_bf16 a[0:15], v[184:187], v[32:35], a[0:15]
    ds_read_b64_tr_b16 v[180:181], v205 offset:23104
    s_waitcnt lgkmcnt(14)
    ds_read_b64_tr_b16 v[182:183], v205 offset:24384
    s_waitcnt lgkmcnt(14)
    ds_read_b64_tr_b16 v[242:243], v3 offset:24576
    s_waitcnt lgkmcnt(14)
    ds_read_b64_tr_b16 v[244:245], v3 offset:25600
    s_waitcnt lgkmcnt(10)
    v_mfma_f32_32x32x16_bf16 a[16:31], v[160:163], v[32:35], a[16:31]
    ds_read_b64_tr_b16 v[184:185], v205 offset:23168
    ds_read_b64_tr_b16 v[186:187], v205 offset:24448
    buffer_store_dwordx4 v[234:237], v209, s[48:51], s39 offen sc1
    v_mfma_f32_32x32x16_bf16 a[144:159], a[220:223], v[234:237], a[144:159]
    s_add_u32 s39, s39, 16384
    s_mov_b64 vcc, s[34:35]
    s_waitcnt vmcnt(12)
    v_cndmask_b32_dpp v218, v52, v48, vcc quad_perm:[1,0,3,2] row_mask:0xf bank_mask:0xf
    v_cndmask_b32_dpp v219, v53, v49, vcc quad_perm:[1,0,3,2] row_mask:0xf bank_mask:0xf
    v_cndmask_b32_dpp v220, v54, v50, vcc quad_perm:[1,0,3,2] row_mask:0xf bank_mask:0xf
    v_mfma_f32_32x32x16_bf16 a[32:47], v[164:167], v[32:35], a[32:47]
    ds_read_b64_tr_b16 v[160:161], v205 offset:23232
    ds_read_b64_tr_b16 v[162:163], v205 offset:24512
    ds_read_b64_tr_b16 v[246:247], v3 offset:28672
    s_waitcnt lgkmcnt(14)
    ds_read_b64_tr_b16 v[248:249], v3 offset:29696
    v_cndmask_b32_dpp v221, v55, v51, vcc quad_perm:[1,0,3,2] row_mask:0xf bank_mask:0xf
    s_waitcnt vmcnt(10)
    v_cndmask_b32_dpp v226, v60, v56, vcc quad_perm:[1,0,3,2] row_mask:0xf bank_mask:0xf
    v_mfma_f32_32x32x16_bf16 a[48:63], v[168:171], v[32:35], a[48:63]
    s_waitcnt lgkmcnt(14)
    ds_read_b64_tr_b16 v[164:165], v205 offset:23296
    s_waitcnt lgkmcnt(14)
    ds_read_b64_tr_b16 v[166:167], v205 offset:24576
    s_waitcnt lgkmcnt(14)
    buffer_store_dwordx4 v[238:241], v209, s[48:51], s39 offen sc1
    v_mfma_f32_32x32x16_bf16 a[144:159], a[220:223], v[238:241], a[144:159]
    s_add_u32 s39, s39, 16384
    v_cndmask_b32_dpp v227, v61, v57, vcc quad_perm:[1,0,3,2] row_mask:0xf bank_mask:0xf
    v_cndmask_b32_dpp v228, v62, v58, vcc quad_perm:[1,0,3,2] row_mask:0xf bank_mask:0xf
    v_cndmask_b32_dpp v229, v63, v59, vcc quad_perm:[1,0,3,2] row_mask:0xf bank_mask:0xf
    s_waitcnt lgkmcnt(10)
    v_mfma_f32_32x32x16_bf16 a[64:79], v[172:175], v[32:35], a[64:79]
    ds_read_b64_tr_b16 v[168:169], v205 offset:25600
    ds_read_b64_tr_b16 v[170:171], v205 offset:26880
    ds_read_b64_tr_b16 v[234:235], v3 offset:32768
    ds_read_b64_tr_b16 v[236:237], v3 offset:33792
    s_not_b64 vcc, vcc
    v_cndmask_b32_dpp v222, v48, v52, vcc quad_perm:[1,0,3,2] row_mask:0xf bank_mask:0xf
    v_mfma_f32_32x32x16_bf16 a[0:15], v[176:179], v[36:39], a[0:15]
    ds_read_b64_tr_b16 v[172:173], v205 offset:25664
    s_waitcnt lgkmcnt(14)
    ds_read_b64_tr_b16 v[174:175], v205 offset:26944
    s_waitcnt lgkmcnt(14)
    buffer_store_dwordx4 v[242:245], v209, s[48:51], s39 offen sc1
    v_mfma_f32_32x32x16_bf16 a[144:159], a[220:223], v[242:245], a[144:159]
    s_add_u32 s39, s39, 16384
    v_cndmask_b32_dpp v223, v49, v53, vcc quad_perm:[1,0,3,2] row_mask:0xf bank_mask:0xf
    v_cndmask_b32_dpp v224, v50, v54, vcc quad_perm:[1,0,3,2] row_mask:0xf bank_mask:0xf
    v_cndmask_b32_dpp v225, v51, v55, vcc quad_perm:[1,0,3,2] row_mask:0xf bank_mask:0xf
    v_mfma_f32_32x32x16_bf16 a[16:31], v[180:183], v[36:39], a[16:31]
    ds_read_b64_tr_b16 v[176:177], v205 offset:25728
    s_waitcnt lgkmcnt(14)
    ds_read_b64_tr_b16 v[178:179], v205 offset:27008
    buffer_load_dwordx4 v196, s[44:47], s84 offen offset:0 lds
    v_cndmask_b32_dpp v230, v56, v60, vcc quad_perm:[1,0,3,2] row_mask:0xf bank_mask:0xf
    v_cndmask_b32_dpp v231, v57, v61, vcc quad_perm:[1,0,3,2] row_mask:0xf bank_mask:0xf
    v_cndmask_b32_dpp v232, v58, v62, vcc quad_perm:[1,0,3,2] row_mask:0xf bank_mask:0xf
    s_waitcnt lgkmcnt(8)
    v_mfma_f32_32x32x16_bf16 a[32:47], v[184:187], v[36:39], a[32:47]
    ds_read_b64_tr_b16 v[180:181], v205 offset:25792
    ds_read_b64_tr_b16 v[182:183], v205 offset:27072
    buffer_store_dwordx4 v[246:249], v209, s[48:51], s39 offen sc1
    v_mfma_f32_32x32x16_bf16 a[144:159], a[220:223], v[246:249], a[144:159]
    s_add_u32 s39, s39, 16384
    v_cndmask_b32_dpp v233, v59, v63, vcc quad_perm:[1,0,3,2] row_mask:0xf bank_mask:0xf
    s_mov_b64 vcc, s[36:37]
    v_cndmask_b32_dpp v48, v226, v218, vcc quad_perm:[2,3,0,1] row_mask:0xf bank_mask:0xf
    v_mfma_f32_32x32x16_bf16 a[48:63], v[160:163], v[36:39], a[48:63]
    ds_read_b64_tr_b16 v[184:185], v205 offset:25856
    ds_read_b64_tr_b16 v[186:187], v205 offset:27136
    buffer_load_dwordx4 v197, s[44:47], s84 offen offset:1024 lds
    v_cndmask_b32_dpp v49, v227, v219, vcc quad_perm:[2,3,0,1] row_mask:0xf bank_mask:0xf
    v_cndmask_b32_dpp v50, v228, v220, vcc quad_perm:[2,3,0,1] row_mask:0xf bank_mask:0xf
    v_cndmask_b32_dpp v51, v229, v221, vcc quad_perm:[2,3,0,1] row_mask:0xf bank_mask:0xf
    v_mfma_f32_32x32x16_bf16 a[64:79], v[164:167], v[36:39], a[64:79]
    ds_read_b64_tr_b16 v[160:161], v205 offset:28160
    ds_read_b64_tr_b16 v[162:163], v205 offset:29440
    s_waitcnt lgkmcnt(10)
    buffer_store_dwordx4 v[234:237], v209, s[48:51], s39 offen sc1
    v_mfma_f32_32x32x16_bf16 a[144:159], a[220:223], v[234:237], a[144:159]
    s_add_u32 s39, s39, 16384
L_PC0:
    v_cmp_eq_u32 s[78:79], 0, v12
    s_nop 3
    s_cmp_lg_u64 s[78:79], 0
    s_cbranch_scc1 L_PS0
L_PR0:
    v_readfirstlane_b32 s82, v12
    v_readfirstlane_b32 s83, v13
    v_cndmask_b32_dpp v52, v230, v222, vcc quad_perm:[2,3,0,1] row_mask:0xf bank_mask:0xf
    v_cndmask_b32_dpp v53, v231, v223, vcc quad_perm:[2,3,0,1] row_mask:0xf bank_mask:0xf
    v_cndmask_b32_dpp v54, v232, v224, vcc quad_perm:[2,3,0,1] row_mask:0xf bank_mask:0xf
    s_waitcnt lgkmcnt(6)
    v_mfma_f32_32x32x16_bf16 a[0:15], v[168:171], v[40:43], a[0:15]
    ds_read_b64_tr_b16 v[164:165], v205 offset:28224
    ds_read_b64_tr_b16 v[166:167], v205 offset:29504
    buffer_load_dwordx4 v198, s[44:47], s84 offen offset:2048 lds
    v_accvgpr_read_b32 v234, a144
    v_cvt_pk_bf16_f32 v235, v234, v234
    v_lshlrev_b32 v235, 16, v235
    v_mfma_f32_32x32x16_bf16 a[16:31], v[172:175], v[40:43], a[16:31]
    ds_read_b64_tr_b16 v[168:169], v205 offset:28288
    ds_read_b64_tr_b16 v[170:171], v205 offset:29568
    buffer_load_dwordx4 v199, s[44:47], s84 offen offset:3072 lds
    s_add_u32 m0, s72, 50176
    v_sub_f32 v236, v234, v235
    v_mfma_f32_32x32x16_bf16 a[32:47], v[176:179], v[40:43], a[32:47]
    ds_read_b64_tr_b16 v[172:173], v205 offset:28352
    ds_read_b64_tr_b16 v[174:175], v205 offset:29632
    buffer_load_dwordx4 v200, s[44:47], s84 offen offset:0 lds
    v_cvt_pk_bf16_f32 v234, v235, v236
    v_cmp_gt_u32 s[78:79], 32, v1
    s_nop 1
    v_cndmask_b32 v234, v250, v234, s[78:79]
    s_waitcnt lgkmcnt(6)
    v_mfma_f32_32x32x16_bf16 a[48:63], v[180:183], v[40:43], a[48:63]
    ds_read_b64_tr_b16 v[176:177], v205 offset:28416
    ds_read_b64_tr_b16 v[178:179], v205 offset:29696
    buffer_store_dword v234, v209, s[48:51], s3 offen sc1
    v_cndmask_b32_dpp v55, v233, v225, vcc quad_perm:[2,3,0,1] row_mask:0xf bank_mask:0xf
    s_not_b64 vcc, vcc
    v_mfma_f32_32x32x16_bf16 a[64:79], v[184:187], v[40:43], a[64:79]
    s_waitcnt vmcnt(1)
    s_waitcnt lgkmcnt(0)
    s_barrier
    v_add_u32 v205, 40960, v205
    ds_read_b64_tr_b16 v[180:181], v205 offset:0
    ds_read_b64_tr_b16 v[182:183], v205 offset:1280
    buffer_load_dwordx4 v[64:67], v212, s[40:43], s29 offen offset:384
    v_cndmask_b32_dpp v56, v218, v226, vcc quad_perm:[2,3,0,1] row_mask:0xf bank_mask:0xf
    v_cndmask_b32_dpp v57, v219, v227, vcc quad_perm:[2,3,0,1] row_mask:0xf bank_mask:0xf
    v_cndmask_b32_dpp v58, v220, v228, vcc quad_perm:[2,3,0,1] row_mask:0xf bank_mask:0xf
    v_mfma_f32_32x32x16_bf16 a[0:15], v[160:163], v[44:47], a[0:15]
    ds_read_b64_tr_b16 v[184:185], v205 offset:64
    ds_read_b64_tr_b16 v[186:187], v205 offset:1344
    buffer_load_dwordx4 v[68:71], v212, s[40:43], s29 offen offset:1536
    v_cndmask_b32_dpp v59, v221, v229, vcc quad_perm:[2,3,0,1] row_mask:0xf bank_mask:0xf
    v_cndmask_b32_dpp v60, v222, v230, vcc quad_perm:[2,3,0,1] row_mask:0xf bank_mask:0xf
    v_mfma_f32_32x32x16_bf16 a[16:31], v[164:167], v[44:47], a[16:31]
    ds_read_b64_tr_b16 v[160:161], v205 offset:128
    ds_read_b64_tr_b16 v[162:163], v205 offset:1408
    buffer_load_dwordx4 v[72:75], v212, s[40:43], s29 offen offset:2688
    v_cndmask_b32_dpp v61, v223, v231, vcc quad_perm:[2,3,0,1] row_mask:0xf bank_mask:0xf
    v_cndmask_b32_dpp v62, v224, v232, vcc quad_perm:[2,3,0,1] row_mask:0xf bank_mask:0xf
    v_cndmask_b32_dpp v63, v225, v233, vcc quad_perm:[2,3,0,1] row_mask:0xf bank_mask:0xf
    v_mfma_f32_32x32x16_bf16 a[32:47], v[168:171], v[44:47], a[32:47]
    ds_read_b64_tr_b16 v[164:165], v205 offset:192
    ds_read_b64_tr_b16 v[166:167], v205 offset:1472
    buffer_load_dwordx4 v[76:79], v212, s[40:43], s29 offen offset:3840
    v_mfma_f32_32x32x16_bf16 a[48:63], v[172:175], v[44:47], a[48:63]
    ds_read_b64_tr_b16 v[168:169], v205 offset:256
    ds_read_b64_tr_b16 v[170:171], v205 offset:1536
    buffer_load_dwordx4 v[80:83], v212, s[40:43], s29 offen offset:512
    s_waitcnt lgkmcnt(6)
    v_mfma_f32_32x32x16_bf16 a[64:79], v[176:179], v[44:47], a[64:79]
    ds_read_b64_tr_b16 v[172:173], v205 offset:2560
    ds_read_b64_tr_b16 v[174:175], v205 offset:3840
    buffer_load_dwordx4 v[84:87], v212, s[40:43], s29 offen offset:1664
    v_mfma_f32_32x32x16_bf16 a[0:15], v[180:183], v[48:51], a[0:15]
    ds_read_b64_tr_b16 v[176:177], v205 offset:2624
    ds_read_b64_tr_b16 v[178:179], v205 offset:3904
    buffer_load_dwordx4 v[88:91], v212, s[40:43], s29 offen offset:2816
    v_mfma_f32_32x32x16_bf16 a[16:31], v[184:187], v[48:51], a[16:31]
    ds_read_b64_tr_b16 v[180:181], v205 offset:2688
    ds_read_b64_tr_b16 v[182:183], v205 offset:3968
    buffer_load_dwordx4 v[92:95], v212, s[40:43], s29 offen offset:3968
    s_add_u32 s84, s16, 2359296
    s_add_u32 m0, s72, 81920
    s_mov_b64 vcc, s[34:35]
    s_waitcnt lgkmcnt(6)
    v_mfma_f32_32x32x16_bf16 a[32:47], v[160:163], v[48:51], a[32:47]
    ds_read_b64_tr_b16 v[184:185], v205 offset:2752
    ds_read_b64_tr_b16 v[186:187], v205 offset:4032
    buffer_load_dwordx4 v196, s[44:47], s84 offen offset:0 lds
    s_waitcnt vmcnt(7)
    v_cndmask_b32_dpp v218, v68, v64, vcc quad_perm:[1,0,3,2] row_mask:0xf bank_mask:0xf
    v_cndmask_b32_dpp v219, v69, v65, vcc quad_perm:[1,0,3,2] row_mask:0xf bank_mask:0xf
    v_cndmask_b32_dpp v220, v70, v66, vcc quad_perm:[1,0,3,2] row_mask:0xf bank_mask:0xf
    v_mfma_f32_32x32x16_bf16 a[48:63], v[164:167], v[48:51], a[48:63]
    ds_read_b64_tr_b16 v[160:161], v205 offset:2816
    ds_read_b64_tr_b16 v[162:163], v205 offset:4096
    buffer_load_dwordx4 v197, s[44:47], s84 offen offset:1024 lds
    v_cndmask_b32_dpp v221, v71, v67, vcc quad_perm:[1,0,3,2] row_mask:0xf bank_mask:0xf
    s_waitcnt vmcnt(6)
    v_cndmask_b32_dpp v226, v76, v72, vcc quad_perm:[1,0,3,2] row_mask:0xf bank_mask:0xf
    v_mfma_f32_32x32x16_bf16 a[64:79], v[168:171], v[48:51], a[64:79]
    ds_read_b64_tr_b16 v[164:165], v205 offset:5120
    ds_read_b64_tr_b16 v[166:167], v205 offset:6400
    buffer_load_dwordx4 v198, s[44:47], s84 offen offset:2048 lds
    v_cndmask_b32_dpp v227, v77, v73, vcc quad_perm:[1,0,3,2] row_mask:0xf bank_mask:0xf
    v_cndmask_b32_dpp v228, v78, v74, vcc quad_perm:[1,0,3,2] row_mask:0xf bank_mask:0xf
    v_cndmask_b32_dpp v229, v79, v75, vcc quad_perm:[1,0,3,2] row_mask:0xf bank_mask:0xf
    s_waitcnt lgkmcnt(6)
    v_mfma_f32_32x32x16_bf16 a[0:15], v[172:175], v[52:55], a[0:15]
    ds_read_b64_tr_b16 v[168:169], v205 offset:5184
    ds_read_b64_tr_b16 v[170:171], v205 offset:6464
    buffer_load_dwordx4 v199, s[44:47], s84 offen offset:3072 lds
    s_add_u32 m0, s72, 86016
    s_not_b64 vcc, vcc
    v_mfma_f32_32x32x16_bf16 a[16:31], v[176:179], v[52:55], a[16:31]
    ds_read_b64_tr_b16 v[172:173], v205 offset:5248
    ds_read_b64_tr_b16 v[174:175], v205 offset:6528
    buffer_load_dwordx4 v200, s[44:47], s84 offen offset:0 lds
    s_add_u32 s84, s84, 147456
    s_add_u32 m0, s72, 87040
    v_cndmask_b32_dpp v222, v64, v68, vcc quad_perm:[1,0,3,2] row_mask:0xf bank_mask:0xf
    v_mfma_f32_32x32x16_bf16 a[32:47], v[180:183], v[52:55], a[32:47]
    ds_read_b64_tr_b16 v[176:177], v205 offset:5312
    ds_read_b64_tr_b16 v[178:179], v205 offset:6592
    buffer_load_dwordx4 v196, s[44:47], s84 offen offset:0 lds
    v_cndmask_b32_dpp v223, v65, v69, vcc quad_perm:[1,0,3,2] row_mask:0xf bank_mask:0xf
    v_cndmask_b32_dpp v224, v66, v70, vcc quad_perm:[1,0,3,2] row_mask:0xf bank_mask:0xf
    s_waitcnt lgkmcnt(6)
    v_mfma_f32_32x32x16_bf16 a[48:63], v[184:187], v[52:55], a[48:63]
    ds_read_b64_tr_b16 v[180:181], v205 offset:5376
    ds_read_b64_tr_b16 v[182:183], v205 offset:6656
    buffer_load_dwordx4 v197, s[44:47], s84 offen offset:1024 lds
    v_cndmask_b32_dpp v225, v67, v71, vcc quad_perm:[1,0,3,2] row_mask:0xf bank_mask:0xf
    v_cndmask_b32_dpp v230, v72, v76, vcc quad_perm:[1,0,3,2] row_mask:0xf bank_mask:0xf
    v_cndmask_b32_dpp v231, v73, v77, vcc quad_perm:[1,0,3,2] row_mask:0xf bank_mask:0xf
    v_mfma_f32_32x32x16_bf16 a[64:79], v[160:163], v[52:55], a[64:79]
    ds_read_b64_tr_b16 v[184:185], v205 offset:7680
    ds_read_b64_tr_b16 v[186:187], v205 offset:8960
    buffer_load_dwordx4 v198, s[44:47], s84 offen offset:2048 lds
    v_cndmask_b32_dpp v232, v74, v78, vcc quad_perm:[1,0,3,2] row_mask:0xf bank_mask:0xf
    v_cndmask_b32_dpp v233, v75, v79, vcc quad_perm:[1,0,3,2] row_mask:0xf bank_mask:0xf
    v_mfma_f32_32x32x16_bf16 a[0:15], v[164:167], v[56:59], a[0:15]
    ds_read_b64_tr_b16 v[160:161], v205 offset:7744
    ds_read_b64_tr_b16 v[162:163], v205 offset:9024
    buffer_load_dwordx4 v199, s[44:47], s84 offen offset:3072 lds
    s_add_u32 m0, s72, 91136
    s_mov_b64 vcc, s[36:37]
    v_cndmask_b32_dpp v64, v226, v218, vcc quad_perm:[2,3,0,1] row_mask:0xf bank_mask:0xf
    s_waitcnt lgkmcnt(6)
    v_mfma_f32_32x32x16_bf16 a[16:31], v[168:171], v[56:59], a[16:31]
    ds_read_b64_tr_b16 v[164:165], v205 offset:7808
    ds_read_b64_tr_b16 v[166:167], v205 offset:9088
    buffer_load_dwordx4 v200, s[44:47], s84 offen offset:0 lds
    v_cndmask_b32_dpp v65, v227, v219, vcc quad_perm:[2,3,0,1] row_mask:0xf bank_mask:0xf
    v_cndmask_b32_dpp v66, v228, v220, vcc quad_perm:[2,3,0,1] row_mask:0xf bank_mask:0xf
    v_mfma_f32_32x32x16_bf16 a[32:47], v[172:175], v[56:59], a[32:47]
    ds_read_b64_tr_b16 v[168:169], v205 offset:7872
    ds_read_b64_tr_b16 v[170:171], v205 offset:9152
    buffer_load_dwordx4 v[96:99], v212, s[40:43], s30 offen offset:0
    v_cndmask_b32_dpp v67, v229, v221, vcc quad_perm:[2,3,0,1] row_mask:0xf bank_mask:0xf
    v_cndmask_b32_dpp v68, v230, v222, vcc quad_perm:[2,3,0,1] row_mask:0xf bank_mask:0xf
    v_cndmask_b32_dpp v69, v231, v223, vcc quad_perm:[2,3,0,1] row_mask:0xf bank_mask:0xf
    v_mfma_f32_32x32x16_bf16 a[48:63], v[176:179], v[56:59], a[48:63]
    ds_read_b64_tr_b16 v[172:173], v205 offset:7936
    ds_read_b64_tr_b16 v[174:175], v205 offset:9216
    buffer_load_dwordx4 v[100:103], v212, s[40:43], s30 offen offset:1152
    v_cndmask_b32_dpp v70, v232, v224, vcc quad_perm:[2,3,0,1] row_mask:0xf bank_mask:0xf
    v_cndmask_b32_dpp v71, v233, v225, vcc quad_perm:[2,3,0,1] row_mask:0xf bank_mask:0xf
    s_waitcnt lgkmcnt(6)
    v_mfma_f32_32x32x16_bf16 a[64:79], v[180:183], v[56:59], a[64:79]
    ds_read_b64_tr_b16 v[176:177], v205 offset:20480
    ds_read_b64_tr_b16 v[178:179], v205 offset:21760
    buffer_load_dwordx4 v[104:107], v212, s[40:43], s30 offen offset:2304
    s_not_b64 vcc, vcc
    v_cndmask_b32_dpp v72, v218, v226, vcc quad_perm:[2,3,0,1] row_mask:0xf bank_mask:0xf
    v_cndmask_b32_dpp v73, v219, v227, vcc quad_perm:[2,3,0,1] row_mask:0xf bank_mask:0xf
    v_mfma_f32_32x32x16_bf16 a[0:15], v[184:187], v[60:63], a[0:15]
    ds_read_b64_tr_b16 v[180:181], v205 offset:20544
    ds_read_b64_tr_b16 v[182:183], v205 offset:21824
    buffer_load_dwordx4 v[108:111], v212, s[40:43], s30 offen offset:3456
    v_cndmask_b32_dpp v74, v220, v228, vcc quad_perm:[2,3,0,1] row_mask:0xf bank_mask:0xf
    v_cndmask_b32_dpp v75, v221, v229, vcc quad_perm:[2,3,0,1] row_mask:0xf bank_mask:0xf
    v_mfma_f32_32x32x16_bf16 a[16:31], v[160:163], v[60:63], a[16:31]
    ds_read_b64_tr_b16 v[184:185], v205 offset:20608
    ds_read_b64_tr_b16 v[186:187], v205 offset:21888
    v_cndmask_b32_dpp v76, v222, v230, vcc quad_perm:[2,3,0,1] row_mask:0xf bank_mask:0xf
    v_cndmask_b32_dpp v77, v223, v231, vcc quad_perm:[2,3,0,1] row_mask:0xf bank_mask:0xf
    v_cndmask_b32_dpp v78, v224, v232, vcc quad_perm:[2,3,0,1] row_mask:0xf bank_mask:0xf
    v_cndmask_b32_dpp v79, v225, v233, vcc quad_perm:[2,3,0,1] row_mask:0xf bank_mask:0xf
    s_waitcnt lgkmcnt(6)
    v_mfma_f32_32x32x16_bf16 a[32:47], v[164:167], v[60:63], a[32:47]
    ds_read_b64_tr_b16 v[160:161], v205 offset:20672
    ds_read_b64_tr_b16 v[162:163], v205 offset:21952
    v_mfma_f32_32x32x16_bf16 a[48:63], v[168:171], v[60:63], a[48:63]
    ds_read_b64_tr_b16 v[164:165], v205 offset:20736
    ds_read_b64_tr_b16 v[166:167], v205 offset:22016
    v_mfma_f32_32x32x16_bf16 a[64:79], v[172:175], v[60:63], a[64:79]
    ds_read_b64_tr_b16 v[168:169], v205 offset:23040
    ds_read_b64_tr_b16 v[170:171], v205 offset:24320
    s_waitcnt lgkmcnt(6)
    v_mfma_f32_32x32x16_bf16 a[0:15], v[176:179], v[64:67], a[0:15]
    ds_read_b64_tr_b16 v[172:173], v205 offset:23104
    ds_read_b64_tr_b16 v[174:175], v205 offset:24384
    v_mfma_f32_32x32x16_bf16 a[16:31], v[180:183], v[64:67], a[16:31]
    ds_read_b64_tr_b16 v[176:177], v205 offset:23168
    ds_read_b64_tr_b16 v[178:179], v205 offset:24448
    buffer_load_dwordx4 v[112:115], v212, s[40:43], s30 offen offset:128
    s_mov_b64 vcc, s[34:35]
    s_waitcnt vmcnt(17)
    v_cndmask_b32_dpp v218, v84, v80, vcc quad_perm:[1,0,3,2] row_mask:0xf bank_mask:0xf
    v_cndmask_b32_dpp v219, v85, v81, vcc quad_perm:[1,0,3,2] row_mask:0xf bank_mask:0xf
    v_mfma_f32_32x32x16_bf16 a[32:47], v[184:187], v[64:67], a[32:47]
    ds_read_b64_tr_b16 v[180:181], v205 offset:23232
    ds_read_b64_tr_b16 v[182:183], v205 offset:24512
    v_cndmask_b32_dpp v220, v86, v82, vcc quad_perm:[1,0,3,2] row_mask:0xf bank_mask:0xf
    v_cndmask_b32_dpp v221, v87, v83, vcc quad_perm:[1,0,3,2] row_mask:0xf bank_mask:0xf
    s_waitcnt vmcnt(15)
    v_cndmask_b32_dpp v226, v92, v88, vcc quad_perm:[1,0,3,2] row_mask:0xf bank_mask:0xf
    v_cndmask_b32_dpp v227, v93, v89, vcc quad_perm:[1,0,3,2] row_mask:0xf bank_mask:0xf
    s_waitcnt lgkmcnt(6)
    v_mfma_f32_32x32x16_bf16 a[48:63], v[160:163], v[64:67], a[48:63]
    ds_read_b64_tr_b16 v[184:185], v205 offset:23296
    ds_read_b64_tr_b16 v[186:187], v205 offset:24576
    buffer_load_dwordx4 v[116:119], v212, s[40:43], s30 offen offset:1280
    v_cndmask_b32_dpp v228, v94, v90, vcc quad_perm:[1,0,3,2] row_mask:0xf bank_mask:0xf
    v_cndmask_b32_dpp v229, v95, v91, vcc quad_perm:[1,0,3,2] row_mask:0xf bank_mask:0xf
    v_mfma_f32_32x32x16_bf16 a[64:79], v[164:167], v[64:67], a[64:79]
    ds_read_b64_tr_b16 v[160:161], v205 offset:25600
    ds_read_b64_tr_b16 v[162:163], v205 offset:26880
    s_not_b64 vcc, vcc
    v_cndmask_b32_dpp v222, v80, v84, vcc quad_perm:[1,0,3,2] row_mask:0xf bank_mask:0xf
    v_cndmask_b32_dpp v223, v81, v85, vcc quad_perm:[1,0,3,2] row_mask:0xf bank_mask:0xf
    v_cndmask_b32_dpp v224, v82, v86, vcc quad_perm:[1,0,3,2] row_mask:0xf bank_mask:0xf
    v_mfma_f32_32x32x16_bf16 a[0:15], v[168:171], v[68:71], a[0:15]
    ds_read_b64_tr_b16 v[164:165], v205 offset:25664
    ds_read_b64_tr_b16 v[166:167], v205 offset:26944
    buffer_load_dwordx4 v[120:123], v212, s[40:43], s30 offen offset:2432
    v_cndmask_b32_dpp v225, v83, v87, vcc quad_perm:[1,0,3,2] row_mask:0xf bank_mask:0xf
    v_cndmask_b32_dpp v230, v88, v92, vcc quad_perm:[1,0,3,2] row_mask:0xf bank_mask:0xf
    s_waitcnt lgkmcnt(6)
    v_mfma_f32_32x32x16_bf16 a[16:31], v[172:175], v[68:71], a[16:31]
    ds_read_b64_tr_b16 v[168:169], v205 offset:25728
    ds_read_b64_tr_b16 v[170:171], v205 offset:27008
    buffer_load_dwordx4 v[124:127], v212, s[40:43], s30 offen offset:3584
    s_add_u32 s84, s16, 3538944
    s_add_u32 m0, s72, 0
    v_cndmask_b32_dpp v231, v89, v93, vcc quad_perm:[1,0,3,2] row_mask:0xf bank_mask:0xf
    v_mfma_f32_32x32x16_bf16 a[32:47], v[176:179], v[68:71], a[32:47]
    ds_read_b64_tr_b16 v[172:173], v205 offset:25792
    ds_read_b64_tr_b16 v[174:175], v205 offset:27072
    buffer_load_dwordx4 v196, s[44:47], s84 offen offset:0 lds
    v_cndmask_b32_dpp v232, v90, v94, vcc quad_perm:[1,0,3,2] row_mask:0xf bank_mask:0xf
    v_cndmask_b32_dpp v233, v91, v95, vcc quad_perm:[1,0,3,2] row_mask:0xf bank_mask:0xf
    v_mfma_f32_32x32x16_bf16 a[48:63], v[180:183], v[68:71], a[48:63]
    ds_read_b64_tr_b16 v[176:177], v205 offset:25856
    ds_read_b64_tr_b16 v[178:179], v205 offset:27136
    buffer_load_dwordx4 v197, s[44:47], s84 offen offset:1024 lds
    s_mov_b64 vcc, s[36:37]
    v_cndmask_b32_dpp v80, v226, v218, vcc quad_perm:[2,3,0,1] row_mask:0xf bank_mask:0xf
    v_cndmask_b32_dpp v81, v227, v219, vcc quad_perm:[2,3,0,1] row_mask:0xf bank_mask:0xf
    s_waitcnt lgkmcnt(6)
    v_mfma_f32_32x32x16_bf16 a[64:79], v[184:187], v[68:71], a[64:79]
    ds_read_b64_tr_b16 v[180:181], v205 offset:28160
    ds_read_b64_tr_b16 v[182:183], v205 offset:29440
    buffer_load_dwordx4 v198, s[44:47], s84 offen offset:2048 lds
    v_cndmask_b32_dpp v82, v228, v220, vcc quad_perm:[2,3,0,1] row_mask:0xf bank_mask:0xf
    v_cndmask_b32_dpp v83, v229, v221, vcc quad_perm:[2,3,0,1] row_mask:0xf bank_mask:0xf
    v_mfma_f32_32x32x16_bf16 a[0:15], v[160:163], v[72:75], a[0:15]
    ds_read_b64_tr_b16 v[184:185], v205 offset:28224
    ds_read_b64_tr_b16 v[186:187], v205 offset:29504
    v_cndmask_b32_dpp v84, v230, v222, vcc quad_perm:[2,3,0,1] row_mask:0xf bank_mask:0xf
    v_cndmask_b32_dpp v85, v231, v223, vcc quad_perm:[2,3,0,1] row_mask:0xf bank_mask:0xf
    v_cndmask_b32_dpp v86, v232, v224, vcc quad_perm:[2,3,0,1] row_mask:0xf bank_mask:0xf
    v_cndmask_b32_dpp v87, v233, v225, vcc quad_perm:[2,3,0,1] row_mask:0xf bank_mask:0xf
    v_mfma_f32_32x32x16_bf16 a[16:31], v[164:167], v[72:75], a[16:31]
    ds_read_b64_tr_b16 v[160:161], v205 offset:28288
    ds_read_b64_tr_b16 v[162:163], v205 offset:29568
    buffer_load_dwordx4 v199, s[44:47], s84 offen offset:3072 lds
    s_add_u32 m0, s72, 4096
    s_not_b64 vcc, vcc
    s_waitcnt lgkmcnt(6)
    v_mfma_f32_32x32x16_bf16 a[32:47], v[168:171], v[72:75], a[32:47]
    ds_read_b64_tr_b16 v[164:165], v205 offset:28352
    ds_read_b64_tr_b16 v[166:167], v205 offset:29632
    v_cndmask_b32_dpp v88, v218, v226, vcc quad_perm:[2,3,0,1] row_mask:0xf bank_mask:0xf
    v_cndmask_b32_dpp v89, v219, v227, vcc quad_perm:[2,3,0,1] row_mask:0xf bank_mask:0xf
    v_cndmask_b32_dpp v90, v220, v228, vcc quad_perm:[2,3,0,1] row_mask:0xf bank_mask:0xf
    v_cndmask_b32_dpp v91, v221, v229, vcc quad_perm:[2,3,0,1] row_mask:0xf bank_mask:0xf
    v_mfma_f32_32x32x16_bf16 a[48:63], v[172:175], v[72:75], a[48:63]
    ds_read_b64_tr_b16 v[168:169], v205 offset:28416
    ds_read_b64_tr_b16 v[170:171], v205 offset:29696
    buffer_load_dwordx4 v200, s[44:47], s84 offen offset:0 lds
    s_add_u32 s84, s84, 147456
    s_add_u32 m0, s72, 5120
    v_mfma_f32_32x32x16_bf16 a[64:79], v[176:179], v[72:75], a[64:79]
    s_waitcnt vmcnt(13)
    s_waitcnt lgkmcnt(0)
    s_barrier
    v_add_u32 v205, 40960, v205
    ds_read_b64_tr_b16 v[172:173], v205 offset:0
    ds_read_b64_tr_b16 v[174:175], v205 offset:1280
    s_lshl_b32 s90, s2, 3
    s_add_u32 s90, s90, 4096
    s_cmp_eq_u32 s4, 0
    s_cselect_b32 s90, s90, 0x40000000
    buffer_store_dwordx2 v[12:13], v207, s[48:51], s90 offen offset:0 sc1
    v_mfma_f32_32x32x16_bf16 a[0:15], v[180:183], v[76:79], a[0:15]
    ds_read_b64_tr_b16 v[176:177], v205 offset:64
    ds_read_b64_tr_b16 v[178:179], v205 offset:1344
    s_lshl_b32 s90, s98, 3
    s_add_u32 s90, s90, 8192
    s_cmp_eq_u32 s4, 1
    s_cselect_b32 s90, s90, 0x40000000
    buffer_store_dwordx2 v[12:13], v207, s[48:51], s90 offen offset:0 sc1
    v_mfma_f32_32x32x16_bf16 a[16:31], v[184:187], v[76:79], a[16:31]
    ds_read_b64_tr_b16 v[180:181], v205 offset:128
    ds_read_b64_tr_b16 v[182:183], v205 offset:1408
    buffer_load_dwordx4 v196, s[44:47], s84 offen offset:0 lds
    v_mfma_f32_32x32x16_bf16 a[32:47], v[160:163], v[76:79], a[32:47]
    ds_read_b64_tr_b16 v[184:185], v205 offset:192
    ds_read_b64_tr_b16 v[186:187], v205 offset:1472
    buffer_load_dwordx4 v197, s[44:47], s84 offen offset:1024 lds
    s_sub_u32 s71, s2, 92
    s_mul_i32 s91, s71, 1821
    s_lshr_b32 s91, s91, 16
    s_mul_i32 s90, s71, 7282
    s_lshr_b32 s90, s90, 16
    s_mul_i32 s95, s90, 9
    s_sub_u32 s95, s71, s95
    s_add_u32 s96, s95, 5
    s_cmp_ge_u32 s96, 9
    s_cselect_b32 s97, 9, 0
    s_sub_u32 s96, s96, s97
    s_and_b32 s97, s90, 1
    s_cmp_eq_u32 s97, 0
    s_cselect_b32 s95, s96, s95
    s_and_b32 s90, s90, 3
    s_mul_i32 s38, s90, 20
    s_lshl_b32 s97, s95, 1
    s_add_u32 s38, s38, s97
    s_mul_i32 s90, s90, 9
    s_add_u32 s95, s95, s90
    s_lshl_b32 s96, s71, 5
    s_lshl_b32 s90, s4, 3
    s_add_u32 s96, s96, s90
    s_mov_b32 s97, 4
    s_mov_b32 s77, 8
    s_cmp_lt_u32 s71, 144
    s_cbranch_scc1 L_RP_W2C
    s_sub_u32 s90, s71, 144
    s_lshr_b32 s91, s90, 2
    s_and_b32 s95, s90, 3
    s_mul_i32 s38, s95, 20
    s_add_u32 s38, s38, 18
    s_add_u32 s95, s95, 36
    s_mul_i32 s96, s90, 36
    s_lshl_b32 s90, s4, 3
    s_add_u32 s96, s96, s90
    s_lshr_b32 s90, s4, 1
    s_lshl_b32 s90, s90, 2
    s_add_u32 s96, s96, s90
    s_mov_b32 s97, 8
    s_mov_b32 s77, 4
    s_cmp_lt_u32 s71, 160
    s_cbranch_scc1 L_RP_W2C
    s_sub_u32 s91, s71, 160
    s_mov_b32 s95, 40
    s_mov_b32 s38, 80
    s_lshl_b32 s96, s91, 2
    s_add_u32 s96, s96, s4
    s_mul_i32 s96, s96, 36
    s_add_u32 s96, s96, 16
    s_mov_b32 s97, 16
    s_mov_b32 s77, 8
L_RP_W2C:
    s_mul_i32 s96, s96, 1152
    s_waitcnt lgkmcnt(6)
    v_mfma_f32_32x32x16_bf16 a[48:63], v[164:167], v[76:79], a[48:63]
    ds_read_b64_tr_b16 v[160:161], v205 offset:256
    ds_read_b64_tr_b16 v[162:163], v205 offset:1536
    s_cmp_lt_u32 s71, 164
    s_cselect_b32 s96, s96, 0x40000000
    s_mul_i32 s11, s91, 41
    s_add_u32 s11, s11, s95
    v_mfma_f32_32x32x16_bf16 a[64:79], v[168:171], v[76:79], a[64:79]
    ds_read_b64_tr_b16 v[164:165], v205 offset:2560
    ds_read_b64_tr_b16 v[166:167], v205 offset:3840
    buffer_load_dwordx4 v198, s[44:47], s84 offen offset:2048 lds
    v_lshrrev_b32 v235, 5, v1
    v_mul_lo_u32 v235, v235, s97
    v_mfma_f32_32x32x16_bf16 a[0:15], v[172:175], v[80:83], a[0:15]
    ds_read_b64_tr_b16 v[168:169], v205 offset:2624
    ds_read_b64_tr_b16 v[170:171], v205 offset:3904
    v_bfe_u32 v236, v1, 2, 2
    v_add_u32 v234, v235, v236
    v_mul_u32_u24 v234, 1152, v234
    v_bfe_u32 v235, v1, 4, 1
    s_waitcnt lgkmcnt(6)
    v_mfma_f32_32x32x16_bf16 a[16:31], v[176:179], v[80:83], a[16:31]
    ds_read_b64_tr_b16 v[172:173], v205 offset:2688
    ds_read_b64_tr_b16 v[174:175], v205 offset:3968
    buffer_load_dwordx4 v199, s[44:47], s84 offen offset:3072 lds
    s_add_u32 m0, s72, 9216
    v_lshl_add_u32 v234, v235, 5, v234
    v_mfma_f32_32x32x16_bf16 a[32:47], v[180:183], v[80:83], a[32:47]
    ds_read_b64_tr_b16 v[176:177], v205 offset:2752
    ds_read_b64_tr_b16 v[178:179], v205 offset:4032
    v_and_b32 v235, 3, v1
    v_lshl_add_u32 v234, v235, 3, v234
    s_lshr_b32 s90, s4, 1
    s_mul_i32 s90, s90, 576
    v_mfma_f32_32x32x16_bf16 a[48:63], v[184:187], v[80:83], a[48:63]
    ds_read_b64_tr_b16 v[180:181], v205 offset:2816
    ds_read_b64_tr_b16 v[182:183], v205 offset:4096
    buffer_load_dwordx4 v200, s[44:47], s84 offen offset:0 lds
    s_add_u32 s90, s90, 122880
    v_add_u32 v3, s90, v234
    s_waitcnt lgkmcnt(6)
    v_mfma_f32_32x32x16_bf16 a[64:79], v[160:163], v[80:83], a[64:79]
    ds_read_b64_tr_b16 v[184:185], v205 offset:5120
    ds_read_b64_tr_b16 v[186:187], v205 offset:6400
    buffer_load_dwordx4 v[128:131], v212, s[40:43], s30 offen offset:256
    s_mul_i32 s77, s77, 1152
    v_add_u32 v2, s77, v3
    v_cndmask_b32_dpp v92, v222, v230, vcc quad_perm:[2,3,0,1] row_mask:0xf bank_mask:0xf
    v_mfma_f32_32x32x16_bf16 a[0:15], v[164:167], v[84:87], a[0:15]
    ds_read_b64_tr_b16 v[160:161], v205 offset:5184
    ds_read_b64_tr_b16 v[162:163], v205 offset:6464
    buffer_load_dwordx4 v[132:135], v212, s[40:43], s30 offen offset:1408
    v_cndmask_b32_dpp v93, v223, v231, vcc quad_perm:[2,3,0,1] row_mask:0xf bank_mask:0xf
    v_cndmask_b32_dpp v94, v224, v232, vcc quad_perm:[2,3,0,1] row_mask:0xf bank_mask:0xf
    v_mfma_f32_32x32x16_bf16 a[16:31], v[168:171], v[84:87], a[16:31]
    ds_read_b64_tr_b16 v[164:165], v205 offset:5248
    ds_read_b64_tr_b16 v[166:167], v205 offset:6528
    v_cndmask_b32_dpp v95, v225, v233, vcc quad_perm:[2,3,0,1] row_mask:0xf bank_mask:0xf
    s_mov_b64 vcc, s[34:35]
    s_waitcnt vmcnt(20)
    v_cndmask_b32_dpp v218, v100, v96, vcc quad_perm:[1,0,3,2] row_mask:0xf bank_mask:0xf
    v_cndmask_b32_dpp v219, v101, v97, vcc quad_perm:[1,0,3,2] row_mask:0xf bank_mask:0xf
    s_waitcnt lgkmcnt(6)
    v_mfma_f32_32x32x16_bf16 a[32:47], v[172:175], v[84:87], a[32:47]
    ds_read_b64_tr_b16 v[168:169], v205 offset:5312
    ds_read_b64_tr_b16 v[170:171], v205 offset:6592
    buffer_load_dwordx4 v[136:139], v212, s[40:43], s30 offen offset:2560
    v_cndmask_b32_dpp v220, v102, v98, vcc quad_perm:[1,0,3,2] row_mask:0xf bank_mask:0xf
    v_cndmask_b32_dpp v221, v103, v99, vcc quad_perm:[1,0,3,2] row_mask:0xf bank_mask:0xf
    v_mfma_f32_32x32x16_bf16 a[48:63], v[176:179], v[84:87], a[48:63]
    ds_read_b64_tr_b16 v[172:173], v205 offset:5376
    ds_read_b64_tr_b16 v[174:175], v205 offset:6656
    s_waitcnt vmcnt(19)
    v_cndmask_b32_dpp v226, v108, v104, vcc quad_perm:[1,0,3,2] row_mask:0xf bank_mask:0xf
    v_cndmask_b32_dpp v227, v109, v105, vcc quad_perm:[1,0,3,2] row_mask:0xf bank_mask:0xf
    v_cndmask_b32_dpp v228, v110, v106, vcc quad_perm:[1,0,3,2] row_mask:0xf bank_mask:0xf
    v_cndmask_b32_dpp v229, v111, v107, vcc quad_perm:[1,0,3,2] row_mask:0xf bank_mask:0xf
    v_mfma_f32_32x32x16_bf16 a[64:79], v[180:183], v[84:87], a[64:79]
    ds_read_b64_tr_b16 v[176:177], v205 offset:7680
    ds_read_b64_tr_b16 v[178:179], v205 offset:8960
    buffer_load_dwordx4 v[140:143], v212, s[40:43], s30 offen offset:3712
    s_not_b64 vcc, vcc
    v_cndmask_b32_dpp v222, v96, v100, vcc quad_perm:[1,0,3,2] row_mask:0xf bank_mask:0xf
    s_waitcnt lgkmcnt(6)
    v_mfma_f32_32x32x16_bf16 a[0:15], v[184:187], v[88:91], a[0:15]
    ds_read_b64_tr_b16 v[180:181], v205 offset:7744
    ds_read_b64_tr_b16 v[182:183], v205 offset:9024
    v_cndmask_b32_dpp v223, v97, v101, vcc quad_perm:[1,0,3,2] row_mask:0xf bank_mask:0xf
    v_cndmask_b32_dpp v224, v98, v102, vcc quad_perm:[1,0,3,2] row_mask:0xf bank_mask:0xf
    v_cndmask_b32_dpp v225, v99, v103, vcc quad_perm:[1,0,3,2] row_mask:0xf bank_mask:0xf
    v_cndmask_b32_dpp v230, v104, v108, vcc quad_perm:[1,0,3,2] row_mask:0xf bank_mask:0xf
    v_mfma_f32_32x32x16_bf16 a[16:31], v[160:163], v[88:91], a[16:31]
    ds_read_b64_tr_b16 v[184:185], v205 offset:7808
    ds_read_b64_tr_b16 v[186:187], v205 offset:9088
    buffer_load_dwordx4 v[144:147], v212, s[40:43], s30 offen offset:384
    v_cndmask_b32_dpp v231, v105, v109, vcc quad_perm:[1,0,3,2] row_mask:0xf bank_mask:0xf
    v_cndmask_b32_dpp v232, v106, v110, vcc quad_perm:[1,0,3,2] row_mask:0xf bank_mask:0xf
    v_mfma_f32_32x32x16_bf16 a[32:47], v[164:167], v[88:91], a[32:47]
    ds_read_b64_tr_b16 v[160:161], v205 offset:7872
    ds_read_b64_tr_b16 v[162:163], v205 offset:9152
    v_cndmask_b32_dpp v233, v107, v111, vcc quad_perm:[1,0,3,2] row_mask:0xf bank_mask:0xf
    s_mov_b64 vcc, s[36:37]
    v_cndmask_b32_dpp v96, v226, v218, vcc quad_perm:[2,3,0,1] row_mask:0xf bank_mask:0xf
    v_cndmask_b32_dpp v97, v227, v219, vcc quad_perm:[2,3,0,1] row_mask:0xf bank_mask:0xf
    s_waitcnt lgkmcnt(6)
    v_mfma_f32_32x32x16_bf16 a[48:63], v[168:171], v[88:91], a[48:63]
    ds_read_b64_tr_b16 v[164:165], v205 offset:7936
    ds_read_b64_tr_b16 v[166:167], v205 offset:9216
    buffer_load_dwordx4 v[148:151], v212, s[40:43], s30 offen offset:1536
    v_cndmask_b32_dpp v98, v228, v220, vcc quad_perm:[2,3,0,1] row_mask:0xf bank_mask:0xf
    v_cndmask_b32_dpp v99, v229, v221, vcc quad_perm:[2,3,0,1] row_mask:0xf bank_mask:0xf
    v_mfma_f32_32x32x16_bf16 a[64:79], v[172:175], v[88:91], a[64:79]
    ds_read_b64_tr_b16 v[168:169], v205 offset:20480
    ds_read_b64_tr_b16 v[170:171], v205 offset:21760
    v_cndmask_b32_dpp v100, v230, v222, vcc quad_perm:[2,3,0,1] row_mask:0xf bank_mask:0xf
    v_cndmask_b32_dpp v101, v231, v223, vcc quad_perm:[2,3,0,1] row_mask:0xf bank_mask:0xf
    v_cndmask_b32_dpp v102, v232, v224, vcc quad_perm:[2,3,0,1] row_mask:0xf bank_mask:0xf
    v_cndmask_b32_dpp v103, v233, v225, vcc quad_perm:[2,3,0,1] row_mask:0xf bank_mask:0xf
    v_mfma_f32_32x32x16_bf16 a[0:15], v[176:179], v[92:95], a[0:15]
    ds_read_b64_tr_b16 v[172:173], v205 offset:20544
    ds_read_b64_tr_b16 v[174:175], v205 offset:21824
    buffer_load_dwordx4 v[152:155], v212, s[40:43], s30 offen offset:2688
    s_not_b64 vcc, vcc
    v_cndmask_b32_dpp v104, v218, v226, vcc quad_perm:[2,3,0,1] row_mask:0xf bank_mask:0xf
    s_waitcnt lgkmcnt(6)
    v_mfma_f32_32x32x16_bf16 a[16:31], v[180:183], v[92:95], a[16:31]
    ds_read_b64_tr_b16 v[176:177], v205 offset:20608
    ds_read_b64_tr_b16 v[178:179], v205 offset:21888
    buffer_load_dwordx4 v[156:159], v212, s[40:43], s30 offen offset:3840
    s_add_u32 m0, s74, 122880
    v_cndmask_b32_dpp v105, v219, v227, vcc quad_perm:[2,3,0,1] row_mask:0xf bank_mask:0xf
    v_cndmask_b32_dpp v106, v220, v228, vcc quad_perm:[2,3,0,1] row_mask:0xf bank_mask:0xf
    v_mfma_f32_32x32x16_bf16 a[32:47], v[184:187], v[92:95], a[32:47]
    ds_read_b64_tr_b16 v[180:181], v205 offset:20672
    ds_read_b64_tr_b16 v[182:183], v205 offset:21952
    v_cndmask_b32_dpp v107, v221, v229, vcc quad_perm:[2,3,0,1] row_mask:0xf bank_mask:0xf
    v_cndmask_b32_dpp v108, v222, v230, vcc quad_perm:[2,3,0,1] row_mask:0xf bank_mask:0xf
    v_cndmask_b32_dpp v109, v223, v231, vcc quad_perm:[2,3,0,1] row_mask:0xf bank_mask:0xf
    v_mfma_f32_32x32x16_bf16 a[48:63], v[160:163], v[92:95], a[48:63]
    ds_read_b64_tr_b16 v[184:185], v205 offset:20736
    ds_read_b64_tr_b16 v[186:187], v205 offset:22016
    buffer_load_dwordx4 v209, s[52:55], s96 offen offset:0 lds
    v_cndmask_b32_dpp v110, v224, v232, vcc quad_perm:[2,3,0,1] row_mask:0xf bank_mask:0xf
    v_cndmask_b32_dpp v111, v225, v233, vcc quad_perm:[2,3,0,1] row_mask:0xf bank_mask:0xf
    s_waitcnt lgkmcnt(6)
    v_mfma_f32_32x32x16_bf16 a[64:79], v[164:167], v[92:95], a[64:79]
    ds_read_b64_tr_b16 v[160:161], v205 offset:23040
    ds_read_b64_tr_b16 v[162:163], v205 offset:24320
    v_mfma_f32_32x32x16_bf16 a[0:15], v[168:171], v[96:99], a[0:15]
    ds_read_b64_tr_b16 v[164:165], v205 offset:23104
    ds_read_b64_tr_b16 v[166:167], v205 offset:24384
    buffer_load_dwordx4 v209, s[52:55], s96 offen offset:1024 lds
    v_mfma_f32_32x32x16_bf16 a[16:31], v[172:175], v[96:99], a[16:31]
    ds_read_b64_tr_b16 v[168:169], v205 offset:23168
    ds_read_b64_tr_b16 v[170:171], v205 offset:24448
    buffer_load_dwordx4 v209, s[52:55], s96 offen offset:2048 lds
    s_mov_b64 vcc, s[34:35]
    s_waitcnt vmcnt(25)
    v_cndmask_b32_dpp v218, v116, v112, vcc quad_perm:[1,0,3,2] row_mask:0xf bank_mask:0xf
    v_cndmask_b32_dpp v219, v117, v113, vcc quad_perm:[1,0,3,2] row_mask:0xf bank_mask:0xf
    s_waitcnt lgkmcnt(6)
    v_mfma_f32_32x32x16_bf16 a[32:47], v[176:179], v[96:99], a[32:47]
    ds_read_b64_tr_b16 v[172:173], v205 offset:23232
    ds_read_b64_tr_b16 v[174:175], v205 offset:24512
    v_cndmask_b32_dpp v220, v118, v114, vcc quad_perm:[1,0,3,2] row_mask:0xf bank_mask:0xf
    v_cndmask_b32_dpp v221, v119, v115, vcc quad_perm:[1,0,3,2] row_mask:0xf bank_mask:0xf
    s_waitcnt vmcnt(23)
    v_cndmask_b32_dpp v226, v124, v120, vcc quad_perm:[1,0,3,2] row_mask:0xf bank_mask:0xf
    v_cndmask_b32_dpp v227, v125, v121, vcc quad_perm:[1,0,3,2] row_mask:0xf bank_mask:0xf
    v_mfma_f32_32x32x16_bf16 a[48:63], v[180:183], v[96:99], a[48:63]
    ds_read_b64_tr_b16 v[176:177], v205 offset:23296
    ds_read_b64_tr_b16 v[178:179], v205 offset:24576
    buffer_load_dwordx4 v209, s[52:55], s96 offen offset:3072 lds
    s_add_u32 m0, s74, 126976
    s_add_u32 s96, s96, 4096
    v_mfma_f32_32x32x16_bf16 a[64:79], v[184:187], v[96:99], a[64:79]
    ds_read_b64_tr_b16 v[180:181], v205 offset:25600
    ds_read_b64_tr_b16 v[182:183], v205 offset:26880
    buffer_load_dwordx4 v209, s[52:55], s96 offen offset:0 lds
    v_cndmask_b32_dpp v228, v126, v122, vcc quad_perm:[1,0,3,2] row_mask:0xf bank_mask:0xf
    v_cndmask_b32_dpp v229, v127, v123, vcc quad_perm:[1,0,3,2] row_mask:0xf bank_mask:0xf
    s_not_b64 vcc, vcc
    s_waitcnt lgkmcnt(6)
    v_mfma_f32_32x32x16_bf16 a[0:15], v[160:163], v[100:103], a[0:15]
    ds_read_b64_tr_b16 v[184:185], v205 offset:25664
    ds_read_b64_tr_b16 v[186:187], v205 offset:26944
    v_cndmask_b32_dpp v222, v112, v116, vcc quad_perm:[1,0,3,2] row_mask:0xf bank_mask:0xf
    v_cndmask_b32_dpp v223, v113, v117, vcc quad_perm:[1,0,3,2] row_mask:0xf bank_mask:0xf
    v_cndmask_b32_dpp v224, v114, v118, vcc quad_perm:[1,0,3,2] row_mask:0xf bank_mask:0xf
    v_mfma_f32_32x32x16_bf16 a[16:31], v[164:167], v[100:103], a[16:31]
    ds_read_b64_tr_b16 v[160:161], v205 offset:25728
    ds_read_b64_tr_b16 v[162:163], v205 offset:27008
    buffer_load_dwordx4 v209, s[52:55], s96 offen offset:1024 lds
    v_cndmask_b32_dpp v225, v115, v119, vcc quad_perm:[1,0,3,2] row_mask:0xf bank_mask:0xf
    v_cndmask_b32_dpp v230, v120, v124, vcc quad_perm:[1,0,3,2] row_mask:0xf bank_mask:0xf
    v_cndmask_b32_dpp v231, v121, v125, vcc quad_perm:[1,0,3,2] row_mask:0xf bank_mask:0xf
    v_mfma_f32_32x32x16_bf16 a[32:47], v[168:171], v[100:103], a[32:47]
    ds_read_b64_tr_b16 v[164:165], v205 offset:25792
    ds_read_b64_tr_b16 v[166:167], v205 offset:27072
    v_cndmask_b32_dpp v232, v122, v126, vcc quad_perm:[1,0,3,2] row_mask:0xf bank_mask:0xf
    v_cndmask_b32_dpp v233, v123, v127, vcc quad_perm:[1,0,3,2] row_mask:0xf bank_mask:0xf
    s_mov_b64 vcc, s[36:37]
    s_waitcnt lgkmcnt(6)
    v_mfma_f32_32x32x16_bf16 a[48:63], v[172:175], v[100:103], a[48:63]
    ds_read_b64_tr_b16 v[168:169], v205 offset:25856
    ds_read_b64_tr_b16 v[170:171], v205 offset:27136
    buffer_load_dwordx4 v209, s[52:55], s96 offen offset:2048 lds
    v_cndmask_b32_dpp v112, v226, v218, vcc quad_perm:[2,3,0,1] row_mask:0xf bank_mask:0xf
    v_cndmask_b32_dpp v113, v227, v219, vcc quad_perm:[2,3,0,1] row_mask:0xf bank_mask:0xf
    v_cndmask_b32_dpp v114, v228, v220, vcc quad_perm:[2,3,0,1] row_mask:0xf bank_mask:0xf
    v_mfma_f32_32x32x16_bf16 a[64:79], v[176:179], v[100:103], a[64:79]
    ds_read_b64_tr_b16 v[172:173], v205 offset:28160
    ds_read_b64_tr_b16 v[174:175], v205 offset:29440
    buffer_load_dwordx4 v209, s[52:55], s96 offen offset:3072 lds
    s_add_u32 m0, s74, 131072
    s_add_u32 s96, s96, 4096
    v_mfma_f32_32x32x16_bf16 a[0:15], v[180:183], v[104:107], a[0:15]
    ds_read_b64_tr_b16 v[176:177], v205 offset:28224
    ds_read_b64_tr_b16 v[178:179], v205 offset:29504
    v_cndmask_b32_dpp v115, v229, v221, vcc quad_perm:[2,3,0,1] row_mask:0xf bank_mask:0xf
    v_cndmask_b32_dpp v116, v230, v222, vcc quad_perm:[2,3,0,1] row_mask:0xf bank_mask:0xf
    v_cndmask_b32_dpp v117, v231, v223, vcc quad_perm:[2,3,0,1] row_mask:0xf bank_mask:0xf
    v_cndmask_b32_dpp v118, v232, v224, vcc quad_perm:[2,3,0,1] row_mask:0xf bank_mask:0xf
    s_waitcnt lgkmcnt(6)
    v_mfma_f32_32x32x16_bf16 a[16:31], v[184:187], v[104:107], a[16:31]
    ds_read_b64_tr_b16 v[180:181], v205 offset:28288
    ds_read_b64_tr_b16 v[182:183], v205 offset:29568
    buffer_load_dwordx4 v209, s[52:55], s96 offen offset:0 lds
    s_mov_b32 s84, s17
    s_lshr_b32 s85, s72, 1
    v_mfma_f32_32x32x16_bf16 a[32:47], v[160:163], v[104:107], a[32:47]
    ds_read_b64_tr_b16 v[184:185], v205 offset:28352
    ds_read_b64_tr_b16 v[186:187], v205 offset:29632
    s_add_u32 m0, s85, 40960
    s_nop 0
    buffer_load_dwordx4 v196, s[44:47], s84 offen offset:0 lds
    s_lshl_b32 s95, s91, 2
    s_add_u32 s90, s95, s4
    v_mfma_f32_32x32x16_bf16 a[48:63], v[164:167], v[104:107], a[48:63]
    ds_read_b64_tr_b16 v[160:161], v205 offset:28416
    ds_read_b64_tr_b16 v[162:163], v205 offset:29696
    s_mul_i32 s90, s90, 375808
    s_add_u32 s90, s90, 4194304
    s_cmp_lt_u32 s71, 164
    s_cselect_b32 s90, s90, 0x40000000
    s_waitcnt lgkmcnt(6)
    v_mfma_f32_32x32x16_bf16 a[64:79], v[168:171], v[104:107], a[64:79]
    s_waitcnt vmcnt(18)
    s_waitcnt lgkmcnt(0)
    s_barrier
    v_subrev_u32 v205, 81920, v205
    ds_read_b64_tr_b16 v[164:165], v205 offset:0
    ds_read_b64_tr_b16 v[166:167], v205 offset:1280
    buffer_load_dwordx4 v197, s[44:47], s84 offen offset:1024 lds
    s_mul_i32 s39, s38, 3072
    s_add_u32 s39, s39, s90
    v_mfma_f32_32x32x16_bf16 a[0:15], v[172:175], v[108:111], a[0:15]
    ds_read_b64_tr_b16 v[168:169], v205 offset:64
    ds_read_b64_tr_b16 v[170:171], v205 offset:1344
    s_lshl_b32 s96, s38, 10
    s_add_u32 s96, s96, s90
    s_add_u32 s96, s96, 290816
    v_mfma_f32_32x32x16_bf16 a[16:31], v[176:179], v[108:111], a[16:31]
    ds_read_b64_tr_b16 v[172:173], v205 offset:128
    ds_read_b64_tr_b16 v[174:175], v205 offset:1408
    buffer_load_dwordx4 v198, s[44:47], s84 offen offset:2048 lds
    s_add_u32 s3, s39, 3072
    s_add_u32 s77, s96, 1024
    s_cmp_lt_u32 s38, 80
    s_cselect_b32 s3, s3, 0x40000000
    s_cselect_b32 s77, s77, 0x40000000
    v_mfma_f32_32x32x16_bf16 a[32:47], v[180:183], v[108:111], a[32:47]
    ds_read_b64_tr_b16 v[176:177], v205 offset:192
    ds_read_b64_tr_b16 v[178:179], v205 offset:1472
    buffer_load_dwordx4 v199, s[44:47], s84 offen offset:3072 lds
    v_mfma_f32_32x32x16_bf16 a[48:63], v[184:187], v[108:111], a[48:63]
    ds_read_b64_tr_b16 v[180:181], v205 offset:256
    ds_read_b64_tr_b16 v[182:183], v205 offset:1536
    s_add_u32 m0, s85, 45056
    s_mul_i32 s97, s38, 3277
    s_lshr_b32 s97, s97, 16
    s_mul_i32 s15, s97, 20
    v_mfma_f32_32x32x16_bf16 a[64:79], v[160:163], v[108:111], a[64:79]
    ds_read_b64_tr_b16 v[184:185], v205 offset:2560
    ds_read_b64_tr_b16 v[186:187], v205 offset:3840
    buffer_load_dwordx4 v200, s[44:47], s84 offen offset:0 lds
    s_sub_u32 s15, s38, s15
    s_lshr_b32 s90, s97, 1
    s_waitcnt lgkmcnt(6)
    v_mfma_f32_32x32x16_bf16 a[0:15], v[164:167], v[112:115], a[0:15]
    ds_read_b64_tr_b16 v[160:161], v205 offset:2624
    ds_read_b64_tr_b16 v[162:163], v205 offset:3904
    s_mul_i32 s90, s90, 20
    s_add_u32 s15, s15, s90
    s_and_b32 s90, s4, 1
    s_and_b32 s97, s97, 1
    v_mfma_f32_32x32x16_bf16 a[16:31], v[168:171], v[112:115], a[16:31]
    ds_read_b64_tr_b16 v[164:165], v205 offset:2688
    ds_read_b64_tr_b16 v[166:167], v205 offset:3968
    buffer_load_dwordx2 v[8:9], v15, s[48:51], 0 offen sc1
    s_cmp_lt_u32 s38, 80
    s_cselect_b32 s97, s97, s90
    s_cselect_b32 s38, s90, 0
    v_mfma_f32_32x32x16_bf16 a[32:47], v[172:175], v[112:115], a[32:47]
    ds_read_b64_tr_b16 v[168:169], v205 offset:2752
    ds_read_b64_tr_b16 v[170:171], v205 offset:4032
    s_add_u32 s15, s15, s38
    s_lshl_b32 s15, s15, 10
    s_andn2_b32 s90, s4, 1
    s_waitcnt lgkmcnt(6)
    v_mfma_f32_32x32x16_bf16 a[48:63], v[176:179], v[112:115], a[48:63]
    ds_read_b64_tr_b16 v[172:173], v205 offset:2816
    ds_read_b64_tr_b16 v[174:175], v205 offset:4096
    s_add_u32 s90, s90, s97
    s_add_u32 s90, s90, s95
    s_mul_i32 s90, s90, 375808
    v_mfma_f32_32x32x16_bf16 a[64:79], v[180:183], v[112:115], a[64:79]
    ds_read_b64_tr_b16 v[176:177], v205 offset:5120
    ds_read_b64_tr_b16 v[178:179], v205 offset:6400
    s_add_u32 s15, s15, s90
    s_add_u32 s15, s15, 4443136
    s_cmp_lt_u32 s71, 164
    s_cselect_b32 s15, s15, 0x40000000
    v_cndmask_b32_dpp v119, v233, v225, vcc quad_perm:[2,3,0,1] row_mask:0xf bank_mask:0xf
    s_nop 1
    v_mfma_f32_32x32x16_bf16 a[0:15], v[184:187], v[116:119], a[0:15]
    ds_read_b64_tr_b16 v[180:181], v205 offset:5184
    ds_read_b64_tr_b16 v[182:183], v205 offset:6464
    s_mul_i32 s38, s38, 18432
    s_add_u32 s38, s38, 256
    s_and_b32 s95, s4, 1
    s_waitcnt lgkmcnt(6)
    v_mfma_f32_32x32x16_bf16 a[16:31], v[160:163], v[116:119], a[16:31]
    ds_read_b64_tr_b16 v[184:185], v205 offset:5248
    ds_read_b64_tr_b16 v[186:187], v205 offset:6528
    s_mul_i32 s95, s95, 320
    s_not_b64 vcc, vcc
    v_cndmask_b32_dpp v120, v218, v226, vcc quad_perm:[2,3,0,1] row_mask:0xf bank_mask:0xf
    v_cndmask_b32_dpp v121, v219, v227, vcc quad_perm:[2,3,0,1] row_mask:0xf bank_mask:0xf
    v_mfma_f32_32x32x16_bf16 a[32:47], v[164:167], v[116:119], a[32:47]
    ds_read_b64_tr_b16 v[160:161], v205 offset:5312
    ds_read_b64_tr_b16 v[162:163], v205 offset:6592
    v_cndmask_b32_dpp v122, v220, v228, vcc quad_perm:[2,3,0,1] row_mask:0xf bank_mask:0xf
    v_cndmask_b32_dpp v123, v221, v229, vcc quad_perm:[2,3,0,1] row_mask:0xf bank_mask:0xf
    v_cndmask_b32_dpp v124, v222, v230, vcc quad_perm:[2,3,0,1] row_mask:0xf bank_mask:0xf
    v_mfma_f32_32x32x16_bf16 a[48:63], v[168:171], v[116:119], a[48:63]
    ds_read_b64_tr_b16 v[164:165], v205 offset:5376
    ds_read_b64_tr_b16 v[166:167], v205 offset:6656
    v_cndmask_b32_dpp v125, v223, v231, vcc quad_perm:[2,3,0,1] row_mask:0xf bank_mask:0xf
    v_cndmask_b32_dpp v126, v224, v232, vcc quad_perm:[2,3,0,1] row_mask:0xf bank_mask:0xf
    v_cndmask_b32_dpp v127, v225, v233, vcc quad_perm:[2,3,0,1] row_mask:0xf bank_mask:0xf
    s_mov_b64 vcc, s[34:35]
    s_waitcnt lgkmcnt(6)
    v_mfma_f32_32x32x16_bf16 a[64:79], v[172:175], v[116:119], a[64:79]
    ds_read_b64_tr_b16 v[168:169], v205 offset:7680
    ds_read_b64_tr_b16 v[170:171], v205 offset:8960
    s_waitcnt vmcnt(21)
    v_cndmask_b32_dpp v218, v132, v128, vcc quad_perm:[1,0,3,2] row_mask:0xf bank_mask:0xf
    v_cndmask_b32_dpp v219, v133, v129, vcc quad_perm:[1,0,3,2] row_mask:0xf bank_mask:0xf
    v_cndmask_b32_dpp v220, v134, v130, vcc quad_perm:[1,0,3,2] row_mask:0xf bank_mask:0xf
    v_mfma_f32_32x32x16_bf16 a[0:15], v[176:179], v[120:123], a[0:15]
    ds_read_b64_tr_b16 v[172:173], v205 offset:7744
    ds_read_b64_tr_b16 v[174:175], v205 offset:9024
    v_cndmask_b32_dpp v221, v135, v131, vcc quad_perm:[1,0,3,2] row_mask:0xf bank_mask:0xf
    s_waitcnt vmcnt(19)
    v_cndmask_b32_dpp v226, v140, v136, vcc quad_perm:[1,0,3,2] row_mask:0xf bank_mask:0xf
    v_cndmask_b32_dpp v227, v141, v137, vcc quad_perm:[1,0,3,2] row_mask:0xf bank_mask:0xf
    v_cndmask_b32_dpp v228, v142, v138, vcc quad_perm:[1,0,3,2] row_mask:0xf bank_mask:0xf
    v_mfma_f32_32x32x16_bf16 a[16:31], v[180:183], v[120:123], a[16:31]
    ds_read_b64_tr_b16 v[176:177], v205 offset:7808
    ds_read_b64_tr_b16 v[178:179], v205 offset:9088
    v_cndmask_b32_dpp v229, v143, v139, vcc quad_perm:[1,0,3,2] row_mask:0xf bank_mask:0xf
    s_not_b64 vcc, vcc
    v_cndmask_b32_dpp v222, v128, v132, vcc quad_perm:[1,0,3,2] row_mask:0xf bank_mask:0xf
    s_waitcnt lgkmcnt(6)
    v_mfma_f32_32x32x16_bf16 a[32:47], v[184:187], v[120:123], a[32:47]
    ds_read_b64_tr_b16 v[180:181], v205 offset:7872
    ds_read_b64_tr_b16 v[182:183], v205 offset:9152
    v_cndmask_b32_dpp v223, v129, v133, vcc quad_perm:[1,0,3,2] row_mask:0xf bank_mask:0xf
    v_cndmask_b32_dpp v224, v130, v134, vcc quad_perm:[1,0,3,2] row_mask:0xf bank_mask:0xf
    v_cndmask_b32_dpp v225, v131, v135, vcc quad_perm:[1,0,3,2] row_mask:0xf bank_mask:0xf
    v_cndmask_b32_dpp v230, v136, v140, vcc quad_perm:[1,0,3,2] row_mask:0xf bank_mask:0xf
    v_mfma_f32_32x32x16_bf16 a[48:63], v[160:163], v[120:123], a[48:63]
    ds_read_b64_tr_b16 v[184:185], v205 offset:7936
    ds_read_b64_tr_b16 v[186:187], v205 offset:9216
    v_cndmask_b32_dpp v231, v137, v141, vcc quad_perm:[1,0,3,2] row_mask:0xf bank_mask:0xf
    v_cndmask_b32_dpp v232, v138, v142, vcc quad_perm:[1,0,3,2] row_mask:0xf bank_mask:0xf
    v_cndmask_b32_dpp v233, v139, v143, vcc quad_perm:[1,0,3,2] row_mask:0xf bank_mask:0xf
    v_mfma_f32_32x32x16_bf16 a[64:79], v[164:167], v[120:123], a[64:79]
    ds_read_b64_tr_b16 v[160:161], v205 offset:20480
    ds_read_b64_tr_b16 v[162:163], v205 offset:21760
    s_mov_b64 vcc, s[36:37]
    v_cndmask_b32_dpp v128, v226, v218, vcc quad_perm:[2,3,0,1] row_mask:0xf bank_mask:0xf
    v_cndmask_b32_dpp v129, v227, v219, vcc quad_perm:[2,3,0,1] row_mask:0xf bank_mask:0xf
    v_cndmask_b32_dpp v130, v228, v220, vcc quad_perm:[2,3,0,1] row_mask:0xf bank_mask:0xf
    s_waitcnt lgkmcnt(6)
    v_mfma_f32_32x32x16_bf16 a[0:15], v[168:171], v[124:127], a[0:15]
    ds_read_b64_tr_b16 v[164:165], v205 offset:20544
    ds_read_b64_tr_b16 v[166:167], v205 offset:21824
    v_cndmask_b32_dpp v131, v229, v221, vcc quad_perm:[2,3,0,1] row_mask:0xf bank_mask:0xf
    v_cndmask_b32_dpp v132, v230, v222, vcc quad_perm:[2,3,0,1] row_mask:0xf bank_mask:0xf
    v_cndmask_b32_dpp v133, v231, v223, vcc quad_perm:[2,3,0,1] row_mask:0xf bank_mask:0xf
    v_mfma_f32_32x32x16_bf16 a[16:31], v[172:175], v[124:127], a[16:31]
    ds_read_b64_tr_b16 v[168:169], v205 offset:20608
    ds_read_b64_tr_b16 v[170:171], v205 offset:21888
    v_cndmask_b32_dpp v134, v232, v224, vcc quad_perm:[2,3,0,1] row_mask:0xf bank_mask:0xf
    v_cndmask_b32_dpp v135, v233, v225, vcc quad_perm:[2,3,0,1] row_mask:0xf bank_mask:0xf
    s_not_b64 vcc, vcc
    v_cndmask_b32_dpp v136, v218, v226, vcc quad_perm:[2,3,0,1] row_mask:0xf bank_mask:0xf
    v_mfma_f32_32x32x16_bf16 a[32:47], v[176:179], v[124:127], a[32:47]
    ds_read_b64_tr_b16 v[172:173], v205 offset:20672
    ds_read_b64_tr_b16 v[174:175], v205 offset:21952
    v_cndmask_b32_dpp v137, v219, v227, vcc quad_perm:[2,3,0,1] row_mask:0xf bank_mask:0xf
    v_cndmask_b32_dpp v138, v220, v228, vcc quad_perm:[2,3,0,1] row_mask:0xf bank_mask:0xf
    v_cndmask_b32_dpp v139, v221, v229, vcc quad_perm:[2,3,0,1] row_mask:0xf bank_mask:0xf
    s_waitcnt lgkmcnt(6)
    v_mfma_f32_32x32x16_bf16 a[48:63], v[180:183], v[124:127], a[48:63]
    ds_read_b64_tr_b16 v[176:177], v205 offset:20736
    ds_read_b64_tr_b16 v[178:179], v205 offset:22016
    v_cndmask_b32_dpp v140, v222, v230, vcc quad_perm:[2,3,0,1] row_mask:0xf bank_mask:0xf
    v_cndmask_b32_dpp v141, v223, v231, vcc quad_perm:[2,3,0,1] row_mask:0xf bank_mask:0xf
    v_cndmask_b32_dpp v142, v224, v232, vcc quad_perm:[2,3,0,1] row_mask:0xf bank_mask:0xf
    v_cndmask_b32_dpp v143, v225, v233, vcc quad_perm:[2,3,0,1] row_mask:0xf bank_mask:0xf
    v_mfma_f32_32x32x16_bf16 a[64:79], v[184:187], v[124:127], a[64:79]
    ds_read_b64_tr_b16 v[180:181], v205 offset:23040
    ds_read_b64_tr_b16 v[182:183], v205 offset:24320
    v_mfma_f32_32x32x16_bf16 a[0:15], v[160:163], v[128:131], a[0:15]
    ds_read_b64_tr_b16 v[184:185], v205 offset:23104
    ds_read_b64_tr_b16 v[186:187], v205 offset:24384
    s_waitcnt lgkmcnt(6)
    v_mfma_f32_32x32x16_bf16 a[16:31], v[164:167], v[128:131], a[16:31]
    ds_read_b64_tr_b16 v[160:161], v205 offset:23168
    ds_read_b64_tr_b16 v[162:163], v205 offset:24448
    s_mov_b64 vcc, s[34:35]
    s_waitcnt vmcnt(17)
    v_cndmask_b32_dpp v218, v148, v144, vcc quad_perm:[1,0,3,2] row_mask:0xf bank_mask:0xf
    v_cndmask_b32_dpp v219, v149, v145, vcc quad_perm:[1,0,3,2] row_mask:0xf bank_mask:0xf
    v_cndmask_b32_dpp v220, v150, v146, vcc quad_perm:[1,0,3,2] row_mask:0xf bank_mask:0xf
    v_mfma_f32_32x32x16_bf16 a[32:47], v[168:171], v[128:131], a[32:47]
    ds_read_b64_tr_b16 v[164:165], v205 offset:23232
    ds_read_b64_tr_b16 v[166:167], v205 offset:24512
    v_cndmask_b32_dpp v221, v151, v147, vcc quad_perm:[1,0,3,2] row_mask:0xf bank_mask:0xf
    s_waitcnt vmcnt(15)
    v_cndmask_b32_dpp v226, v156, v152, vcc quad_perm:[1,0,3,2] row_mask:0xf bank_mask:0xf
    v_cndmask_b32_dpp v227, v157, v153, vcc quad_perm:[1,0,3,2] row_mask:0xf bank_mask:0xf
    v_cndmask_b32_dpp v228, v158, v154, vcc quad_perm:[1,0,3,2] row_mask:0xf bank_mask:0xf
    v_mfma_f32_32x32x16_bf16 a[48:63], v[172:175], v[128:131], a[48:63]
    ds_read_b64_tr_b16 v[168:169], v205 offset:23296
    ds_read_b64_tr_b16 v[170:171], v205 offset:24576
    v_cndmask_b32_dpp v229, v159, v155, vcc quad_perm:[1,0,3,2] row_mask:0xf bank_mask:0xf
    s_not_b64 vcc, vcc
    v_cndmask_b32_dpp v222, v144, v148, vcc quad_perm:[1,0,3,2] row_mask:0xf bank_mask:0xf
    s_waitcnt lgkmcnt(6)
    v_mfma_f32_32x32x16_bf16 a[64:79], v[176:179], v[128:131], a[64:79]
    ds_read_b64_tr_b16 v[172:173], v205 offset:25600
    ds_read_b64_tr_b16 v[174:175], v205 offset:26880
    v_cndmask_b32_dpp v223, v145, v149, vcc quad_perm:[1,0,3,2] row_mask:0xf bank_mask:0xf
    v_cndmask_b32_dpp v224, v146, v150, vcc quad_perm:[1,0,3,2] row_mask:0xf bank_mask:0xf
    v_cndmask_b32_dpp v225, v147, v151, vcc quad_perm:[1,0,3,2] row_mask:0xf bank_mask:0xf
    v_cndmask_b32_dpp v230, v152, v156, vcc quad_perm:[1,0,3,2] row_mask:0xf bank_mask:0xf
    v_mfma_f32_32x32x16_bf16 a[0:15], v[180:183], v[132:135], a[0:15]
    ds_read_b64_tr_b16 v[176:177], v205 offset:25664
    ds_read_b64_tr_b16 v[178:179], v205 offset:26944
    s_waitcnt vmcnt(0)
L_PC1:
    v_cmp_ne_u64 s[78:79], s[82:83], v[8:9]
    s_nop 3
    s_cmp_lg_u64 s[78:79], 0
    s_cbranch_scc1 L_PS1
L_PR1:
    s_lshl_b32 s85, s4, 10
    s_add_u32 s84, s12, s85
    s_add_u32 m0, s85, 114688
    s_nop 0
    buffer_load_dwordx4 v209, s[48:51], s84 offen offset:0 sc1 lds
    v_mfma_f32_32x32x16_bf16 a[16:31], v[184:187], v[132:135], a[16:31]
    ds_read_b64_tr_b16 v[180:181], v205 offset:25728
    ds_read_b64_tr_b16 v[182:183], v205 offset:27008
    s_add_u32 s84, s12, 4096
    s_mov_b32 m0, 118784
    s_nop 0
    buffer_load_dwordx4 v209, s[48:51], s84 offen offset:0 sc1 lds
    s_waitcnt lgkmcnt(6)
    v_mfma_f32_32x32x16_bf16 a[32:47], v[160:163], v[132:135], a[32:47]
    ds_read_b64_tr_b16 v[184:185], v205 offset:25792
    ds_read_b64_tr_b16 v[186:187], v205 offset:27072
    s_add_u32 s84, s20, 0
    s_add_u32 m0, s73, 81920
    s_nop 0
    buffer_load_dwordx4 v209, s[48:51], s84 offen offset:0 sc1 lds
    v_mfma_f32_32x32x16_bf16 a[48:63], v[164:167], v[132:135], a[48:63]
    ds_read_b64_tr_b16 v[160:161], v205 offset:25856
    ds_read_b64_tr_b16 v[162:163], v205 offset:27136
    buffer_load_dwordx4 v209, s[48:51], s84 offen offset:1024 sc1 lds
    v_and_b32 v15, 31, v1
    v_lshlrev_b32 v15, 2, v15
    v_cndmask_b32_dpp v231, v153, v157, vcc quad_perm:[1,0,3,2] row_mask:0xf bank_mask:0xf
    v_mfma_f32_32x32x16_bf16 a[64:79], v[168:171], v[132:135], a[64:79]
    ds_read_b64_tr_b16 v[164:165], v205 offset:28160
    ds_read_b64_tr_b16 v[166:167], v205 offset:29440
    buffer_load_dword v8, v15, s[48:51], s31 offen sc1
    buffer_load_dwordx4 v209, s[48:51], s84 offen offset:2048 sc1 lds
    v_cndmask_b32_dpp v232, v154, v158, vcc quad_perm:[1,0,3,2] row_mask:0xf bank_mask:0xf
    s_waitcnt lgkmcnt(6)
    v_mfma_f32_32x32x16_bf16 a[0:15], v[172:175], v[136:139], a[0:15]
    ds_read_b64_tr_b16 v[168:169], v205 offset:28224
    ds_read_b64_tr_b16 v[170:171], v205 offset:29504
    buffer_load_dwordx4 v209, s[48:51], s84 offen offset:3072 sc1 lds
    s_add_u32 m0, s73, 86016
    s_add_u32 s84, s84, 4096
    v_cndmask_b32_dpp v233, v155, v159, vcc quad_perm:[1,0,3,2] row_mask:0xf bank_mask:0xf
    v_mfma_f32_32x32x16_bf16 a[16:31], v[176:179], v[136:139], a[16:31]
    ds_read_b64_tr_b16 v[172:173], v205 offset:28288
    ds_read_b64_tr_b16 v[174:175], v205 offset:29568
    buffer_load_dwordx4 v209, s[48:51], s84 offen offset:0 sc1 lds
    s_mov_b64 vcc, s[36:37]
    v_cndmask_b32_dpp v144, v226, v218, vcc quad_perm:[2,3,0,1] row_mask:0xf bank_mask:0xf
    v_mfma_f32_32x32x16_bf16 a[32:47], v[180:183], v[136:139], a[32:47]
    ds_read_b64_tr_b16 v[176:177], v205 offset:28352
    ds_read_b64_tr_b16 v[178:179], v205 offset:29632
    buffer_load_dwordx4 v209, s[48:51], s84 offen offset:1024 sc1 lds
    v_cndmask_b32_dpp v145, v227, v219, vcc quad_perm:[2,3,0,1] row_mask:0xf bank_mask:0xf
    v_cndmask_b32_dpp v146, v228, v220, vcc quad_perm:[2,3,0,1] row_mask:0xf bank_mask:0xf
    v_cndmask_b32_dpp v147, v229, v221, vcc quad_perm:[2,3,0,1] row_mask:0xf bank_mask:0xf
    s_waitcnt lgkmcnt(6)
    v_mfma_f32_32x32x16_bf16 a[48:63], v[184:187], v[136:139], a[48:63]
    ds_read_b64_tr_b16 v[180:181], v205 offset:28416
    ds_read_b64_tr_b16 v[182:183], v205 offset:29696
    buffer_load_dwordx4 v209, s[48:51], s84 offen offset:2048 sc1 lds
    v_cndmask_b32_dpp v148, v230, v222, vcc quad_perm:[2,3,0,1] row_mask:0xf bank_mask:0xf
    v_cndmask_b32_dpp v149, v231, v223, vcc quad_perm:[2,3,0,1] row_mask:0xf bank_mask:0xf
    v_mfma_f32_32x32x16_bf16 a[64:79], v[160:163], v[136:139], a[64:79]
    s_waitcnt lgkmcnt(0)
    s_barrier
    v_add_u32 v205, 40960, v205
    ds_read_b64_tr_b16 v[184:185], v205 offset:0
    ds_read_b64_tr_b16 v[186:187], v205 offset:1280
    buffer_load_dwordx4 v209, s[48:51], s84 offen offset:3072 sc1 lds
    s_add_u32 s84, s20, 32768
    s_add_u32 m0, s73, 0
    s_add_u32 s90, s91, 1
    v_mfma_f32_32x32x16_bf16 a[0:15], v[164:167], v[140:143], a[0:15]
    ds_read_b64_tr_b16 v[160:161], v205 offset:64
    ds_read_b64_tr_b16 v[162:163], v205 offset:1344
    s_and_b32 s90, s90, 3
    s_lshl_b32 s90, s90, 6
    s_add_u32 s90, s90, s95
    v_mfma_f32_32x32x16_bf16 a[16:31], v[168:171], v[140:143], a[16:31]
    ds_read_b64_tr_b16 v[164:165], v205 offset:128
    ds_read_b64_tr_b16 v[166:167], v205 offset:1408
    v_add_u32 v250, s90, v3
    v_add_u32 v251, s90, v2
    v_cndmask_b32_dpp v150, v232, v224, vcc quad_perm:[2,3,0,1] row_mask:0xf bank_mask:0xf
    v_cndmask_b32_dpp v151, v233, v225, vcc quad_perm:[2,3,0,1] row_mask:0xf bank_mask:0xf
    v_mfma_f32_32x32x16_bf16 a[32:47], v[172:175], v[140:143], a[32:47]
    ds_read_b64_tr_b16 v[168:169], v205 offset:192
    ds_read_b64_tr_b16 v[170:171], v205 offset:1472
    ds_read_b64_tr_b16 v[234:235], v250 offset:0
    ds_read_b64_tr_b16 v[236:237], v251 offset:0
    s_not_b64 vcc, vcc
    v_mfma_f32_32x32x16_bf16 a[48:63], v[176:179], v[140:143], a[48:63]
    ds_read_b64_tr_b16 v[172:173], v205 offset:256
    ds_read_b64_tr_b16 v[174:175], v205 offset:1536
    ds_read_b64_tr_b16 v[238:239], v250 offset:18432
    ds_read_b64_tr_b16 v[240:241], v251 offset:18432
    s_add_u32 s90, s91, 2
    s_and_b32 s90, s90, 3
    s_waitcnt lgkmcnt(10)
    v_mfma_f32_32x32x16_bf16 a[64:79], v[180:183], v[140:143], a[64:79]
    ds_read_b64_tr_b16 v[176:177], v205 offset:2560
    ds_read_b64_tr_b16 v[178:179], v205 offset:3840
    buffer_load_dwordx4 v209, s[48:51], s84 offen offset:0 sc1 lds
    s_lshl_b32 s90, s90, 6
    s_add_u32 s90, s90, s95
    v_mfma_f32_32x32x16_bf16 a[0:15], v[184:187], v[144:147], a[0:15]
    ds_read_b64_tr_b16 v[180:181], v205 offset:2624
    ds_read_b64_tr_b16 v[182:183], v205 offset:3904
    v_add_u32 v250, s90, v3
    v_add_u32 v251, s90, v2
    v_cndmask_b32_dpp v152, v218, v226, vcc quad_perm:[2,3,0,1] row_mask:0xf bank_mask:0xf
    v_cndmask_b32_dpp v153, v219, v227, vcc quad_perm:[2,3,0,1] row_mask:0xf bank_mask:0xf
    v_mfma_f32_32x32x16_bf16 a[16:31], v[160:163], v[144:147], a[16:31]
    ds_read_b64_tr_b16 v[184:185], v205 offset:2688
    s_waitcnt lgkmcnt(14)
    ds_read_b64_tr_b16 v[186:187], v205 offset:3968
    s_waitcnt lgkmcnt(14)
    ds_read_b64_tr_b16 v[242:243], v250 offset:0
    s_waitcnt lgkmcnt(14)
    ds_read_b64_tr_b16 v[244:245], v251 offset:0
    v_cndmask_b32_dpp v154, v220, v228, vcc quad_perm:[2,3,0,1] row_mask:0xf bank_mask:0xf
    s_waitcnt lgkmcnt(10)
    v_mfma_f32_32x32x16_bf16 a[32:47], v[164:167], v[144:147], a[32:47]
    ds_read_b64_tr_b16 v[160:161], v205 offset:2752
    ds_read_b64_tr_b16 v[162:163], v205 offset:4032
    buffer_store_dwordx4 v[234:237], v209, s[48:51], s39 offen offset:0 sc1
    ds_read_b64_tr_b16 v[246:247], v250 offset:18432
    v_cndmask_b32_dpp v155, v221, v229, vcc quad_perm:[2,3,0,1] row_mask:0xf bank_mask:0xf
    v_cndmask_b32_dpp v156, v222, v230, vcc quad_perm:[2,3,0,1] row_mask:0xf bank_mask:0xf
    v_mfma_f32_32x32x16_bf16 a[48:63], v[168:171], v[144:147], a[48:63]
    ds_read_b64_tr_b16 v[164:165], v205 offset:2816
    ds_read_b64_tr_b16 v[166:167], v205 offset:4096
    s_waitcnt lgkmcnt(14)
    ds_read_b64_tr_b16 v[248:249], v251 offset:18432
    s_waitcnt lgkmcnt(14)
    buffer_store_dwordx4 v[238:241], v209, s[48:51], s3 offen offset:0 sc1
    s_add_u32 s90, s91, 3
    v_mfma_f32_32x32x16_bf16 a[64:79], v[172:175], v[144:147], a[64:79]
    ds_read_b64_tr_b16 v[168:169], v205 offset:5120
    s_waitcnt lgkmcnt(14)
    ds_read_b64_tr_b16 v[170:171], v205 offset:6400
    buffer_load_dwordx4 v209, s[48:51], s84 offen offset:1024 sc1 lds
    s_and_b32 s90, s90, 3
    s_lshl_b32 s90, s90, 6
    s_add_u32 s90, s90, s95
    s_waitcnt lgkmcnt(10)
    v_mfma_f32_32x32x16_bf16 a[0:15], v[176:179], v[148:151], a[0:15]
    ds_read_b64_tr_b16 v[172:173], v205 offset:5184
    ds_read_b64_tr_b16 v[174:175], v205 offset:6464
    buffer_load_dwordx4 v209, s[48:51], s84 offen offset:2048 sc1 lds
    v_add_u32 v250, s90, v3
    v_add_u32 v251, s90, v2
    v_mfma_f32_32x32x16_bf16 a[16:31], v[180:183], v[148:151], a[16:31]
    ds_read_b64_tr_b16 v[176:177], v205 offset:5248
    ds_read_b64_tr_b16 v[178:179], v205 offset:6528
    ds_read_b64_tr_b16 v[234:235], v250 offset:0
    s_waitcnt lgkmcnt(14)
    ds_read_b64_tr_b16 v[236:237], v251 offset:0
    v_cndmask_b32_dpp v157, v223, v231, vcc quad_perm:[2,3,0,1] row_mask:0xf bank_mask:0xf
    v_cndmask_b32_dpp v158, v224, v232, vcc quad_perm:[2,3,0,1] row_mask:0xf bank_mask:0xf
    v_mfma_f32_32x32x16_bf16 a[32:47], v[184:187], v[148:151], a[32:47]
    s_waitcnt lgkmcnt(14)
    ds_read_b64_tr_b16 v[180:181], v205 offset:5312
    s_waitcnt lgkmcnt(14)
    ds_read_b64_tr_b16 v[182:183], v205 offset:6592
    buffer_store_dwordx4 v[242:245], v209, s[48:51], s39 offen offset:1024 sc1
    s_waitcnt lgkmcnt(14)
    ds_read_b64_tr_b16 v[238:239], v250 offset:18432
    v_cndmask_b32_dpp v159, v225, v233, vcc quad_perm:[2,3,0,1] row_mask:0xf bank_mask:0xf
    s_waitcnt lgkmcnt(9)
    v_mfma_f32_32x32x16_bf16 a[48:63], v[160:163], v[148:151], a[48:63]
    ds_read_b64_tr_b16 v[184:185], v205 offset:5376
    ds_read_b64_tr_b16 v[186:187], v205 offset:6656
    ds_read_b64_tr_b16 v[240:241], v251 offset:18432
    buffer_store_dwordx4 v[246:249], v209, s[48:51], s3 offen offset:1024 sc1
    s_add_u32 s90, s91, 4
    s_and_b32 s90, s90, 3
    v_mfma_f32_32x32x16_bf16 a[64:79], v[164:167], v[148:151], a[64:79]
    ds_read_b64_tr_b16 v[160:161], v205 offset:7680
    ds_read_b64_tr_b16 v[162:163], v205 offset:8960
    s_lshl_b32 s90, s90, 6
    s_add_u32 s90, s90, s95
    v_add_u32 v250, s90, v3
    v_mfma_f32_32x32x16_bf16 a[0:15], v[168:171], v[152:155], a[0:15]
    ds_read_b64_tr_b16 v[164:165], v205 offset:7744
    s_waitcnt lgkmcnt(14)
    ds_read_b64_tr_b16 v[166:167], v205 offset:9024
    buffer_load_dwordx4 v209, s[48:51], s84 offen offset:3072 sc1 lds
    s_add_u32 m0, s73, 4096
    s_add_u32 s84, s84, 4096
    v_add_u32 v251, s90, v2
    s_waitcnt lgkmcnt(8)
    v_mfma_f32_32x32x16_bf16 a[16:31], v[172:175], v[152:155], a[16:31]
    ds_read_b64_tr_b16 v[168:169], v205 offset:7808
    ds_read_b64_tr_b16 v[170:171], v205 offset:9088
    ds_read_b64_tr_b16 v[242:243], v250 offset:0
    ds_read_b64_tr_b16 v[244:245], v251 offset:0
    s_waitcnt vmcnt(14)
    v_xor_b32 v9, 0x8000, v8
    v_mfma_f32_32x32x16_bf16 a[32:47], v[176:179], v[152:155], a[32:47]
    ds_read_b64_tr_b16 v[172:173], v205 offset:7872
    ds_read_b64_tr_b16 v[174:175], v205 offset:9152
    buffer_store_dwordx4 v[234:237], v209, s[48:51], s39 offen offset:2048 sc1
    ds_read_b64_tr_b16 v[246:247], v250 offset:18432
    v_and_b32 v9, 0xffff, v9
    v_lshl_or_b32 v9, v9, 16, v9
    v_mfma_f32_32x32x16_bf16 a[48:63], v[180:183], v[152:155], a[48:63]
    s_waitcnt lgkmcnt(14)
    ds_read_b64_tr_b16 v[176:177], v205 offset:7936
    s_waitcnt lgkmcnt(14)
    ds_read_b64_tr_b16 v[178:179], v205 offset:9216
    s_waitcnt lgkmcnt(14)
    ds_read_b64_tr_b16 v[248:249], v251 offset:18432
    s_waitcnt lgkmcnt(14)
    buffer_store_dwordx4 v[238:241], v209, s[48:51], s3 offen offset:2048 sc1
    v_lshrrev_b32 v15, 16, v8
    s_waitcnt lgkmcnt(10)
    v_mfma_f32_32x32x16_bf16 a[64:79], v[184:187], v[152:155], a[64:79]
    s_waitcnt vmcnt(10)
    s_waitcnt lgkmcnt(0)
    s_barrier
    v_add_u32 v206, 81920, v209
    ds_read_b128 v[180:183], v206 offset:32768
    buffer_load_dwordx4 v209, s[48:51], s84 offen offset:0 sc1 lds
    v_and_b32 v8, v254, v8
    v_rcp_f32 v211, v8
    v_mfma_f32_32x32x16_bf16 a[0:15], v[160:163], v[156:159], a[0:15]
    ds_read_b128 v[184:187], v206 offset:33792
    s_mov_b32 s92, -1
    s_mov_b32 s93, 0
    v_cndmask_b32 v214, v15, v9, s[92:93]
    v_mfma_f32_32x32x16_bf16 a[16:31], v[164:167], v[156:159], a[16:31]
    ds_read_b128 v[160:163], v206 offset:34816
    buffer_load_dwordx4 v209, s[48:51], s84 offen offset:1024 sc1 lds
    v_cndmask_b32 v215, 0, v9, s[92:93]
    v_cndmask_b32 v216, 0, v9, s[92:93]
    v_cndmask_b32 v217, 0, v9, s[92:93]
    v_mfma_f32_32x32x16_bf16 a[32:47], v[168:171], v[156:159], a[32:47]
    ds_read_b128 v[164:167], v206 offset:35840
    v_add_u32 v250, s38, v3
    v_add_u32 v251, s38, v2
    v_mfma_f32_32x32x16_bf16 a[48:63], v[172:175], v[156:159], a[48:63]
    ds_read_b128 v[168:171], v206 offset:36864
    ds_read_b64_tr_b16 v[234:235], v250 offset:0
    ds_read_b64_tr_b16 v[236:237], v251 offset:0
    v_mfma_f32_32x32x16_bf16 a[64:79], v[176:179], v[156:159], a[64:79]
    ds_read_b128 v[172:175], v206 offset:0
    buffer_store_dwordx4 v[242:245], v209, s[48:51], s96 offen offset:0 sc1
    s_waitcnt lgkmcnt(5)
    v_mfma_f32_32x32x16_bf16 a[0:15], v[180:183], v[214:217], a[0:15]
    ds_read_b128 v[176:179], v206 offset:1024
    buffer_load_dwordx4 v209, s[48:51], s84 offen offset:2048 sc1 lds
    v_mfma_f32_32x32x16_bf16 a[16:31], v[184:187], v[214:217], a[16:31]
    ds_read_b128 v[180:183], v206 offset:2048
    buffer_store_dwordx4 v[246:249], v209, s[48:51], s77 offen offset:0 sc1
    v_mfma_f32_32x32x16_bf16 a[32:47], v[160:163], v[214:217], a[32:47]
    ds_read_b128 v[184:187], v206 offset:3072
    buffer_load_dwordx4 v209, s[48:51], s84 offen offset:3072 sc1 lds
    s_add_u32 s84, s20, 65536
    s_add_u32 m0, s73, 40960
    s_nop 1
    v_accvgpr_read_b32 v218, a0
    v_accvgpr_read_b32 v219, a1
    s_waitcnt lgkmcnt(3)
    v_mfma_f32_32x32x16_bf16 a[48:63], v[164:167], v[214:217], a[48:63]
    ds_read_b128 v[160:163], v206 offset:4096
    buffer_store_dwordx4 v[234:237], v209, s[48:51], s15 offen offset:0 sc1
    v_accvgpr_read_b32 v220, a2
    v_accvgpr_read_b32 v221, a3
    v_accvgpr_read_b32 v222, a4
    v_accvgpr_read_b32 v223, a5
    v_mfma_f32_32x32x16_bf16 a[64:79], v[168:171], v[214:217], a[64:79]
    ds_read_b128 v[164:167], v206 offset:5120
    v_accvgpr_read_b32 v224, a6
    v_accvgpr_read_b32 v225, a7
    v_mul_f32 v218, v218, |v218|
    v_mul_f32 v219, v219, |v219|
    v_mfma_f32_32x32x16_bf16 a[144:159], v[172:175], v[16:19], 0
    ds_read_b128 v[168:171], v206 offset:6144
    v_mul_f32 v220, v220, |v220|
    v_mul_f32 v221, v221, |v221|
    v_mul_f32 v222, v222, |v222|
    v_mul_f32 v223, v223, |v223|
    v_mul_f32 v224, v224, |v224|
    s_waitcnt lgkmcnt(3)
    v_mfma_f32_32x32x16_bf16 a[160:175], v[176:179], v[16:19], 0
    ds_read_b128 v[172:175], v206 offset:7168
    buffer_load_dwordx4 v209, s[48:51], s84 offen offset:0 sc1 lds
    v_mul_f32 v225, v225, |v225|
    v_cvt_pk_bf16_f32 v226, v218, v219
    v_cvt_pk_bf16_f32 v227, v220, v221
    v_mfma_f32_32x32x16_bf16 a[176:191], v[180:183], v[16:19], 0
    ds_read_b128 v[176:179], v206 offset:8192
    v_cvt_pk_bf16_f32 v228, v222, v223
    v_cvt_pk_bf16_f32 v229, v224, v225
    v_pk_max_i16 v226, v226, 0
    v_pk_max_i16 v227, v227, 0
    v_pk_max_i16 v228, v228, 0
    v_mfma_f32_32x32x16_bf16 a[192:207], v[184:187], v[16:19], 0
    ds_read_b128 v[180:183], v206 offset:9216
    buffer_load_dwordx4 v209, s[48:51], s84 offen offset:1024 sc1 lds
    v_pk_max_i16 v229, v229, 0
    v_accvgpr_read_b32 v218, a8
    v_accvgpr_read_b32 v219, a9
    s_waitcnt lgkmcnt(3)
    v_mfma_f32_32x32x16_bf16 a[144:159], v[160:163], v[20:23], a[144:159]
    ds_read_b128 v[184:187], v206 offset:10240
    v_accvgpr_read_b32 v220, a10
    v_accvgpr_read_b32 v221, a11
    v_accvgpr_read_b32 v222, a12
    v_accvgpr_read_b32 v223, a13
    v_accvgpr_read_b32 v224, a14
    v_mfma_f32_32x32x16_bf16 a[160:175], v[164:167], v[20:23], a[160:175]
    ds_read_b128 v[160:163], v206 offset:11264
    buffer_load_dwordx4 v209, s[48:51], s84 offen offset:2048 sc1 lds
    v_accvgpr_read_b32 v225, a15
    v_mul_f32 v218, v218, |v218|
    v_mul_f32 v219, v219, |v219|
    v_mfma_f32_32x32x16_bf16 a[176:191], v[168:171], v[20:23], a[176:191]
    ds_read_b128 v[164:167], v206 offset:12288
    buffer_load_dwordx4 v209, s[48:51], s84 offen offset:3072 sc1 lds
    s_add_u32 m0, s73, 45056
    s_add_u32 s84, s84, 4096
    v_mul_f32 v220, v220, |v220|
    v_mul_f32 v221, v221, |v221|
    s_waitcnt lgkmcnt(3)
    v_mfma_f32_32x32x16_bf16 a[192:207], v[172:175], v[20:23], a[192:207]
    ds_read_b128 v[168:171], v206 offset:13312
    v_mul_f32 v222, v222, |v222|
    v_mul_f32 v223, v223, |v223|
    v_mul_f32 v224, v224, |v224|
    v_mul_f32 v225, v225, |v225|
    v_mfma_f32_32x32x16_bf16 a[144:159], v[176:179], v[24:27], a[144:159]
    ds_read_b128 v[172:175], v206 offset:14336
    buffer_load_dwordx4 v209, s[48:51], s84 offen offset:0 sc1 lds
    v_cvt_pk_bf16_f32 v230, v218, v219
    v_cvt_pk_bf16_f32 v231, v220, v221
    v_cvt_pk_bf16_f32 v232, v222, v223
    v_cvt_pk_bf16_f32 v233, v224, v225
    v_mfma_f32_32x32x16_bf16 a[160:175], v[180:183], v[24:27], a[160:175]
    ds_read_b128 v[176:179], v206 offset:15360
    v_pk_max_i16 v230, v230, 0
    v_pk_max_i16 v231, v231, 0
    v_pk_max_i16 v232, v232, 0
    v_pk_max_i16 v233, v233, 0
    s_waitcnt lgkmcnt(3)
    v_mfma_f32_32x32x16_bf16 a[176:191], v[184:187], v[24:27], a[176:191]
    ds_read_b128 v[180:183], v206 offset:16384
    s_add_u32 s94, s14, 0
    buffer_store_dwordx4 v[226:229], v209, s[48:51], s94 offen sc1
    buffer_store_dwordx4 v[230:233], v209, s[48:51], s94 offen offset:1024 sc1
    v_accvgpr_write_b32 a0, v226
    v_accvgpr_write_b32 a1, v227
    v_mfma_f32_32x32x16_bf16 a[192:207], v[160:163], v[24:27], a[192:207]
    ds_read_b128 v[184:187], v206 offset:17408
    v_accvgpr_write_b32 a2, v228
    v_accvgpr_write_b32 a3, v229
    v_accvgpr_write_b32 a4, v230
    v_accvgpr_write_b32 a5, v231
    v_mfma_f32_32x32x16_bf16 a[144:159], v[164:167], v[28:31], a[144:159]
    ds_read_b128 v[160:163], v206 offset:18432
    v_accvgpr_write_b32 a6, v232
    v_accvgpr_write_b32 a7, v233
    s_waitcnt lgkmcnt(3)
    v_mfma_f32_32x32x16_bf16 a[160:175], v[168:171], v[28:31], a[160:175]
    ds_read_b128 v[164:167], v206 offset:19456
    buffer_load_dwordx4 v209, s[48:51], s84 offen offset:1024 sc1 lds
    v_accvgpr_read_b32 v218, a16
    v_accvgpr_read_b32 v219, a17
    v_accvgpr_read_b32 v220, a18
    v_accvgpr_read_b32 v221, a19
    v_mfma_f32_32x32x16_bf16 a[176:191], v[172:175], v[28:31], a[176:191]
    ds_read_b128 v[168:171], v206 offset:20480
    buffer_load_dwordx4 v209, s[48:51], s84 offen offset:2048 sc1 lds
    v_accvgpr_read_b32 v222, a20
    v_accvgpr_read_b32 v223, a21
    v_accvgpr_read_b32 v224, a22
    v_accvgpr_read_b32 v225, a23
    v_mfma_f32_32x32x16_bf16 a[192:207], v[176:179], v[28:31], a[192:207]
    ds_read_b128 v[172:175], v206 offset:21504
    v_mul_f32 v218, v218, |v218|
    v_mul_f32 v219, v219, |v219|
    v_mul_f32 v220, v220, |v220|
    v_mul_f32 v221, v221, |v221|
    s_waitcnt lgkmcnt(3)
    v_mfma_f32_32x32x16_bf16 a[144:159], v[180:183], v[32:35], a[144:159]
    ds_read_b128 v[176:179], v206 offset:22528
    buffer_load_dwordx4 v209, s[48:51], s84 offen offset:3072 sc1 lds
    v_mul_f32 v222, v222, |v222|
    v_mul_f32 v223, v223, |v223|
    v_mul_f32 v224, v224, |v224|
    v_mul_f32 v225, v225, |v225|
    v_mfma_f32_32x32x16_bf16 a[160:175], v[184:187], v[32:35], a[160:175]
    ds_read_b128 v[180:183], v206 offset:23552
    v_cvt_pk_bf16_f32 v226, v218, v219
    v_cvt_pk_bf16_f32 v227, v220, v221
    v_cvt_pk_bf16_f32 v228, v222, v223
    v_cvt_pk_bf16_f32 v229, v224, v225
    v_mfma_f32_32x32x16_bf16 a[176:191], v[160:163], v[32:35], a[176:191]
    ds_read_b128 v[184:187], v206 offset:24576
    v_pk_max_i16 v226, v226, 0
    v_pk_max_i16 v227, v227, 0
    v_pk_max_i16 v228, v228, 0
    v_pk_max_i16 v229, v229, 0
    v_accvgpr_read_b32 v218, a24
    s_waitcnt lgkmcnt(3)
    v_mfma_f32_32x32x16_bf16 a[192:207], v[164:167], v[32:35], a[192:207]
    ds_read_b128 v[160:163], v206 offset:25600
    v_accvgpr_read_b32 v219, a25
    v_accvgpr_read_b32 v220, a26
    v_accvgpr_read_b32 v221, a27
    v_accvgpr_read_b32 v222, a28
    v_mfma_f32_32x32x16_bf16 a[144:159], v[168:171], v[36:39], a[144:159]
    ds_read_b128 v[164:167], v206 offset:26624
    v_accvgpr_read_b32 v223, a29
    v_accvgpr_read_b32 v224, a30
    v_accvgpr_read_b32 v225, a31
    v_mul_f32 v218, v218, |v218|
    v_mul_f32 v219, v219, |v219|
    v_mfma_f32_32x32x16_bf16 a[160:175], v[172:175], v[36:39], a[160:175]
    ds_read_b128 v[168:171], v206 offset:27648
    v_mul_f32 v220, v220, |v220|
    v_mul_f32 v221, v221, |v221|
    v_mul_f32 v222, v222, |v222|
    v_mul_f32 v223, v223, |v223|
    s_waitcnt lgkmcnt(3)
    v_mfma_f32_32x32x16_bf16 a[176:191], v[176:179], v[36:39], a[176:191]
    ds_read_b128 v[172:175], v206 offset:28672
    v_mul_f32 v224, v224, |v224|
    v_mul_f32 v225, v225, |v225|
    v_cvt_pk_bf16_f32 v230, v218, v219
    v_cvt_pk_bf16_f32 v231, v220, v221
    v_cvt_pk_bf16_f32 v232, v222, v223
    v_mfma_f32_32x32x16_bf16 a[192:207], v[180:183], v[36:39], a[192:207]
    ds_read_b128 v[176:179], v206 offset:29696
    v_cvt_pk_bf16_f32 v233, v224, v225
    v_pk_max_i16 v230, v230, 0
    v_pk_max_i16 v231, v231, 0
    v_pk_max_i16 v232, v232, 0
    v_mfma_f32_32x32x16_bf16 a[144:159], v[184:187], v[40:43], a[144:159]
    ds_read_b128 v[180:183], v206 offset:30720
    v_pk_max_i16 v233, v233, 0
    s_add_u32 s94, s14, 2048
    s_waitcnt lgkmcnt(3)
    v_mfma_f32_32x32x16_bf16 a[160:175], v[160:163], v[40:43], a[160:175]
    ds_read_b128 v[184:187], v206 offset:31744
    buffer_store_dwordx4 v[226:229], v209, s[48:51], s94 offen sc1
    buffer_store_dwordx4 v[230:233], v209, s[48:51], s94 offen offset:1024 sc1
    v_accvgpr_write_b32 a8, v226
    v_accvgpr_write_b32 a9, v227
    v_accvgpr_write_b32 a10, v228
    v_mfma_f32_32x32x16_bf16 a[176:191], v[164:167], v[40:43], a[176:191]
    s_waitcnt vmcnt(13)
    s_waitcnt lgkmcnt(0)
    s_barrier
    v_add_u32 v206, 0, v209
    ds_read_b128 v[160:163], v206 offset:0
    s_add_u32 s84, s20, 98304
    s_add_u32 m0, s73, 81920
    s_nop 0
    buffer_load_dwordx4 v209, s[48:51], s84 offen offset:0 sc1 lds
    v_accvgpr_write_b32 a11, v229
    v_accvgpr_write_b32 a12, v230
    v_mfma_f32_32x32x16_bf16 a[192:207], v[168:171], v[40:43], a[192:207]
    ds_read_b128 v[164:167], v206 offset:1024
    buffer_load_dwordx4 v209, s[48:51], s84 offen offset:1024 sc1 lds
    v_accvgpr_write_b32 a13, v231
    v_accvgpr_write_b32 a14, v232
    v_accvgpr_write_b32 a15, v233
    v_mfma_f32_32x32x16_bf16 a[144:159], v[172:175], v[44:47], a[144:159]
    ds_read_b128 v[168:171], v206 offset:2048
    v_accvgpr_read_b32 v218, a32
    v_accvgpr_read_b32 v219, a33
    v_accvgpr_read_b32 v220, a34
    v_accvgpr_read_b32 v221, a35
    v_accvgpr_read_b32 v222, a36
    v_mfma_f32_32x32x16_bf16 a[160:175], v[176:179], v[44:47], a[160:175]
    ds_read_b128 v[172:175], v206 offset:3072
    buffer_load_dwordx4 v209, s[48:51], s84 offen offset:2048 sc1 lds
    v_accvgpr_read_b32 v223, a37
    v_accvgpr_read_b32 v224, a38
    v_accvgpr_read_b32 v225, a39
    v_mfma_f32_32x32x16_bf16 a[176:191], v[180:183], v[44:47], a[176:191]
    ds_read_b128 v[176:179], v206 offset:4096
    buffer_load_dwordx4 v209, s[48:51], s84 offen offset:3072 sc1 lds
    s_add_u32 m0, s73, 86016
    s_add_u32 s84, s84, 4096
    v_mul_f32 v218, v218, |v218|
    v_mul_f32 v219, v219, |v219|
    s_waitcnt lgkmcnt(3)
    v_mfma_f32_32x32x16_bf16 a[192:207], v[184:187], v[44:47], a[192:207]
    ds_read_b128 v[180:183], v206 offset:5120
    v_mul_f32 v220, v220, |v220|
    v_mul_f32 v221, v221, |v221|
    v_mul_f32 v222, v222, |v222|
    v_mul_f32 v223, v223, |v223|
    v_mfma_f32_32x32x16_bf16 a[144:159], v[160:163], v[48:51], a[144:159]
    ds_read_b128 v[184:187], v206 offset:6144
    buffer_load_dwordx4 v209, s[48:51], s84 offen offset:0 sc1 lds
    v_mul_f32 v224, v224, |v224|
    v_mul_f32 v225, v225, |v225|
    v_cvt_pk_bf16_f32 v226, v218, v219
    v_cvt_pk_bf16_f32 v227, v220, v221
    v_mfma_f32_32x32x16_bf16 a[160:175], v[164:167], v[48:51], a[160:175]
    ds_read_b128 v[160:163], v206 offset:7168
    v_cvt_pk_bf16_f32 v228, v222, v223
    v_cvt_pk_bf16_f32 v229, v224, v225
    v_pk_max_i16 v226, v226, 0
    v_pk_max_i16 v227, v227, 0
    s_waitcnt lgkmcnt(3)
    v_mfma_f32_32x32x16_bf16 a[176:191], v[168:171], v[48:51], a[176:191]
    ds_read_b128 v[164:167], v206 offset:8192
    buffer_load_dwordx4 v209, s[48:51], s84 offen offset:1024 sc1 lds
    v_pk_max_i16 v228, v228, 0
    v_pk_max_i16 v229, v229, 0
    v_accvgpr_read_b32 v218, a40
    v_accvgpr_read_b32 v219, a41
    v_mfma_f32_32x32x16_bf16 a[192:207], v[172:175], v[48:51], a[192:207]
    ds_read_b128 v[168:171], v206 offset:9216
    buffer_load_dwordx4 v209, s[48:51], s84 offen offset:2048 sc1 lds
    v_accvgpr_read_b32 v220, a42
    v_accvgpr_read_b32 v221, a43
    v_accvgpr_read_b32 v222, a44
    v_mfma_f32_32x32x16_bf16 a[144:159], v[176:179], v[52:55], a[144:159]
    ds_read_b128 v[172:175], v206 offset:10240
    v_accvgpr_read_b32 v223, a45
    v_accvgpr_read_b32 v224, a46
    v_accvgpr_read_b32 v225, a47
    v_mul_f32 v218, v218, |v218|
    v_mul_f32 v219, v219, |v219|
    s_waitcnt lgkmcnt(3)
    v_mfma_f32_32x32x16_bf16 a[160:175], v[180:183], v[52:55], a[160:175]
    ds_read_b128 v[176:179], v206 offset:11264
    buffer_load_dwordx4 v209, s[48:51], s84 offen offset:3072 sc1 lds
    v_mul_f32 v220, v220, |v220|
    v_mul_f32 v221, v221, |v221|
    v_mul_f32 v222, v222, |v222|
    v_mfma_f32_32x32x16_bf16 a[176:191], v[184:187], v[52:55], a[176:191]
    ds_read_b128 v[180:183], v206 offset:12288
    v_mul_f32 v223, v223, |v223|
    v_mul_f32 v224, v224, |v224|
    v_mul_f32 v225, v225, |v225|
    v_cvt_pk_bf16_f32 v230, v218, v219
    v_cvt_pk_bf16_f32 v231, v220, v221
    v_mfma_f32_32x32x16_bf16 a[192:207], v[160:163], v[52:55], a[192:207]
    ds_read_b128 v[184:187], v206 offset:13312
    v_cvt_pk_bf16_f32 v232, v222, v223
    v_cvt_pk_bf16_f32 v233, v224, v225
    v_pk_max_i16 v230, v230, 0
    v_pk_max_i16 v231, v231, 0
    s_waitcnt lgkmcnt(3)
    v_mfma_f32_32x32x16_bf16 a[144:159], v[164:167], v[56:59], a[144:159]
    ds_read_b128 v[160:163], v206 offset:14336
    v_pk_max_i16 v232, v232, 0
    v_pk_max_i16 v233, v233, 0
    s_add_u32 s94, s14, 4096
    v_mfma_f32_32x32x16_bf16 a[160:175], v[168:171], v[56:59], a[160:175]
    ds_read_b128 v[164:167], v206 offset:15360
    buffer_store_dwordx4 v[226:229], v209, s[48:51], s94 offen sc1
    buffer_store_dwordx4 v[230:233], v209, s[48:51], s94 offen offset:1024 sc1
    v_accvgpr_write_b32 a16, v226
    v_accvgpr_write_b32 a17, v227
    v_accvgpr_write_b32 a18, v228
    v_mfma_f32_32x32x16_bf16 a[176:191], v[172:175], v[56:59], a[176:191]
    ds_read_b128 v[168:171], v206 offset:16384
    v_accvgpr_write_b32 a19, v229
    v_accvgpr_write_b32 a20, v230
    v_accvgpr_write_b32 a21, v231
    v_accvgpr_write_b32 a22, v232
    v_accvgpr_write_b32 a23, v233
    s_waitcnt lgkmcnt(3)
    v_mfma_f32_32x32x16_bf16 a[192:207], v[176:179], v[56:59], a[192:207]
    ds_read_b128 v[172:175], v206 offset:17408
    v_mfma_f32_32x32x16_bf16 a[144:159], v[180:183], v[60:63], a[144:159]
    ds_read_b128 v[176:179], v206 offset:18432
    v_accvgpr_read_b32 v218, a48
    v_accvgpr_read_b32 v219, a49
    v_accvgpr_read_b32 v220, a50
    v_accvgpr_read_b32 v221, a51
    v_accvgpr_read_b32 v222, a52
    v_mfma_f32_32x32x16_bf16 a[160:175], v[184:187], v[60:63], a[160:175]
    ds_read_b128 v[180:183], v206 offset:19456
    v_accvgpr_read_b32 v223, a53
    v_accvgpr_read_b32 v224, a54
    v_accvgpr_read_b32 v225, a55
    v_mul_f32 v218, v218, |v218|
    v_mul_f32 v219, v219, |v219|
    s_waitcnt lgkmcnt(3)
    v_mfma_f32_32x32x16_bf16 a[176:191], v[160:163], v[60:63], a[176:191]
    ds_read_b128 v[184:187], v206 offset:20480
    v_mul_f32 v220, v220, |v220|
    v_mul_f32 v221, v221, |v221|
    v_mul_f32 v222, v222, |v222|
    v_mul_f32 v223, v223, |v223|
    v_mfma_f32_32x32x16_bf16 a[192:207], v[164:167], v[60:63], a[192:207]
    ds_read_b128 v[160:163], v206 offset:21504
    v_mul_f32 v224, v224, |v224|
    v_mul_f32 v225, v225, |v225|
    v_cvt_pk_bf16_f32 v226, v218, v219
    v_cvt_pk_bf16_f32 v227, v220, v221
    v_cvt_pk_bf16_f32 v228, v222, v223
    v_mfma_f32_32x32x16_bf16 a[144:159], v[168:171], v[64:67], a[144:159]
    ds_read_b128 v[164:167], v206 offset:22528
    v_cvt_pk_bf16_f32 v229, v224, v225
    v_pk_max_i16 v226, v226, 0
    v_pk_max_i16 v227, v227, 0
    v_pk_max_i16 v228, v228, 0
    s_waitcnt lgkmcnt(3)
    v_mfma_f32_32x32x16_bf16 a[160:175], v[172:175], v[64:67], a[160:175]
    ds_read_b128 v[168:171], v206 offset:23552
    v_pk_max_i16 v229, v229, 0
    v_accvgpr_read_b32 v218, a56
    v_accvgpr_read_b32 v219, a57
    v_accvgpr_read_b32 v220, a58
    v_accvgpr_read_b32 v221, a59
    v_mfma_f32_32x32x16_bf16 a[176:191], v[176:179], v[64:67], a[176:191]
    ds_read_b128 v[172:175], v206 offset:24576
    v_accvgpr_read_b32 v222, a60
    v_accvgpr_read_b32 v223, a61
    v_accvgpr_read_b32 v224, a62
    v_accvgpr_read_b32 v225, a63
    v_mfma_f32_32x32x16_bf16 a[192:207], v[180:183], v[64:67], a[192:207]
    ds_read_b128 v[176:179], v206 offset:25600
    v_mul_f32 v218, v218, |v218|
    v_mul_f32 v219, v219, |v219|
    v_mul_f32 v220, v220, |v220|
    v_mul_f32 v221, v221, |v221|
    v_mul_f32 v222, v222, |v222|
    s_waitcnt lgkmcnt(3)
    v_mfma_f32_32x32x16_bf16 a[144:159], v[184:187], v[68:71], a[144:159]
    ds_read_b128 v[180:183], v206 offset:26624
    v_mul_f32 v223, v223, |v223|
    v_mul_f32 v224, v224, |v224|
    v_mul_f32 v225, v225, |v225|
    v_cvt_pk_bf16_f32 v230, v218, v219
    v_mfma_f32_32x32x16_bf16 a[160:175], v[160:163], v[68:71], a[160:175]
    ds_read_b128 v[184:187], v206 offset:27648
    v_cvt_pk_bf16_f32 v231, v220, v221
    v_cvt_pk_bf16_f32 v232, v222, v223
    v_cvt_pk_bf16_f32 v233, v224, v225
    v_pk_max_i16 v230, v230, 0
    v_pk_max_i16 v231, v231, 0
    v_mfma_f32_32x32x16_bf16 a[176:191], v[164:167], v[68:71], a[176:191]
    ds_read_b128 v[160:163], v206 offset:28672
    v_pk_max_i16 v232, v232, 0
    v_pk_max_i16 v233, v233, 0
    s_add_u32 s94, s14, 6144
    s_waitcnt lgkmcnt(3)
    v_mfma_f32_32x32x16_bf16 a[192:207], v[168:171], v[68:71], a[192:207]
    ds_read_b128 v[164:167], v206 offset:29696
    buffer_store_dwordx4 v[226:229], v209, s[48:51], s94 offen sc1
    buffer_store_dwordx4 v[230:233], v209, s[48:51], s94 offen offset:1024 sc1
    v_accvgpr_write_b32 a24, v226
    v_accvgpr_write_b32 a25, v227
    v_accvgpr_write_b32 a26, v228
    v_mfma_f32_32x32x16_bf16 a[144:159], v[172:175], v[72:75], a[144:159]
    ds_read_b128 v[168:171], v206 offset:30720
    v_accvgpr_write_b32 a27, v229
    v_accvgpr_write_b32 a28, v230
    v_accvgpr_write_b32 a29, v231
    v_accvgpr_write_b32 a30, v232
    v_accvgpr_write_b32 a31, v233
    v_mfma_f32_32x32x16_bf16 a[160:175], v[176:179], v[72:75], a[160:175]
    ds_read_b128 v[172:175], v206 offset:31744
    s_waitcnt lgkmcnt(3)
    v_mfma_f32_32x32x16_bf16 a[176:191], v[180:183], v[72:75], a[176:191]
    s_waitcnt vmcnt(14)
    s_waitcnt lgkmcnt(0)
    s_barrier
    v_add_u32 v206, 40960, v209
    ds_read_b128 v[176:179], v206 offset:0
    s_lshr_b32 s85, s73, 1
    s_mov_b32 s84, s21
    s_add_u32 m0, s85, 0
    s_nop 0
    buffer_load_dwordx4 v209, s[48:51], s84 offen offset:0 sc1 lds
    buffer_load_dwordx4 v209, s[48:51], s84 offen offset:1024 sc1 lds
    v_mfma_f32_32x32x16_bf16 a[192:207], v[184:187], v[72:75], a[192:207]
    ds_read_b128 v[180:183], v206 offset:1024
    buffer_load_dwordx4 v209, s[48:51], s84 offen offset:2048 sc1 lds
    s_lshl_b32 s90, s11, 3
    s_add_u32 s90, s90, 0
    s_cmp_lt_u32 s71, 164
    s_cselect_b32 s90, s90, 0x40000000
    v_mfma_f32_32x32x16_bf16 a[144:159], v[160:163], v[76:79], a[144:159]
    ds_read_b128 v[184:187], v206 offset:2048
    s_cmp_eq_u32 s4, 0
    s_cselect_b32 s90, s90, 0x40000000
    buffer_store_dwordx2 v[12:13], v207, s[48:51], s90 offen offset:0 sc1
    v_accvgpr_read_b32 v218, a64
    v_mfma_f32_32x32x16_bf16 a[160:175], v[164:167], v[76:79], a[160:175]
    ds_read_b128 v[160:163], v206 offset:3072
    buffer_load_dwordx4 v209, s[48:51], s84 offen offset:3072 sc1 lds
    s_lshl_b32 s98, s8, 12
    s_add_u32 s98, s98, 786432
    s_lshl_b32 s85, s4, 10
    s_add_u32 s84, s98, s85
    v_mfma_f32_32x32x16_bf16 a[176:191], v[168:171], v[76:79], a[176:191]
    ds_read_b128 v[164:167], v206 offset:4096
    s_add_u32 m0, s85, 16384
    s_nop 0
    buffer_load_dwordx4 v209, s[48:51], s84 offen offset:0 sc1 lds
    v_accvgpr_read_b32 v219, a65
    v_accvgpr_read_b32 v220, a66
    v_mfma_f32_32x32x16_bf16 a[192:207], v[172:175], v[76:79], a[192:207]
    ds_read_b128 v[168:171], v206 offset:5120
    v_accvgpr_read_b32 v221, a67
    v_accvgpr_read_b32 v222, a68
    v_accvgpr_read_b32 v223, a69
    v_accvgpr_read_b32 v224, a70
    v_accvgpr_read_b32 v225, a71
    s_waitcnt lgkmcnt(3)
    v_mfma_f32_32x32x16_bf16 a[144:159], v[176:179], v[80:83], a[144:159]
    ds_read_b128 v[172:175], v206 offset:6144
    v_mul_f32 v218, v218, |v218|
    v_mul_f32 v219, v219, |v219|
    v_mul_f32 v220, v220, |v220|
    v_mul_f32 v221, v221, |v221|
    v_mfma_f32_32x32x16_bf16 a[160:175], v[180:183], v[80:83], a[160:175]
    ds_read_b128 v[176:179], v206 offset:7168
    v_mul_f32 v222, v222, |v222|
    v_mul_f32 v223, v223, |v223|
    v_mul_f32 v224, v224, |v224|
    v_mul_f32 v225, v225, |v225|
    v_cvt_pk_bf16_f32 v226, v218, v219
    v_mfma_f32_32x32x16_bf16 a[176:191], v[184:187], v[80:83], a[176:191]
    ds_read_b128 v[180:183], v206 offset:8192
    v_cvt_pk_bf16_f32 v227, v220, v221
    v_cvt_pk_bf16_f32 v228, v222, v223
    v_cvt_pk_bf16_f32 v229, v224, v225
    v_pk_max_i16 v226, v226, 0
    s_waitcnt lgkmcnt(3)
    v_mfma_f32_32x32x16_bf16 a[192:207], v[160:163], v[80:83], a[192:207]
    ds_read_b128 v[184:187], v206 offset:9216
    v_pk_max_i16 v227, v227, 0
    v_pk_max_i16 v228, v228, 0
    v_pk_max_i16 v229, v229, 0
    v_accvgpr_read_b32 v218, a72
    v_accvgpr_read_b32 v219, a73
    v_mfma_f32_32x32x16_bf16 a[144:159], v[164:167], v[84:87], a[144:159]
    ds_read_b128 v[160:163], v206 offset:10240
    v_accvgpr_read_b32 v220, a74
    v_accvgpr_read_b32 v221, a75
    v_accvgpr_read_b32 v222, a76
    v_accvgpr_read_b32 v223, a77
    v_mfma_f32_32x32x16_bf16 a[160:175], v[168:171], v[84:87], a[160:175]
    ds_read_b128 v[164:167], v206 offset:11264
    v_accvgpr_read_b32 v224, a78
    v_accvgpr_read_b32 v225, a79
    v_mul_f32 v218, v218, |v218|
    v_mul_f32 v219, v219, |v219|
    v_mul_f32 v220, v220, |v220|
    s_waitcnt lgkmcnt(3)
    v_mfma_f32_32x32x16_bf16 a[176:191], v[172:175], v[84:87], a[176:191]
    ds_read_b128 v[168:171], v206 offset:12288
    v_mul_f32 v221, v221, |v221|
    v_mul_f32 v222, v222, |v222|
    v_mul_f32 v223, v223, |v223|
    v_mul_f32 v224, v224, |v224|
    v_mfma_f32_32x32x16_bf16 a[192:207], v[176:179], v[84:87], a[192:207]
    ds_read_b128 v[172:175], v206 offset:13312
    v_mul_f32 v225, v225, |v225|
    v_cvt_pk_bf16_f32 v230, v218, v219
    v_cvt_pk_bf16_f32 v231, v220, v221
    v_cvt_pk_bf16_f32 v232, v222, v223
    v_cvt_pk_bf16_f32 v233, v224, v225
    v_mfma_f32_32x32x16_bf16 a[144:159], v[180:183], v[88:91], a[144:159]
    ds_read_b128 v[176:179], v206 offset:14336
    v_pk_max_i16 v230, v230, 0
    v_pk_max_i16 v231, v231, 0
    v_pk_max_i16 v232, v232, 0
    v_pk_max_i16 v233, v233, 0
    s_waitcnt lgkmcnt(3)
    v_mfma_f32_32x32x16_bf16 a[160:175], v[184:187], v[88:91], a[160:175]
    ds_read_b128 v[180:183], v206 offset:15360
    s_add_u32 s94, s14, 8192
    buffer_store_dwordx4 v[226:229], v209, s[48:51], s94 offen sc1
    buffer_store_dwordx4 v[230:233], v209, s[48:51], s94 offen offset:1024 sc1
    v_accvgpr_write_b32 a32, v226
    v_accvgpr_write_b32 a33, v227
    v_mfma_f32_32x32x16_bf16 a[176:191], v[160:163], v[88:91], a[176:191]
    ds_read_b128 v[184:187], v206 offset:16384
    v_accvgpr_write_b32 a34, v228
    v_accvgpr_write_b32 a35, v229
    v_accvgpr_write_b32 a36, v230
    v_accvgpr_write_b32 a37, v231
    v_mfma_f32_32x32x16_bf16 a[192:207], v[164:167], v[88:91], a[192:207]
    ds_read_b128 v[160:163], v206 offset:17408
    v_accvgpr_write_b32 a38, v232
    v_accvgpr_write_b32 a39, v233
    s_waitcnt lgkmcnt(3)
    v_mfma_f32_32x32x16_bf16 a[144:159], v[168:171], v[92:95], a[144:159]
    ds_read_b128 v[164:167], v206 offset:18432
    v_mfma_f32_32x32x16_bf16 a[160:175], v[172:175], v[92:95], a[160:175]
    ds_read_b128 v[168:171], v206 offset:19456
    v_mfma_f32_32x32x16_bf16 a[176:191], v[176:179], v[92:95], a[176:191]
    ds_read_b128 v[172:175], v206 offset:20480
    s_waitcnt lgkmcnt(3)
    v_mfma_f32_32x32x16_bf16 a[192:207], v[180:183], v[92:95], a[192:207]
    ds_read_b128 v[176:179], v206 offset:21504
    v_mfma_f32_32x32x16_bf16 a[144:159], v[184:187], v[96:99], a[144:159]
    ds_read_b128 v[180:183], v206 offset:22528
    v_mfma_f32_32x32x16_bf16 a[160:175], v[160:163], v[96:99], a[160:175]
    ds_read_b128 v[184:187], v206 offset:23552
    s_waitcnt lgkmcnt(3)
    v_mfma_f32_32x32x16_bf16 a[176:191], v[164:167], v[96:99], a[176:191]
    ds_read_b128 v[160:163], v206 offset:24576
    v_mfma_f32_32x32x16_bf16 a[192:207], v[168:171], v[96:99], a[192:207]
    ds_read_b128 v[164:167], v206 offset:25600
    v_mfma_f32_32x32x16_bf16 a[144:159], v[172:175], v[100:103], a[144:159]
    ds_read_b128 v[168:171], v206 offset:26624
    s_waitcnt lgkmcnt(3)
    v_mfma_f32_32x32x16_bf16 a[160:175], v[176:179], v[100:103], a[160:175]
    ds_read_b128 v[172:175], v206 offset:27648
    v_mfma_f32_32x32x16_bf16 a[176:191], v[180:183], v[100:103], a[176:191]
    ds_read_b128 v[176:179], v206 offset:28672
    v_mfma_f32_32x32x16_bf16 a[192:207], v[184:187], v[100:103], a[192:207]
    ds_read_b128 v[180:183], v206 offset:29696
    s_waitcnt lgkmcnt(3)
    v_mfma_f32_32x32x16_bf16 a[144:159], v[160:163], v[104:107], a[144:159]
    ds_read_b128 v[184:187], v206 offset:30720
    v_mfma_f32_32x32x16_bf16 a[160:175], v[164:167], v[104:107], a[160:175]
    ds_read_b128 v[160:163], v206 offset:31744
    v_mfma_f32_32x32x16_bf16 a[176:191], v[168:171], v[104:107], a[176:191]
    s_waitcnt vmcnt(12)
    s_waitcnt lgkmcnt(0)
    s_barrier
    v_add_u32 v206, 81920, v209
    ds_read_b128 v[164:167], v206 offset:0
    s_add_u32 s84, s18, 0
    s_add_u32 m0, s73, 40960
    s_nop 0
    buffer_load_dwordx4 v201, s[44:47], s84 offen offset:0 lds
    buffer_load_dwordx4 v202, s[44:47], s84 offen offset:1024 lds
    v_and_b32 v234, 31, v1
    v_mfma_f32_32x32x16_bf16 a[192:207], v[172:175], v[104:107], a[192:207]
    ds_read_b128 v[168:171], v206 offset:1024
    buffer_load_dwordx4 v203, s[44:47], s84 offen offset:2048 lds
    s_lshl_b32 s86, s4, 5
    v_add_u32 v235, s86, v234
    v_mul_u32_u24 v235, 240, v235
    v_lshrrev_b32 v236, 5, v1
    v_mfma_f32_32x32x16_bf16 a[144:159], v[176:179], v[108:111], a[144:159]
    ds_read_b128 v[172:175], v206 offset:2048
    buffer_load_dwordx4 v204, s[44:47], s84 offen offset:3072 lds
    s_add_u32 s84, s84, 147456
    s_add_u32 m0, s73, 45056
    v_lshl_add_u32 v235, v236, 4, v235
    v_mfma_f32_32x32x16_bf16 a[160:175], v[180:183], v[108:111], a[160:175]
    ds_read_b128 v[176:179], v206 offset:3072
    v_add_u32 v2, 126976, v235
    v_subrev_u32 v3, 26880, v235
    s_lshl_b32 s86, s5, 4
    s_add_u32 s86, s86, s8
    s_add_u32 s86, s86, 16
    s_waitcnt lgkmcnt(3)
    v_mfma_f32_32x32x16_bf16 a[176:191], v[184:187], v[108:111], a[176:191]
    ds_read_b128 v[180:183], v206 offset:4096
    buffer_load_dwordx4 v201, s[44:47], s84 offen offset:0 lds
    s_lshl_b32 s87, s86, 12
    s_add_u32 s87, s87, 31981568
    s_cmp_eq_u32 s5, 15
    s_cselect_b32 s87, 0x40000000, s87
    v_mfma_f32_32x32x16_bf16 a[192:207], v[160:163], v[108:111], a[192:207]
    ds_read_b128 v[184:187], v206 offset:5120
    buffer_load_dwordx4 v202, s[44:47], s84 offen offset:1024 lds
    v_mov_b32 v236, 0x40000000
    v_cmp_gt_u32 vcc, 26880, v235
    s_nop 1
    v_cndmask_b32 v3, v3, v236, vcc
    v_mfma_f32_32x32x16_bf16 a[144:159], v[164:167], v[112:115], a[144:159]
    ds_read_b128 v[160:163], v206 offset:6144
    s_waitcnt lgkmcnt(3)
    v_mfma_f32_32x32x16_bf16 a[160:175], v[168:171], v[112:115], a[160:175]
    ds_read_b128 v[164:167], v206 offset:7168
    buffer_load_dwordx4 v203, s[44:47], s84 offen offset:2048 lds
    v_mfma_f32_32x32x16_bf16 a[176:191], v[172:175], v[112:115], a[176:191]
    ds_read_b128 v[168:171], v206 offset:8192
    v_mfma_f32_32x32x16_bf16 a[192:207], v[176:179], v[112:115], a[192:207]
    ds_read_b128 v[172:175], v206 offset:9216
    buffer_load_dwordx4 v204, s[44:47], s84 offen offset:3072 lds
    s_lshl_b32 s85, s4, 10
    s_add_u32 s84, s13, s85
    s_add_u32 m0, s85, 73728
    s_waitcnt lgkmcnt(3)
    v_mfma_f32_32x32x16_bf16 a[144:159], v[180:183], v[116:119], a[144:159]
    ds_read_b128 v[176:179], v206 offset:10240
    buffer_load_dwordx4 v209, s[48:51], s84 offen offset:0 sc1 lds
    v_mfma_f32_32x32x16_bf16 a[160:175], v[184:187], v[116:119], a[160:175]
    ds_read_b128 v[180:183], v206 offset:11264
    v_mfma_f32_32x32x16_bf16 a[176:191], v[160:163], v[116:119], a[176:191]
    ds_read_b128 v[184:187], v206 offset:12288
    s_waitcnt lgkmcnt(3)
    v_mfma_f32_32x32x16_bf16 a[192:207], v[164:167], v[116:119], a[192:207]
    ds_read_b128 v[160:163], v206 offset:13312
    v_mfma_f32_32x32x16_bf16 a[144:159], v[168:171], v[120:123], a[144:159]
    ds_read_b128 v[164:167], v206 offset:14336
    v_mfma_f32_32x32x16_bf16 a[160:175], v[172:175], v[120:123], a[160:175]
    ds_read_b128 v[168:171], v206 offset:15360
    s_waitcnt lgkmcnt(3)
    v_mfma_f32_32x32x16_bf16 a[176:191], v[176:179], v[120:123], a[176:191]
    ds_read_b128 v[172:175], v206 offset:16384
    v_mfma_f32_32x32x16_bf16 a[192:207], v[180:183], v[120:123], a[192:207]
    ds_read_b128 v[176:179], v206 offset:17408
    v_mfma_f32_32x32x16_bf16 a[144:159], v[184:187], v[124:127], a[144:159]
    ds_read_b128 v[180:183], v206 offset:18432
    s_waitcnt lgkmcnt(3)
    v_mfma_f32_32x32x16_bf16 a[160:175], v[160:163], v[124:127], a[160:175]
    ds_read_b128 v[184:187], v206 offset:19456
    v_mfma_f32_32x32x16_bf16 a[176:191], v[164:167], v[124:127], a[176:191]
    ds_read_b128 v[160:163], v206 offset:20480
    s_lshl_b32 s94, s7, 3
    s_add_u32 s94, s94, s10
    s_waitcnt vmcnt(9)
    buffer_store_dwordx2 v[12:13], v207, s[48:51], s94 offen offset:0 sc1
    v_mfma_f32_32x32x16_bf16 a[192:207], v[168:171], v[124:127], a[192:207]
    ds_read_b128 v[164:167], v206 offset:21504
    s_waitcnt lgkmcnt(3)
    v_mfma_f32_32x32x16_bf16 a[144:159], v[172:175], v[128:131], a[144:159]
    ds_read_b128 v[168:171], v206 offset:22528
    v_mfma_f32_32x32x16_bf16 a[160:175], v[176:179], v[128:131], a[160:175]
    ds_read_b128 v[172:175], v206 offset:23552
    v_mfma_f32_32x32x16_bf16 a[176:191], v[180:183], v[128:131], a[176:191]
    ds_read_b128 v[176:179], v206 offset:24576
    s_waitcnt lgkmcnt(3)
    v_mfma_f32_32x32x16_bf16 a[192:207], v[184:187], v[128:131], a[192:207]
    ds_read_b128 v[180:183], v206 offset:25600
    v_mfma_f32_32x32x16_bf16 a[144:159], v[160:163], v[132:135], a[144:159]
    ds_read_b128 v[184:187], v206 offset:26624
    v_mfma_f32_32x32x16_bf16 a[160:175], v[164:167], v[132:135], a[160:175]
    ds_read_b128 v[160:163], v206 offset:27648
    s_waitcnt lgkmcnt(3)
    v_mfma_f32_32x32x16_bf16 a[176:191], v[168:171], v[132:135], a[176:191]
    ds_read_b128 v[164:167], v206 offset:28672
    v_mfma_f32_32x32x16_bf16 a[192:207], v[172:175], v[132:135], a[192:207]
    ds_read_b128 v[168:171], v206 offset:29696
    v_mfma_f32_32x32x16_bf16 a[144:159], v[176:179], v[136:139], a[144:159]
    ds_read_b128 v[172:175], v206 offset:30720
    s_waitcnt lgkmcnt(3)
    v_mfma_f32_32x32x16_bf16 a[160:175], v[180:183], v[136:139], a[160:175]
    ds_read_b128 v[176:179], v206 offset:31744
    v_mfma_f32_32x32x16_bf16 a[176:191], v[184:187], v[136:139], a[176:191]
    s_waitcnt lgkmcnt(0)
    s_barrier
    v_add_u32 v206, 0, v209
    ds_read_b128 v[180:183], v206 offset:0
    s_add_u32 s84, s18, 1179648
    s_add_u32 m0, s73, 81920
    s_nop 0
    buffer_load_dwordx4 v201, s[44:47], s84 offen offset:0 lds
    buffer_load_dwordx4 v202, s[44:47], s84 offen offset:1024 lds
    v_mfma_f32_32x32x16_bf16 a[192:207], v[160:163], v[136:139], a[192:207]
    ds_read_b128 v[184:187], v206 offset:1024
    buffer_load_dwordx4 v203, s[44:47], s84 offen offset:2048 lds
    v_mfma_f32_32x32x16_bf16 a[144:159], v[164:167], v[140:143], a[144:159]
    ds_read_b128 v[160:163], v206 offset:2048
    buffer_load_dwordx4 v204, s[44:47], s84 offen offset:3072 lds
    s_add_u32 s84, s84, 147456
    s_add_u32 m0, s73, 86016
    v_mfma_f32_32x32x16_bf16 a[160:175], v[168:171], v[140:143], a[160:175]
    ds_read_b128 v[164:167], v206 offset:3072
    v_mfma_f32_32x32x16_bf16 a[176:191], v[172:175], v[140:143], a[176:191]
    ds_read_b128 v[168:171], v206 offset:4096
    buffer_load_dwordx4 v201, s[44:47], s84 offen offset:0 lds
    s_waitcnt lgkmcnt(3)
    v_mfma_f32_32x32x16_bf16 a[192:207], v[176:179], v[140:143], a[192:207]
    ds_read_b128 v[172:175], v206 offset:5120
    buffer_load_dwordx4 v202, s[44:47], s84 offen offset:1024 lds
    v_mfma_f32_32x32x16_bf16 a[144:159], v[180:183], v[144:147], a[144:159]
    ds_read_b128 v[176:179], v206 offset:6144
    v_mfma_f32_32x32x16_bf16 a[160:175], v[184:187], v[144:147], a[160:175]
    ds_read_b128 v[180:183], v206 offset:7168
    buffer_load_dwordx4 v203, s[44:47], s84 offen offset:2048 lds
    s_waitcnt lgkmcnt(3)
    v_mfma_f32_32x32x16_bf16 a[176:191], v[160:163], v[144:147], a[176:191]
    ds_read_b128 v[184:187], v206 offset:8192
    v_mfma_f32_32x32x16_bf16 a[192:207], v[164:167], v[144:147], a[192:207]
    ds_read_b128 v[160:163], v206 offset:9216
    buffer_load_dwordx4 v204, s[44:47], s84 offen offset:3072 lds
    v_mfma_f32_32x32x16_bf16 a[144:159], v[168:171], v[148:151], a[144:159]
    ds_read_b128 v[164:167], v206 offset:10240
    s_waitcnt lgkmcnt(3)
    v_mfma_f32_32x32x16_bf16 a[160:175], v[172:175], v[148:151], a[160:175]
    ds_read_b128 v[168:171], v206 offset:11264
    v_mfma_f32_32x32x16_bf16 a[176:191], v[176:179], v[148:151], a[176:191]
    ds_read_b128 v[172:175], v206 offset:12288
    v_mfma_f32_32x32x16_bf16 a[192:207], v[180:183], v[148:151], a[192:207]
    ds_read_b128 v[176:179], v206 offset:13312
    s_waitcnt lgkmcnt(3)
    v_mfma_f32_32x32x16_bf16 a[144:159], v[184:187], v[152:155], a[144:159]
    ds_read_b128 v[180:183], v206 offset:14336
    v_mfma_f32_32x32x16_bf16 a[160:175], v[160:163], v[152:155], a[160:175]
    ds_read_b128 v[184:187], v206 offset:15360
    v_mfma_f32_32x32x16_bf16 a[176:191], v[164:167], v[152:155], a[176:191]
    ds_read_b128 v[160:163], v206 offset:17408
    s_waitcnt lgkmcnt(3)
    v_mfma_f32_32x32x16_bf16 a[192:207], v[168:171], v[152:155], a[192:207]
    ds_read_b128 v[164:167], v206 offset:18432
    v_mfma_f32_32x32x16_bf16 a[144:159], v[172:175], v[156:159], a[144:159]
    ds_read_b128 v[168:171], v206 offset:19456
    v_mfma_f32_32x32x16_bf16 a[160:175], v[176:179], v[156:159], a[160:175]
    ds_read_b128 v[172:175], v206 offset:16384
    s_waitcnt lgkmcnt(3)
    v_mfma_f32_32x32x16_bf16 a[176:191], v[180:183], v[156:159], a[176:191]
    s_waitcnt vmcnt(9)
    s_waitcnt lgkmcnt(0)
    s_barrier
    v_add_u32 v206, 40960, v209
    ds_read_b128 v[176:179], v206 offset:32768
    s_add_u32 s84, s18, 2359296
    s_add_u32 m0, s73, 0
    s_nop 0
    buffer_load_dwordx4 v201, s[44:47], s84 offen offset:0 lds
    buffer_load_dwordx4 v202, s[44:47], s84 offen offset:1024 lds
    v_lshrrev_b32 v15, 1, v209
    v_mfma_f32_32x32x16_bf16 a[192:207], v[184:187], v[156:159], a[192:207]
    ds_read_b128 v[180:183], v206 offset:33792
    buffer_load_dwordx4 v203, s[44:47], s84 offen offset:2048 lds
    v_min_u32 v15, 320, v15
    s_mul_i32 s92, s6, 328
    s_add_u32 s92, s92, 0
    v_add_u32 v15, s92, v15
    v_mfma_f32_32x32x16_bf16 a[160:175], v[160:163], v[214:217], a[160:175]
    ds_read_b128 v[184:187], v206 offset:34816
    buffer_load_dwordx4 v204, s[44:47], s84 offen offset:3072 lds
    s_add_u32 s84, s84, 147456
    s_add_u32 m0, s73, 4096
    v_and_b32 v8, 3, v1
    v_mfma_f32_32x32x16_bf16 a[176:191], v[164:167], v[214:217], a[176:191]
    ds_read_b128 v[160:163], v206 offset:35840
    v_lshlrev_b32 v8, 3, v8
    v_add_u32 v8, s10, v8
    v_cmp_gt_u32 vcc, 48, v1
    s_nop 1
    v_cndmask_b32 v15, v8, v15, vcc
    v_mfma_f32_32x32x16_bf16 a[192:207], v[168:171], v[214:217], a[192:207]
    ds_read_b64_tr_b16 v[164:165], v4 offset:0
    ds_read_b64_tr_b16 v[166:167], v4 offset:1024
    buffer_load_dwordx2 v[8:9], v15, s[48:51], 0 offen sc1
    buffer_load_dwordx4 v201, s[44:47], s84 offen offset:0 lds
    v_mfma_f32_32x32x16_bf16 a[144:159], v[172:175], v[214:217], a[144:159]
    ds_read_b64_tr_b16 v[168:169], v5 offset:0
    ds_read_b64_tr_b16 v[170:171], v5 offset:1024
    v_accvgpr_read_b32 v234, a160
    v_accvgpr_read_b32 v235, a161
    v_accvgpr_read_b32 v236, a162
    v_accvgpr_read_b32 v237, a163
    v_accvgpr_read_b32 v238, a164
    s_waitcnt lgkmcnt(5)
    v_mfma_f32_32x32x16_bf16 a[80:95], v[176:179], v[214:217], 0
    ds_read_b64_tr_b16 v[172:173], v6 offset:0
    ds_read_b64_tr_b16 v[174:175], v6 offset:1024
    buffer_load_dwordx4 v202, s[44:47], s84 offen offset:1024 lds
    v_accvgpr_read_b32 v239, a165
    v_accvgpr_read_b32 v240, a166
    v_accvgpr_read_b32 v241, a167
    v_mul_f32 v234, v234, v211
    v_mfma_f32_32x32x16_bf16 a[96:111], v[180:183], v[214:217], 0
    ds_read_b64_tr_b16 v[176:177], v7 offset:0
    ds_read_b64_tr_b16 v[178:179], v7 offset:1024
    buffer_load_dwordx4 v203, s[44:47], s84 offen offset:2048 lds
    v_mul_f32 v235, v235, v211
    v_mul_f32 v236, v236, v211
    v_mul_f32 v237, v237, v211
    v_mfma_f32_32x32x16_bf16 a[112:127], v[184:187], v[214:217], 0
    ds_read_b64_tr_b16 v[180:181], v4 offset:2048
    ds_read_b64_tr_b16 v[182:183], v4 offset:3072
    v_mul_f32 v238, v238, v211
    v_mul_f32 v239, v239, v211
    v_mul_f32 v240, v240, v211
    v_mul_f32 v241, v241, v211
    v_cvt_pk_bf16_f32 v242, v234, v235
    s_waitcnt lgkmcnt(6)
    v_mfma_f32_32x32x16_bf16 a[128:143], v[160:163], v[214:217], 0
    ds_read_b64_tr_b16 v[184:185], v5 offset:2048
    ds_read_b64_tr_b16 v[186:187], v5 offset:3072
    buffer_load_dwordx4 v204, s[44:47], s84 offen offset:3072 lds
    v_cvt_pk_bf16_f32 v243, v236, v237
    v_cvt_pk_bf16_f32 v244, v238, v239
    v_cvt_pk_bf16_f32 v245, v240, v241
    v_mfma_f32_32x32x16_bf16 a[80:95], v[164:167], v[16:19], a[80:95]
    ds_read_b64_tr_b16 v[160:161], v6 offset:2048
    ds_read_b64_tr_b16 v[162:163], v6 offset:3072
    buffer_store_dwordx4 v[242:245], v3, s[48:51], s87 offen offset:64 sc1
    ds_write_b128 v2, v[242:245] offset:64
    v_accvgpr_read_b32 v234, a168
    v_accvgpr_read_b32 v235, a169
    v_mfma_f32_32x32x16_bf16 a[96:111], v[168:171], v[16:19], a[96:111]
    ds_read_b64_tr_b16 v[164:165], v7 offset:2048
    ds_read_b64_tr_b16 v[166:167], v7 offset:3072
    v_accvgpr_read_b32 v236, a170
    v_accvgpr_read_b32 v237, a171
    v_accvgpr_read_b32 v238, a172
    v_accvgpr_read_b32 v239, a173
    s_waitcnt lgkmcnt(7)
    v_mfma_f32_32x32x16_bf16 a[112:127], v[172:175], v[16:19], a[112:127]
    ds_read_b64_tr_b16 v[168:169], v4 offset:4096
    ds_read_b64_tr_b16 v[170:171], v4 offset:5120
    v_accvgpr_read_b32 v240, a174
    v_accvgpr_read_b32 v241, a175
    v_mul_f32 v234, v234, v211
    v_mul_f32 v235, v235, v211
    v_mfma_f32_32x32x16_bf16 a[128:143], v[176:179], v[16:19], a[128:143]
    ds_read_b64_tr_b16 v[172:173], v5 offset:4096
    ds_read_b64_tr_b16 v[174:175], v5 offset:5120
    v_mul_f32 v236, v236, v211
    v_mul_f32 v237, v237, v211
    v_mul_f32 v238, v238, v211
    v_mul_f32 v239, v239, v211
    v_mfma_f32_32x32x16_bf16 a[80:95], v[180:183], v[20:23], a[80:95]
    ds_read_b64_tr_b16 v[176:177], v6 offset:4096
    ds_read_b64_tr_b16 v[178:179], v6 offset:5120
    v_mul_f32 v240, v240, v211
    v_mul_f32 v241, v241, v211
    v_cvt_pk_bf16_f32 v246, v234, v235
    v_cvt_pk_bf16_f32 v247, v236, v237
    s_waitcnt lgkmcnt(6)
    v_mfma_f32_32x32x16_bf16 a[96:111], v[184:187], v[20:23], a[96:111]
    ds_read_b64_tr_b16 v[180:181], v7 offset:4096
    ds_read_b64_tr_b16 v[182:183], v7 offset:5120
    v_cvt_pk_bf16_f32 v248, v238, v239
    v_cvt_pk_bf16_f32 v249, v240, v241
    v_mfma_f32_32x32x16_bf16 a[112:127], v[160:163], v[20:23], a[112:127]
    ds_read_b64_tr_b16 v[184:185], v4 offset:6144
    ds_read_b64_tr_b16 v[186:187], v4 offset:7168
    buffer_store_dwordx4 v[246:249], v3, s[48:51], s87 offen offset:96 sc1
    ds_write_b128 v2, v[246:249] offset:96
    v_mfma_f32_32x32x16_bf16 a[128:143], v[164:167], v[20:23], a[128:143]
    ds_read_b64_tr_b16 v[160:161], v5 offset:6144
    ds_read_b64_tr_b16 v[162:163], v5 offset:7168
    s_waitcnt lgkmcnt(7)
    v_mfma_f32_32x32x16_bf16 a[80:95], v[168:171], v[24:27], a[80:95]
    ds_read_b64_tr_b16 v[164:165], v6 offset:6144
    ds_read_b64_tr_b16 v[166:167], v6 offset:7168
    v_accvgpr_read_b32 v234, a176
    v_accvgpr_read_b32 v235, a177
    v_accvgpr_read_b32 v236, a178
    v_accvgpr_read_b32 v237, a179
    v_accvgpr_read_b32 v238, a180
    v_mfma_f32_32x32x16_bf16 a[96:111], v[172:175], v[24:27], a[96:111]
    ds_read_b64_tr_b16 v[168:169], v7 offset:6144
    ds_read_b64_tr_b16 v[170:171], v7 offset:7168
    v_accvgpr_read_b32 v239, a181
    v_accvgpr_read_b32 v240, a182
    v_accvgpr_read_b32 v241, a183
    v_mul_f32 v234, v234, v211
    v_mfma_f32_32x32x16_bf16 a[112:127], v[176:179], v[24:27], a[112:127]
    ds_read_b64_tr_b16 v[172:173], v4 offset:16384
    ds_read_b64_tr_b16 v[174:175], v4 offset:17408
    v_mul_f32 v235, v235, v211
    v_mul_f32 v236, v236, v211
    v_mul_f32 v237, v237, v211
    v_mul_f32 v238, v238, v211
    s_waitcnt lgkmcnt(6)
    v_mfma_f32_32x32x16_bf16 a[128:143], v[180:183], v[24:27], a[128:143]
    ds_read_b64_tr_b16 v[176:177], v5 offset:16384
    ds_read_b64_tr_b16 v[178:179], v5 offset:17408
    v_mul_f32 v239, v239, v211
    v_mul_f32 v240, v240, v211
    v_mul_f32 v241, v241, v211
    v_cvt_pk_bf16_f32 v242, v234, v235
    v_mfma_f32_32x32x16_bf16 a[80:95], v[184:187], v[28:31], a[80:95]
    ds_read_b64_tr_b16 v[180:181], v6 offset:16384
    ds_read_b64_tr_b16 v[182:183], v6 offset:17408
    v_cvt_pk_bf16_f32 v243, v236, v237
    v_cvt_pk_bf16_f32 v244, v238, v239
    v_cvt_pk_bf16_f32 v245, v240, v241
    v_mfma_f32_32x32x16_bf16 a[96:111], v[160:163], v[28:31], a[96:111]
    ds_read_b64_tr_b16 v[184:185], v7 offset:16384
    ds_read_b64_tr_b16 v[186:187], v7 offset:17408
    buffer_store_dwordx4 v[242:245], v3, s[48:51], s87 offen offset:128 sc1
    ds_write_b128 v2, v[242:245] offset:128
    v_accvgpr_read_b32 v234, a184
    v_accvgpr_read_b32 v235, a185
    v_accvgpr_read_b32 v236, a186
    s_waitcnt lgkmcnt(7)
    v_mfma_f32_32x32x16_bf16 a[112:127], v[164:167], v[28:31], a[112:127]
    ds_read_b64_tr_b16 v[160:161], v4 offset:18432
    ds_read_b64_tr_b16 v[162:163], v4 offset:19456
    v_accvgpr_read_b32 v237, a187
    v_accvgpr_read_b32 v238, a188
    v_accvgpr_read_b32 v239, a189
    v_accvgpr_read_b32 v240, a190
    v_mfma_f32_32x32x16_bf16 a[128:143], v[168:171], v[28:31], a[128:143]
    ds_read_b64_tr_b16 v[164:165], v5 offset:18432
    ds_read_b64_tr_b16 v[166:167], v5 offset:19456
    v_accvgpr_read_b32 v241, a191
    v_mul_f32 v234, v234, v211
    v_mul_f32 v235, v235, v211
    v_mul_f32 v236, v236, v211
    v_mfma_f32_32x32x16_bf16 a[80:95], v[172:175], v[32:35], a[80:95]
    ds_read_b64_tr_b16 v[168:169], v6 offset:18432
    ds_read_b64_tr_b16 v[170:171], v6 offset:19456
    v_mul_f32 v237, v237, v211
    v_mul_f32 v238, v238, v211
    v_mul_f32 v239, v239, v211
    v_mul_f32 v240, v240, v211
    s_waitcnt lgkmcnt(7)
    v_mfma_f32_32x32x16_bf16 a[96:111], v[176:179], v[32:35], a[96:111]
    ds_read_b64_tr_b16 v[172:173], v7 offset:18432
    ds_read_b64_tr_b16 v[174:175], v7 offset:19456
    v_mul_f32 v241, v241, v211
    v_cvt_pk_bf16_f32 v246, v234, v235
    v_cvt_pk_bf16_f32 v247, v236, v237
    v_cvt_pk_bf16_f32 v248, v238, v239
    v_mfma_f32_32x32x16_bf16 a[112:127], v[180:183], v[32:35], a[112:127]
    ds_read_b64_tr_b16 v[176:177], v4 offset:20480
    ds_read_b64_tr_b16 v[178:179], v4 offset:21504
    s_waitcnt vmcnt(7)
L_PC2:
    v_cmp_ne_u64 s[78:79], s[82:83], v[8:9]
    s_nop 3
    s_cmp_lg_u64 s[78:79], 0
    s_cbranch_scc1 L_PS2
L_PR2:
    v_cvt_pk_bf16_f32 v249, v240, v241
    v_mfma_f32_32x32x16_bf16 a[128:143], v[184:187], v[32:35], a[128:143]
    ds_read_b64_tr_b16 v[180:181], v5 offset:20480
    ds_read_b64_tr_b16 v[182:183], v5 offset:21504
    buffer_store_dwordx4 v[246:249], v3, s[48:51], s87 offen offset:160 sc1
    ds_write_b128 v2, v[246:249] offset:160
    s_waitcnt lgkmcnt(7)
    v_mfma_f32_32x32x16_bf16 a[80:95], v[160:163], v[36:39], a[80:95]
    ds_read_b64_tr_b16 v[184:185], v6 offset:20480
    ds_read_b64_tr_b16 v[186:187], v6 offset:21504
    v_mfma_f32_32x32x16_bf16 a[96:111], v[164:167], v[36:39], a[96:111]
    ds_read_b64_tr_b16 v[160:161], v7 offset:20480
    ds_read_b64_tr_b16 v[162:163], v7 offset:21504
    v_accvgpr_read_b32 v234, a192
    v_accvgpr_read_b32 v235, a193
    v_accvgpr_read_b32 v236, a194
    v_accvgpr_read_b32 v237, a195
    v_accvgpr_read_b32 v238, a196
    v_mfma_f32_32x32x16_bf16 a[112:127], v[168:171], v[36:39], a[112:127]
    ds_read_b64_tr_b16 v[164:165], v4 offset:22528
    ds_read_b64_tr_b16 v[166:167], v4 offset:23552
    v_accvgpr_read_b32 v239, a197
    v_accvgpr_read_b32 v240, a198
    v_accvgpr_read_b32 v241, a199
    v_mul_f32 v234, v234, v211
    s_waitcnt lgkmcnt(7)
    v_mfma_f32_32x32x16_bf16 a[128:143], v[172:175], v[36:39], a[128:143]
    ds_read_b64_tr_b16 v[168:169], v5 offset:22528
    ds_read_b64_tr_b16 v[170:171], v5 offset:23552
    v_mul_f32 v235, v235, v211
    v_mul_f32 v236, v236, v211
    v_mul_f32 v237, v237, v211
    v_mul_f32 v238, v238, v211
    v_mfma_f32_32x32x16_bf16 a[80:95], v[176:179], v[40:43], a[80:95]
    ds_read_b64_tr_b16 v[172:173], v6 offset:22528
    ds_read_b64_tr_b16 v[174:175], v6 offset:23552
    v_mul_f32 v239, v239, v211
    v_mul_f32 v240, v240, v211
    v_mul_f32 v241, v241, v211
    v_cvt_pk_bf16_f32 v242, v234, v235
    v_mfma_f32_32x32x16_bf16 a[96:111], v[180:183], v[40:43], a[96:111]
    ds_read_b64_tr_b16 v[176:177], v7 offset:22528
    ds_read_b64_tr_b16 v[178:179], v7 offset:23552
    v_cvt_pk_bf16_f32 v243, v236, v237
    v_cvt_pk_bf16_f32 v244, v238, v239
    v_cvt_pk_bf16_f32 v245, v240, v241
    s_waitcnt lgkmcnt(6)
    v_mfma_f32_32x32x16_bf16 a[112:127], v[184:187], v[40:43], a[112:127]
    s_waitcnt lgkmcnt(0)
    s_barrier
    v_add_u32 v4, 40960, v4
    v_add_u32 v5, 40960, v5
    v_add_u32 v6, 40960, v6
    v_add_u32 v7, 40960, v7
    ds_read_b64_tr_b16 v[180:181], v4 offset:0
    ds_read_b64_tr_b16 v[182:183], v4 offset:1024
    buffer_store_dwordx4 v[242:245], v3, s[48:51], s87 offen offset:192 sc1
    ds_write_b128 v2, v[242:245] offset:192
    s_add_u32 s84, s18, 3538944
    s_add_u32 m0, s73, 40960
    v_mfma_f32_32x32x16_bf16 a[128:143], v[160:163], v[40:43], a[128:143]
    ds_read_b64_tr_b16 v[184:185], v5 offset:0
    ds_read_b64_tr_b16 v[186:187], v5 offset:1024
    buffer_load_dwordx4 v201, s[44:47], s84 offen offset:0 lds
    buffer_load_dwordx4 v202, s[44:47], s84 offen offset:1024 lds
    v_mfma_f32_32x32x16_bf16 a[80:95], v[164:167], v[44:47], a[80:95]
    ds_read_b64_tr_b16 v[160:161], v6 offset:0
    ds_read_b64_tr_b16 v[162:163], v6 offset:1024
    buffer_load_dwordx4 v203, s[44:47], s84 offen offset:2048 lds
    v_accvgpr_read_b32 v234, a144
    v_accvgpr_read_b32 v235, a145
    v_accvgpr_read_b32 v236, a146
    v_accvgpr_read_b32 v237, a147
    v_mfma_f32_32x32x16_bf16 a[96:111], v[168:171], v[44:47], a[96:111]
    ds_read_b64_tr_b16 v[164:165], v7 offset:0
    ds_read_b64_tr_b16 v[166:167], v7 offset:1024
    v_accvgpr_read_b32 v238, a148
    v_accvgpr_read_b32 v239, a149
    v_accvgpr_read_b32 v240, a150
    v_accvgpr_read_b32 v241, a151
    v_mfma_f32_32x32x16_bf16 a[112:127], v[172:175], v[44:47], a[112:127]
    ds_read_b64_tr_b16 v[168:169], v4 offset:2048
    ds_read_b64_tr_b16 v[170:171], v4 offset:3072
    buffer_load_dwordx4 v204, s[44:47], s84 offen offset:3072 lds
    s_add_u32 s84, s84, 147456
    s_add_u32 m0, s73, 45056
    v_mul_f32 v234, v234, v211
    v_mfma_f32_32x32x16_bf16 a[128:143], v[176:179], v[44:47], a[128:143]
    ds_read_b64_tr_b16 v[172:173], v5 offset:2048
    ds_read_b64_tr_b16 v[174:175], v5 offset:3072
    buffer_load_dwordx4 v201, s[44:47], s84 offen offset:0 lds
    v_mul_f32 v235, v235, v211
    v_mul_f32 v236, v236, v211
    v_mul_f32 v237, v237, v211
    s_waitcnt lgkmcnt(6)
    v_mfma_f32_32x32x16_bf16 a[80:95], v[180:183], v[48:51], a[80:95]
    ds_read_b64_tr_b16 v[176:177], v6 offset:2048
    ds_read_b64_tr_b16 v[178:179], v6 offset:3072
    v_mul_f32 v238, v238, v211
    v_mul_f32 v239, v239, v211
    v_mul_f32 v240, v240, v211
    v_mul_f32 v241, v241, v211
    v_mfma_f32_32x32x16_bf16 a[96:111], v[184:187], v[48:51], a[96:111]
    ds_read_b64_tr_b16 v[180:181], v7 offset:2048
    ds_read_b64_tr_b16 v[182:183], v7 offset:3072
    buffer_load_dwordx4 v202, s[44:47], s84 offen offset:1024 lds
    v_cvt_pk_bf16_f32 v246, v234, v235
    v_cvt_pk_bf16_f32 v247, v236, v237
    v_cvt_pk_bf16_f32 v248, v238, v239
    v_mfma_f32_32x32x16_bf16 a[112:127], v[160:163], v[48:51], a[112:127]
    ds_read_b64_tr_b16 v[184:185], v4 offset:4096
    ds_read_b64_tr_b16 v[186:187], v4 offset:5120
    v_cvt_pk_bf16_f32 v249, v240, v241
    s_waitcnt lgkmcnt(6)
    v_mfma_f32_32x32x16_bf16 a[128:143], v[164:167], v[48:51], a[128:143]
    ds_read_b64_tr_b16 v[160:161], v5 offset:4096
    ds_read_b64_tr_b16 v[162:163], v5 offset:5120
    ds_write_b128 v2, v[246:249] offset:0
    buffer_load_dwordx4 v203, s[44:47], s84 offen offset:2048 lds
    v_accvgpr_read_b32 v234, a152
    v_accvgpr_read_b32 v235, a153
    v_accvgpr_read_b32 v236, a154
    v_mfma_f32_32x32x16_bf16 a[80:95], v[168:171], v[52:55], a[80:95]
    ds_read_b64_tr_b16 v[164:165], v6 offset:4096
    ds_read_b64_tr_b16 v[166:167], v6 offset:5120
    buffer_load_dwordx4 v204, s[44:47], s84 offen offset:3072 lds
    v_accvgpr_read_b32 v237, a155
    v_accvgpr_read_b32 v238, a156
    v_accvgpr_read_b32 v239, a157
    v_mfma_f32_32x32x16_bf16 a[96:111], v[172:175], v[52:55], a[96:111]
    ds_read_b64_tr_b16 v[168:169], v7 offset:4096
    ds_read_b64_tr_b16 v[170:171], v7 offset:5120
    v_accvgpr_read_b32 v240, a158
    v_accvgpr_read_b32 v241, a159
    v_mul_f32 v234, v234, v211
    v_mul_f32 v235, v235, v211
    s_waitcnt lgkmcnt(7)
    v_mfma_f32_32x32x16_bf16 a[112:127], v[176:179], v[52:55], a[112:127]
    ds_read_b64_tr_b16 v[172:173], v4 offset:6144
    ds_read_b64_tr_b16 v[174:175], v4 offset:7168
    v_mul_f32 v236, v236, v211
    v_mul_f32 v237, v237, v211
    v_mul_f32 v238, v238, v211
    v_mul_f32 v239, v239, v211
    v_mfma_f32_32x32x16_bf16 a[128:143], v[180:183], v[52:55], a[128:143]
    ds_read_b64_tr_b16 v[176:177], v5 offset:6144
    ds_read_b64_tr_b16 v[178:179], v5 offset:7168
    v_mul_f32 v240, v240, v211
    v_mul_f32 v241, v241, v211
    v_cvt_pk_bf16_f32 v242, v234, v235
    v_cvt_pk_bf16_f32 v243, v236, v237
    v_mfma_f32_32x32x16_bf16 a[80:95], v[184:187], v[56:59], a[80:95]
    ds_read_b64_tr_b16 v[180:181], v6 offset:6144
    ds_read_b64_tr_b16 v[182:183], v6 offset:7168
    v_cvt_pk_bf16_f32 v244, v238, v239
    v_cvt_pk_bf16_f32 v245, v240, v241
    s_waitcnt lgkmcnt(6)
    v_mfma_f32_32x32x16_bf16 a[96:111], v[160:163], v[56:59], a[96:111]
    ds_read_b64_tr_b16 v[184:185], v7 offset:6144
    ds_read_b64_tr_b16 v[186:187], v7 offset:7168
    ds_write_b128 v2, v[242:245] offset:32
    v_and_b32 v226, 15, v1
    v_lshlrev_b32 v227, 2, v226
    v_and_b32 v15, 3, v1
    v_lshlrev_b32 v15, 3, v15
    v_mfma_f32_32x32x16_bf16 a[112:127], v[164:167], v[56:59], a[112:127]
    ds_read_b64_tr_b16 v[160:161], v4 offset:16384
    ds_read_b64_tr_b16 v[162:163], v4 offset:17408
    buffer_load_dword v252, v227, s[48:51], s31 offen sc1
    buffer_load_dword v253, v227, s[48:51], s31 offen offset:64 sc1
    v_lshrrev_b32 v227, 4, v1
    s_mul_i32 s88, s4, 7680
    v_mfma_f32_32x32x16_bf16 a[128:143], v[168:171], v[56:59], a[128:143]
    ds_read_b64_tr_b16 v[164:165], v5 offset:16384
    ds_read_b64_tr_b16 v[166:167], v5 offset:17408
    s_add_u32 s88, s88, 126976
    s_sub_u32 s89, s88, 3840
    s_cmp_eq_u32 s4, 0
    s_cselect_b32 s89, 122880, s89
    s_waitcnt lgkmcnt(7)
    v_mfma_f32_32x32x16_bf16 a[80:95], v[172:175], v[60:63], a[80:95]
    ds_read_b64_tr_b16 v[168:169], v6 offset:16384
    ds_read_b64_tr_b16 v[170:171], v6 offset:17408
    s_waitcnt lgkmcnt(6)
    s_barrier
    v_mul_u32_u24 v228, 240, v226
    v_add_u32 v219, s88, v228
    v_add_u32 v221, s89, v228
    v_lshl_add_u32 v218, v227, 3, v219
    v_mfma_f32_32x32x16_bf16 a[96:111], v[176:179], v[60:63], a[96:111]
    ds_read_b64_tr_b16 v[172:173], v7 offset:16384
    ds_read_b64_tr_b16 v[174:175], v7 offset:17408
    v_lshl_add_u32 v220, v227, 3, v221
    v_lshrrev_b32 v228, 2, v1
    v_mul_u32_u24 v228, 240, v228
    v_and_b32 v229, 3, v1
    v_mfma_f32_32x32x16_bf16 a[112:127], v[180:183], v[60:63], a[112:127]
    ds_read_b64_tr_b16 v[176:177], v4 offset:18432
    ds_read_b64_tr_b16 v[178:179], v4 offset:19456
    v_lshl_add_u32 v228, v229, 3, v228
    v_add_u32 v222, s88, v228
    v_add_u32 v223, s89, v228
    s_add_u32 s88, s14, 18432
    s_waitcnt lgkmcnt(6)
    v_mfma_f32_32x32x16_bf16 a[128:143], v[184:187], v[60:63], a[128:143]
    ds_read_b64_tr_b16 v[180:181], v5 offset:18432
    ds_read_b64_tr_b16 v[182:183], v5 offset:19456
    s_sub_u32 s89, s10, 131072
    s_lshl_b32 s89, s89, 3
    s_lshr_b32 s97, s7, 1
    s_lshl_b32 s97, s97, 9
    v_mfma_f32_32x32x16_bf16 a[80:95], v[160:163], v[64:67], a[80:95]
    ds_read_b64_tr_b16 v[184:185], v6 offset:18432
    ds_read_b64_tr_b16 v[186:187], v6 offset:19456
    s_add_u32 s89, s89, s97
    s_and_b32 s97, s7, 1
    s_lshl_b32 s97, s97, 3
    s_add_u32 s89, s89, s97
    v_mfma_f32_32x32x16_bf16 a[96:111], v[164:167], v[64:67], a[96:111]
    ds_read_b64_tr_b16 v[160:161], v7 offset:18432
    ds_read_b64_tr_b16 v[162:163], v7 offset:19456
    s_add_u32 s89, s89, 31457280
    v_lshrrev_b32 v228, 5, v1
    v_lshlrev_b32 v228, 9, v228
    v_lshl_add_u32 v228, v226, 4, v228
    s_waitcnt lgkmcnt(6)
    v_mfma_f32_32x32x16_bf16 a[112:127], v[168:171], v[64:67], a[112:127]
    ds_read_b64_tr_b16 v[164:165], v4 offset:20480
    ds_read_b64_tr_b16 v[166:167], v4 offset:21504
    v_and_b32 v227, 1, v227
    v_lshl_add_u32 v2, v227, 3, v228
    v_add_u32 v15, s10, v15
    s_add_u32 s92, s26, 0
    v_mfma_f32_32x32x16_bf16 a[128:143], v[172:175], v[64:67], a[128:143]
    ds_read_b64_tr_b16 v[168:169], v5 offset:20480
    ds_read_b64_tr_b16 v[170:171], v5 offset:21504
    ds_read_b64 a[192:193], v218 offset:72
    ds_read_b64 a[194:195], v219 offset:104
    v_mfma_f32_32x32x16_bf16 a[80:95], v[176:179], v[68:71], a[80:95]
    ds_read_b64_tr_b16 v[172:173], v6 offset:20480
    ds_read_b64_tr_b16 v[174:175], v6 offset:21504
    ds_read_b64 a[196:197], v218 offset:3912
    s_waitcnt lgkmcnt(14)
    ds_read_b64 a[198:199], v219 offset:3944
    s_waitcnt lgkmcnt(10)
    v_mfma_f32_32x32x16_bf16 a[96:111], v[180:183], v[68:71], a[96:111]
    ds_read_b64_tr_b16 v[176:177], v7 offset:20480
    ds_read_b64_tr_b16 v[178:179], v7 offset:21504
    ds_read_b64 v[224:225], v218 offset:3840
    ds_read_b32 v226, v219 offset:3872
    v_mov_b32 v227, 0
    v_mfma_f32_32x32x16_bf16 a[112:127], v[184:187], v[68:71], a[112:127]
    ds_read_b64_tr_b16 v[180:181], v4 offset:22528
    s_waitcnt lgkmcnt(14)
    ds_read_b64_tr_b16 v[182:183], v4 offset:23552
    s_waitcnt lgkmcnt(14)
    ds_read_b64 a[200:201], v218 offset:112
    s_waitcnt lgkmcnt(14)
    ds_read_b64 a[202:203], v219 offset:104
    v_mfma_f32_32x32x16_bf16 a[128:143], v[160:163], v[68:71], a[128:143]
    s_waitcnt lgkmcnt(14)
    ds_read_b64_tr_b16 v[184:185], v5 offset:22528
    s_waitcnt lgkmcnt(14)
    ds_read_b64_tr_b16 v[186:187], v5 offset:23552
    s_waitcnt lgkmcnt(14)
    ds_read_b64 a[204:205], v218 offset:3952
    s_waitcnt lgkmcnt(14)
    ds_read_b64 a[206:207], v219 offset:3944
    s_waitcnt lgkmcnt(14)
    v_mfma_f32_32x32x16_bf16 a[80:95], v[164:167], v[72:75], a[80:95]
    ds_read_b64_tr_b16 v[160:161], v6 offset:22528
    s_waitcnt lgkmcnt(14)
    ds_read_b64_tr_b16 v[162:163], v6 offset:23552
    s_waitcnt lgkmcnt(14)
    ds_read_b64 v[228:229], v218 offset:3880
    s_waitcnt lgkmcnt(14)
    ds_read_b32 v231, v219 offset:3876
    v_mov_b32 v230, 0
    v_mfma_f32_32x32x16_bf16 a[96:111], v[168:171], v[72:75], a[96:111]
    s_waitcnt lgkmcnt(14)
    ds_read_b64_tr_b16 v[164:165], v7 offset:22528
    s_waitcnt lgkmcnt(14)
    ds_read_b64_tr_b16 v[166:167], v7 offset:23552
    s_lshl_b32 s87, s86, 7
    s_add_u32 s87, s87, 65536
    s_cmp_eq_u32 s4, 3
    s_cselect_b32 s87, s87, 0x40000000
    s_waitcnt vmcnt(10)
    buffer_store_dwordx2 v[12:13], v207, s[48:51], s87 offen offset:0 sc1
    v_mfma_f32_32x32x16_bf16 a[112:127], v[172:175], v[72:75], a[112:127]
    s_waitcnt lgkmcnt(0)
    s_barrier
    v_subrev_u32 v4, 81920, v4
    v_subrev_u32 v5, 81920, v5
    v_subrev_u32 v6, 81920, v6
    v_subrev_u32 v7, 81920, v7
    ds_read_b64_tr_b16 v[168:169], v4 offset:0
    ds_read_b64_tr_b16 v[170:171], v4 offset:1024
    ds_read_b64_tr_b16 a[208:209], v222 offset:144
    ds_read_b64_tr_b16 a[210:211], v222 offset:3984
    s_mov_b32 s84, s19
    s_lshr_b32 s85, s73, 1
    v_mfma_f32_32x32x16_bf16 a[128:143], v[176:179], v[72:75], a[128:143]
    ds_read_b64_tr_b16 v[172:173], v5 offset:0
    ds_read_b64_tr_b16 v[174:175], v5 offset:1024
    ds_read_b64_tr_b16 a[212:213], v222 offset:184
    ds_read_b64_tr_b16 a[214:215], v222 offset:4024
    s_add_u32 m0, s85, 81920
    v_mfma_f32_32x32x16_bf16 a[80:95], v[180:183], v[76:79], a[80:95]
    ds_read_b64_tr_b16 v[176:177], v6 offset:0
    ds_read_b64_tr_b16 v[178:179], v6 offset:1024
    ds_read_b64_tr_b16 a[216:217], v222 offset:176
    ds_read_b64_tr_b16 a[218:219], v222 offset:4016
    v_cndmask_b32 v226, 0, v226, s[32:33]
    v_cndmask_b32 v231, 0, v231, s[32:33]
    s_waitcnt vmcnt(1)
    v_and_b32 v253, v254, v253
    v_mfma_f32_32x32x16_bf16 a[96:111], v[184:187], v[76:79], a[96:111]
    ds_read_b64_tr_b16 v[180:181], v7 offset:0
    ds_read_b64_tr_b16 v[182:183], v7 offset:1024
    buffer_load_dwordx4 v201, s[44:47], s84 offen offset:0 lds
    buffer_load_dwordx4 v202, s[44:47], s84 offen offset:1024 lds
    v_mul_f32 v253, v253, v253
    v_mfma_f32_16x16x32_bf16 v[232:235], a[192:195], v[224:227], v[188:191]
    v_mfma_f32_16x16x32_bf16 v[236:239], a[196:199], v[224:227], v[192:195]
    v_mfma_f32_16x16x32_bf16 v[240:243], a[200:203], v[228:231], v[188:191]
    v_mfma_f32_16x16x32_bf16 v[244:247], a[204:207], v[228:231], v[192:195]
    s_waitcnt lgkmcnt(12)
    v_mfma_f32_32x32x16_bf16 a[112:127], v[160:163], v[76:79], a[112:127]
    ds_read_b64_tr_b16 v[184:185], v4 offset:2048
    ds_read_b64_tr_b16 v[186:187], v4 offset:3072
    buffer_load_dwordx4 v203, s[44:47], s84 offen offset:2048 lds
    v_max3_f32 v248, v232, v233, v234
    v_max3_f32 v200, v235, v236, v237
    v_max3_f32 v248, v248, v238, v239
    v_max_f32 v248, v248, v200
    v_mfma_f32_32x32x16_bf16 a[128:143], v[164:167], v[76:79], a[128:143]
    ds_read_b64_tr_b16 v[160:161], v5 offset:2048
    s_waitcnt lgkmcnt(14)
    ds_read_b64_tr_b16 v[162:163], v5 offset:3072
    buffer_load_dwordx4 v204, s[44:47], s84 offen offset:3072 lds
    v_max3_f32 v249, v240, v241, v242
    v_max3_f32 v205, v243, v244, v245
    v_max3_f32 v249, v249, v246, v247
    v_mfma_f32_32x32x16_bf16 a[80:95], v[168:171], v[80:83], a[80:95]
    s_waitcnt lgkmcnt(14)
    ds_read_b64_tr_b16 v[164:165], v6 offset:2048
    s_waitcnt lgkmcnt(14)
    ds_read_b64_tr_b16 v[166:167], v6 offset:3072
    v_max_f32 v249, v249, v205
    v_mov_b32 v205, 0x3eae1a93
    s_waitcnt lgkmcnt(6)
    v_mfma_f32_32x32x16_bf16 a[96:111], v[172:175], v[80:83], a[96:111]
    ds_read_b64_tr_b16 v[168:169], v7 offset:2048
    ds_read_b64_tr_b16 v[170:171], v7 offset:3072
    buffer_load_dwordx4 a[144:147], v209, s[48:51], s92 offen offset:0 sc1
    v_permlane16_swap_b32 v248, v249
    v_max_f32 v248, v248, v249
    v_mov_b32 v249, v248
    v_mfma_f32_32x32x16_bf16 a[112:127], v[176:179], v[80:83], a[112:127]
    ds_read_b64_tr_b16 v[172:173], v4 offset:4096
    ds_read_b64_tr_b16 v[174:175], v4 offset:5120
    buffer_load_dwordx4 a[148:151], v209, s[48:51], s92 offen offset:1024 sc1
    v_mfma_f32_32x32x16_bf16 a[128:143], v[180:183], v[80:83], a[128:143]
    ds_read_b64_tr_b16 v[176:177], v5 offset:4096
    ds_read_b64_tr_b16 v[178:179], v5 offset:5120
    v_permlane32_swap_b32 v248, v249
    v_max_f32 v248, v248, v249
    v_mul_f32 v248, 0xbeae1a93, v248
    v_mov_b32 v249, v248
    s_waitcnt lgkmcnt(6)
    v_mfma_f32_32x32x16_bf16 a[80:95], v[184:187], v[84:87], a[80:95]
    ds_read_b64_tr_b16 v[180:181], v6 offset:4096
    ds_read_b64_tr_b16 v[182:183], v6 offset:5120
    buffer_load_dwordx4 a[152:155], v209, s[48:51], s92 offen offset:2048 sc1
    v_mfma_f32_32x32x16_bf16 a[96:111], v[160:163], v[84:87], a[96:111]
    ds_read_b64_tr_b16 v[184:185], v7 offset:4096
    ds_read_b64_tr_b16 v[186:187], v7 offset:5120
    v_permlane16_swap_b32 v248, v249
    v_fma_f32 v232, v232, v205, v248
    v_fma_f32 v233, v233, v205, v248
    v_fma_f32 v234, v234, v205, v248
    v_mfma_f32_32x32x16_bf16 a[112:127], v[164:167], v[84:87], a[112:127]
    ds_read_b64_tr_b16 v[160:161], v4 offset:6144
    ds_read_b64_tr_b16 v[162:163], v4 offset:7168
    buffer_load_dwordx4 a[156:159], v209, s[48:51], s92 offen offset:3072 sc1
    v_fma_f32 v235, v235, v205, v248
    v_fma_f32 v236, v236, v205, v248
    v_fma_f32 v237, v237, v205, v248
    s_waitcnt lgkmcnt(6)
    v_mfma_f32_32x32x16_bf16 a[128:143], v[168:171], v[84:87], a[128:143]
    ds_read_b64_tr_b16 v[164:165], v5 offset:6144
    ds_read_b64_tr_b16 v[166:167], v5 offset:7168
    v_fma_f32 v238, v238, v205, v248
    v_fma_f32 v239, v239, v205, v248
    v_exp_f32 v232, v232
    v_mfma_f32_32x32x16_bf16 a[80:95], v[172:175], v[88:91], a[80:95]
    ds_read_b64_tr_b16 v[168:169], v6 offset:6144
    ds_read_b64_tr_b16 v[170:171], v6 offset:7168
    v_exp_f32 v233, v233
    v_exp_f32 v234, v234
    v_mfma_f32_32x32x16_bf16 a[96:111], v[176:179], v[88:91], a[96:111]
    ds_read_b64_tr_b16 v[172:173], v7 offset:6144
    ds_read_b64_tr_b16 v[174:175], v7 offset:7168
    v_exp_f32 v235, v235
    v_exp_f32 v236, v236
    s_waitcnt lgkmcnt(6)
    v_mfma_f32_32x32x16_bf16 a[112:127], v[180:183], v[88:91], a[112:127]
    ds_read_b64_tr_b16 v[176:177], v4 offset:16384
    ds_read_b64_tr_b16 v[178:179], v4 offset:17408
    v_exp_f32 v237, v237
    v_exp_f32 v238, v238
    v_mfma_f32_32x32x16_bf16 a[128:143], v[184:187], v[88:91], a[128:143]
    ds_read_b64_tr_b16 v[180:181], v5 offset:16384
    ds_read_b64_tr_b16 v[182:183], v5 offset:17408
    v_exp_f32 v239, v239
    v_fma_f32 v240, v240, v205, v249
    v_fma_f32 v241, v241, v205, v249
    v_mfma_f32_32x32x16_bf16 a[80:95], v[160:163], v[92:95], a[80:95]
    ds_read_b64_tr_b16 v[184:185], v6 offset:16384
    ds_read_b64_tr_b16 v[186:187], v6 offset:17408
    v_fma_f32 v242, v242, v205, v249
    v_fma_f32 v243, v243, v205, v249
    v_fma_f32 v244, v244, v205, v249
    v_fma_f32 v245, v245, v205, v249
    s_waitcnt lgkmcnt(6)
    v_mfma_f32_32x32x16_bf16 a[96:111], v[164:167], v[92:95], a[96:111]
    ds_read_b64_tr_b16 v[160:161], v7 offset:16384
    ds_read_b64_tr_b16 v[162:163], v7 offset:17408
    v_fma_f32 v246, v246, v205, v249
    v_fma_f32 v247, v247, v205, v249
    v_exp_f32 v240, v240
    v_mfma_f32_32x32x16_bf16 a[112:127], v[168:171], v[92:95], a[112:127]
    ds_read_b64_tr_b16 v[164:165], v4 offset:18432
    ds_read_b64_tr_b16 v[166:167], v4 offset:19456
    v_exp_f32 v241, v241
    v_exp_f32 v242, v242
    v_mfma_f32_32x32x16_bf16 a[128:143], v[172:175], v[92:95], a[128:143]
    ds_read_b64_tr_b16 v[168:169], v5 offset:18432
    ds_read_b64_tr_b16 v[170:171], v5 offset:19456
    v_exp_f32 v243, v243
    v_exp_f32 v244, v244
    s_waitcnt lgkmcnt(6)
    v_mfma_f32_32x32x16_bf16 a[80:95], v[176:179], v[96:99], a[80:95]
    ds_read_b64_tr_b16 v[172:173], v6 offset:18432
    ds_read_b64_tr_b16 v[174:175], v6 offset:19456
    v_exp_f32 v245, v245
    v_exp_f32 v246, v246
    v_mfma_f32_32x32x16_bf16 a[96:111], v[180:183], v[96:99], a[96:111]
    ds_read_b64_tr_b16 v[176:177], v7 offset:18432
    ds_read_b64_tr_b16 v[178:179], v7 offset:19456
    v_exp_f32 v247, v247
    v_cvt_pk_bf16_f32 v196, v232, v233
    v_cvt_pk_bf16_f32 v197, v234, v235
    v_mfma_f32_32x32x16_bf16 a[112:127], v[184:187], v[96:99], a[112:127]
    ds_read_b64_tr_b16 v[180:181], v4 offset:20480
    ds_read_b64_tr_b16 v[182:183], v4 offset:21504
    v_cvt_pk_bf16_f32 v198, v236, v237
    v_cvt_pk_bf16_f32 v199, v238, v239
    v_cvt_pk_bf16_f32 v214, v240, v241
    v_cvt_pk_bf16_f32 v215, v242, v243
    s_waitcnt lgkmcnt(6)
    v_mfma_f32_32x32x16_bf16 a[128:143], v[160:163], v[96:99], a[128:143]
    ds_read_b64_tr_b16 v[184:185], v5 offset:20480
    ds_read_b64_tr_b16 v[186:187], v5 offset:21504
    v_cvt_pk_bf16_f32 v216, v244, v245
    v_cvt_pk_bf16_f32 v217, v246, v247
    v_mfma_f32_16x16x32_bf16 v[224:227], a[220:223], v[196:199], 0
    v_mfma_f32_16x16x32_bf16 v[232:235], a[208:211], v[196:199], 0
    v_mfma_f32_16x16x32_bf16 v[236:239], a[216:219], v[196:199], 0
    v_mfma_f32_16x16x32_bf16 v[228:231], a[220:223], v[214:217], 0
    v_mfma_f32_16x16x32_bf16 v[240:243], a[212:215], v[214:217], 0
    v_mfma_f32_16x16x32_bf16 v[244:247], a[216:219], v[214:217], 0
    s_add_u32 s92, s26, 4096
    v_mfma_f32_32x32x16_bf16 a[80:95], v[164:167], v[100:103], a[80:95]
    ds_read_b64_tr_b16 v[160:161], v6 offset:20480
    ds_read_b64_tr_b16 v[162:163], v6 offset:21504
    buffer_load_dwordx4 a[160:163], v209, s[48:51], s92 offen offset:0 sc1
    buffer_load_dwordx4 a[164:167], v209, s[48:51], s92 offen offset:1024 sc1
    v_rcp_f32 v248, v224
    v_mfma_f32_32x32x16_bf16 a[96:111], v[168:171], v[100:103], a[96:111]
    ds_read_b64_tr_b16 v[164:165], v7 offset:20480
    ds_read_b64_tr_b16 v[166:167], v7 offset:21504
    buffer_load_dwordx4 a[168:171], v209, s[48:51], s92 offen offset:2048 sc1
    v_rcp_f32 v249, v228
    v_mul_f32 v248, v248, v253
    v_mul_f32 v249, v249, v253
    s_waitcnt lgkmcnt(6)
    v_mfma_f32_32x32x16_bf16 a[112:127], v[172:175], v[100:103], a[112:127]
    ds_read_b64_tr_b16 v[168:169], v4 offset:22528
    ds_read_b64_tr_b16 v[170:171], v4 offset:23552
    buffer_load_dwordx4 a[172:175], v209, s[48:51], s92 offen offset:3072 sc1
    v_mul_f32 v232, v232, v248
    v_mul_f32 v233, v233, v248
    v_mul_f32 v234, v234, v248
    v_mfma_f32_32x32x16_bf16 a[128:143], v[176:179], v[100:103], a[128:143]
    ds_read_b64_tr_b16 v[172:173], v5 offset:22528
    ds_read_b64_tr_b16 v[174:175], v5 offset:23552
    v_mul_f32 v235, v235, v248
    v_mul_f32 v236, v236, v248
    v_mul_f32 v237, v237, v248
    v_mul_f32 v240, v240, v249
    v_mfma_f32_32x32x16_bf16 a[80:95], v[180:183], v[104:107], a[80:95]
    ds_read_b64_tr_b16 v[176:177], v6 offset:22528
    ds_read_b64_tr_b16 v[178:179], v6 offset:23552
    v_mul_f32 v241, v241, v249
    v_mul_f32 v242, v242, v249
    v_mul_f32 v243, v243, v249
    v_mul_f32 v246, v246, v249
    s_waitcnt lgkmcnt(6)
    v_mfma_f32_32x32x16_bf16 a[96:111], v[184:187], v[104:107], a[96:111]
    ds_read_b64_tr_b16 v[180:181], v7 offset:22528
    ds_read_b64_tr_b16 v[182:183], v7 offset:23552
    v_mul_f32 v247, v247, v249
    v_cvt_pk_bf16_f32 v224, v232, v233
    v_cvt_pk_bf16_f32 v225, v234, v235
    v_cvt_pk_bf16_f32 v228, v236, v237
    v_mfma_f32_32x32x16_bf16 a[112:127], v[160:163], v[104:107], a[112:127]
    s_waitcnt lgkmcnt(0)
    s_barrier
    v_add_u32 v4, 40960, v4
    v_add_u32 v5, 40960, v5
    v_add_u32 v6, 40960, v6
    v_add_u32 v7, 40960, v7
    ds_read_b64_tr_b16 v[184:185], v4 offset:0
    ds_read_b64_tr_b16 v[186:187], v4 offset:1024
    s_mov_b32 s84, s22
    s_add_u32 m0, s72, 0
    s_nop 0
    buffer_load_dwordx4 v209, s[48:51], s84 offen offset:0 sc1 lds
    buffer_load_dwordx4 v209, s[48:51], s84 offen offset:1024 sc1 lds
    v_mfma_f32_32x32x16_bf16 a[128:143], v[164:167], v[104:107], a[128:143]
    ds_read_b64_tr_b16 v[160:161], v5 offset:0
    ds_read_b64_tr_b16 v[162:163], v5 offset:1024
    buffer_load_dwordx4 v209, s[48:51], s84 offen offset:2048 sc1 lds
    v_cvt_pk_bf16_f32 v226, v240, v241
    v_cvt_pk_bf16_f32 v227, v242, v243
    v_cvt_pk_bf16_f32 v229, v246, v247
    v_mfma_f32_32x32x16_bf16 a[80:95], v[168:171], v[108:111], a[80:95]
    ds_read_b64_tr_b16 v[164:165], v6 offset:0
    ds_read_b64_tr_b16 v[166:167], v6 offset:1024
    buffer_store_dwordx2 v[224:225], v2, s[48:51], s88 offen offset:256 sc1
    buffer_store_dwordx2 v[226:227], v2, s[48:51], s88 offen offset:1280 sc1
    s_add_u32 s92, s26, 8192
    v_mfma_f32_32x32x16_bf16 a[96:111], v[172:175], v[108:111], a[96:111]
    ds_read_b64_tr_b16 v[168:169], v7 offset:0
    ds_read_b64_tr_b16 v[170:171], v7 offset:1024
    buffer_store_dwordx2 v[228:229], v213, s[48:51], s89 offen offset:256 sc1
    s_or_b32 s97, s5, s4
    s_cmp_eq_u32 s97, 0
    s_cselect_b32 s97, 0xf149f2ca, 0
    v_min_f32 v188, s97, v188
    v_mfma_f32_32x32x16_bf16 a[112:127], v[176:179], v[108:111], a[112:127]
    ds_read_b64_tr_b16 v[172:173], v4 offset:2048
    ds_read_b64_tr_b16 v[174:175], v4 offset:3072
    buffer_load_dwordx4 v209, s[48:51], s84 offen offset:3072 sc1 lds
    s_add_u32 m0, s72, 4096
    s_add_u32 s84, s84, 4096
    v_min_f32 v189, s97, v189
    s_waitcnt lgkmcnt(6)
    v_mfma_f32_32x32x16_bf16 a[128:143], v[180:183], v[108:111], a[128:143]
    ds_read_b64_tr_b16 v[176:177], v5 offset:2048
    ds_read_b64_tr_b16 v[178:179], v5 offset:3072
    v_min_f32 v190, s97, v190
    v_min_f32 v191, s97, v191
    v_mfma_f32_32x32x16_bf16 a[80:95], v[184:187], v[112:115], a[80:95]
    ds_read_b64_tr_b16 v[180:181], v6 offset:2048
    ds_read_b64_tr_b16 v[182:183], v6 offset:3072
    buffer_load_dwordx4 v209, s[48:51], s84 offen offset:0 sc1 lds
    v_mfma_f32_32x32x16_bf16 a[96:111], v[160:163], v[112:115], a[96:111]
    ds_read_b64_tr_b16 v[184:185], v7 offset:2048
    ds_read_b64_tr_b16 v[186:187], v7 offset:3072
    buffer_load_dwordx4 v209, s[48:51], s84 offen offset:1024 sc1 lds
    s_waitcnt lgkmcnt(6)
    v_mfma_f32_32x32x16_bf16 a[112:127], v[164:167], v[112:115], a[112:127]
    ds_read_b64_tr_b16 v[160:161], v4 offset:4096
    ds_read_b64_tr_b16 v[162:163], v4 offset:5120
    s_sub_u32 s86, s86, 16
    s_lshl_b32 s87, s86, 7
    s_add_u32 s87, s87, 65536
    s_lshl_b32 s98, s8, 5
    s_add_u32 s98, s98, 8192
    v_mfma_f32_32x32x16_bf16 a[128:143], v[168:171], v[112:115], a[128:143]
    ds_read_b64_tr_b16 v[164:165], v5 offset:4096
    ds_read_b64_tr_b16 v[166:167], v5 offset:5120
    buffer_load_dwordx4 v209, s[48:51], s84 offen offset:2048 sc1 lds
    s_cmp_eq_u32 s5, 0
    s_cselect_b32 s87, s98, s87
    v_mov_b32 v3, s87
    v_mfma_f32_32x32x16_bf16 a[80:95], v[172:175], v[116:119], a[80:95]
    ds_read_b64_tr_b16 v[168:169], v6 offset:4096
    ds_read_b64_tr_b16 v[170:171], v6 offset:5120
    buffer_load_dwordx2 v[250:251], v3, s[48:51], 0 offen sc1
    s_waitcnt lgkmcnt(6)
    v_mfma_f32_32x32x16_bf16 a[96:111], v[176:179], v[116:119], a[96:111]
    ds_read_b64_tr_b16 v[172:173], v7 offset:4096
    ds_read_b64_tr_b16 v[174:175], v7 offset:5120
    buffer_load_dwordx4 v209, s[48:51], s84 offen offset:3072 sc1 lds
    s_add_u32 m0, s72, 8192
    s_add_u32 s84, s84, 4096
    v_mfma_f32_32x32x16_bf16 a[112:127], v[180:183], v[116:119], a[112:127]
    ds_read_b64_tr_b16 v[176:177], v4 offset:6144
    ds_read_b64_tr_b16 v[178:179], v4 offset:7168
    v_mfma_f32_32x32x16_bf16 a[128:143], v[184:187], v[116:119], a[128:143]
    ds_read_b64_tr_b16 v[180:181], v5 offset:6144
    ds_read_b64_tr_b16 v[182:183], v5 offset:7168
    buffer_load_dwordx4 v209, s[48:51], s84 offen offset:0 sc1 lds
    s_waitcnt lgkmcnt(6)
    v_mfma_f32_32x32x16_bf16 a[80:95], v[160:163], v[120:123], a[80:95]
    ds_read_b64_tr_b16 v[184:185], v6 offset:6144
    ds_read_b64_tr_b16 v[186:187], v6 offset:7168
    buffer_load_dwordx4 v209, s[48:51], s84 offen offset:1024 sc1 lds
    v_mfma_f32_32x32x16_bf16 a[96:111], v[164:167], v[120:123], a[96:111]
    ds_read_b64_tr_b16 v[160:161], v7 offset:6144
    ds_read_b64_tr_b16 v[162:163], v7 offset:7168
    v_mfma_f32_32x32x16_bf16 a[112:127], v[168:171], v[120:123], a[112:127]
    ds_read_b64_tr_b16 v[164:165], v4 offset:16384
    ds_read_b64_tr_b16 v[166:167], v4 offset:17408
    buffer_load_dwordx4 a[176:179], v209, s[48:51], s92 offen offset:0 sc1
    s_waitcnt lgkmcnt(6)
    v_mfma_f32_32x32x16_bf16 a[128:143], v[172:175], v[120:123], a[128:143]
    ds_read_b64_tr_b16 v[168:169], v5 offset:16384
    ds_read_b64_tr_b16 v[170:171], v5 offset:17408
    buffer_load_dwordx4 a[180:183], v209, s[48:51], s92 offen offset:1024 sc1
    s_add_u32 s92, s27, 0
    v_mfma_f32_32x32x16_bf16 a[80:95], v[176:179], v[124:127], a[80:95]
    ds_read_b64_tr_b16 v[172:173], v6 offset:16384
    ds_read_b64_tr_b16 v[174:175], v6 offset:17408
    v_mfma_f32_32x32x16_bf16 a[96:111], v[180:183], v[124:127], a[96:111]
    ds_read_b64_tr_b16 v[176:177], v7 offset:16384
    ds_read_b64_tr_b16 v[178:179], v7 offset:17408
    buffer_load_dwordx4 a[184:187], v209, s[48:51], s92 offen offset:0 sc1
    s_waitcnt lgkmcnt(6)
    v_mfma_f32_32x32x16_bf16 a[112:127], v[184:187], v[124:127], a[112:127]
    ds_read_b64_tr_b16 v[180:181], v4 offset:18432
    ds_read_b64_tr_b16 v[182:183], v4 offset:19456
    v_mfma_f32_32x32x16_bf16 a[128:143], v[160:163], v[124:127], a[128:143]
    ds_read_b64_tr_b16 v[184:185], v5 offset:18432
    ds_read_b64_tr_b16 v[186:187], v5 offset:19456
    buffer_load_dwordx4 a[188:191], v209, s[48:51], s92 offen offset:1024 sc1
    v_mfma_f32_32x32x16_bf16 a[80:95], v[164:167], v[128:131], a[80:95]
    ds_read_b64_tr_b16 v[160:161], v6 offset:18432
    ds_read_b64_tr_b16 v[162:163], v6 offset:19456
    buffer_load_dwordx4 a[40:43], v209, s[48:51], s92 offen offset:2048 sc1
    s_waitcnt lgkmcnt(6)
    v_mfma_f32_32x32x16_bf16 a[96:111], v[168:171], v[128:131], a[96:111]
    ds_read_b64_tr_b16 v[164:165], v7 offset:18432
    ds_read_b64_tr_b16 v[166:167], v7 offset:19456
    v_mfma_f32_32x32x16_bf16 a[112:127], v[172:175], v[128:131], a[112:127]
    ds_read_b64_tr_b16 v[168:169], v4 offset:20480
    ds_read_b64_tr_b16 v[170:171], v4 offset:21504
    buffer_load_dwordx4 a[44:47], v209, s[48:51], s92 offen offset:3072 sc1
    s_add_u32 s92, s27, 4096
    v_mfma_f32_32x32x16_bf16 a[128:143], v[176:179], v[128:131], a[128:143]
    ds_read_b64_tr_b16 v[172:173], v5 offset:20480
    ds_read_b64_tr_b16 v[174:175], v5 offset:21504
    s_waitcnt lgkmcnt(6)
    v_mfma_f32_32x32x16_bf16 a[80:95], v[180:183], v[132:135], a[80:95]
    ds_read_b64_tr_b16 v[176:177], v6 offset:20480
    ds_read_b64_tr_b16 v[178:179], v6 offset:21504
    buffer_load_dwordx4 v[16:19], v209, s[48:51], s92 offen offset:0 sc1
    v_mfma_f32_32x32x16_bf16 a[96:111], v[184:187], v[132:135], a[96:111]
    ds_read_b64_tr_b16 v[180:181], v7 offset:20480
    ds_read_b64_tr_b16 v[182:183], v7 offset:21504
    buffer_load_dwordx4 v[20:23], v209, s[48:51], s92 offen offset:1024 sc1
    v_mfma_f32_32x32x16_bf16 a[112:127], v[160:163], v[132:135], a[112:127]
    ds_read_b64_tr_b16 v[184:185], v4 offset:22528
    ds_read_b64_tr_b16 v[186:187], v4 offset:23552
    s_waitcnt lgkmcnt(6)
    v_mfma_f32_32x32x16_bf16 a[128:143], v[164:167], v[132:135], a[128:143]
    ds_read_b64_tr_b16 v[160:161], v5 offset:22528
    ds_read_b64_tr_b16 v[162:163], v5 offset:23552
    buffer_load_dwordx4 v[24:27], v209, s[48:51], s92 offen offset:2048 sc1
    v_mfma_f32_32x32x16_bf16 a[80:95], v[168:171], v[136:139], a[80:95]
    ds_read_b64_tr_b16 v[164:165], v6 offset:22528
    ds_read_b64_tr_b16 v[166:167], v6 offset:23552
    buffer_load_dwordx4 v[28:31], v209, s[48:51], s92 offen offset:3072 sc1
    s_add_u32 s92, s27, 8192
    v_mfma_f32_32x32x16_bf16 a[96:111], v[172:175], v[136:139], a[96:111]
    ds_read_b64_tr_b16 v[168:169], v7 offset:22528
    ds_read_b64_tr_b16 v[170:171], v7 offset:23552
    s_waitcnt lgkmcnt(6)
    v_mfma_f32_32x32x16_bf16 a[112:127], v[176:179], v[136:139], a[112:127]
    s_waitcnt vmcnt(32)
    s_waitcnt lgkmcnt(0)
    s_barrier
    v_add_u32 v4, 40960, v4
    v_add_u32 v5, 40960, v5
    v_add_u32 v6, 40960, v6
    v_add_u32 v7, 40960, v7
    ds_read_b64_tr_b16 v[172:173], v4 offset:0
    ds_read_b64_tr_b16 v[174:175], v4 offset:1024
    s_waitcnt vmcnt(13)
L_PC3:
    v_cmp_ne_u64 s[78:79], s[82:83], v[250:251]
    s_nop 3
    s_cmp_lg_u64 s[78:79], 0
    s_cbranch_scc1 L_PS3
L_PR3:
    s_cmp_lg_u32 s4, 0
    s_cbranch_scc1 L_HI
    s_lshl_b32 s87, s86, 12
    s_add_u32 s87, s87, 31981568
    s_cmp_eq_u32 s5, 0
    s_cselect_b32 s87, 0x40000000, s87
    s_mov_b32 s98, m0
    s_mov_b32 m0, 122880
    s_nop 0
    buffer_load_dwordx4 v209, s[48:51], s87 offen offset:0 sc1 lds
    buffer_load_dwordx4 v209, s[48:51], s87 offen offset:1024 sc1 lds
    buffer_load_dwordx4 v209, s[48:51], s87 offen offset:2048 sc1 lds
    buffer_load_dwordx4 v209, s[48:51], s87 offen offset:3072 sc1 lds
    s_mov_b32 m0, s98
L_HI:
    buffer_load_dword v250, v14, s[64:67], 0 offen
    s_mov_b32 s84, s23
    s_add_u32 m0, s73, 40960
    s_nop 0
    buffer_load_dwordx4 v209, s[48:51], s84 offen offset:0 sc1 lds
    v_mfma_f32_32x32x16_bf16 a[128:143], v[180:183], v[136:139], a[128:143]
    ds_read_b64_tr_b16 v[176:177], v4 offset:2048
    ds_read_b64_tr_b16 v[178:179], v4 offset:3072
    v_mfma_f32_32x32x16_bf16 a[80:95], v[184:187], v[140:143], a[80:95]
    ds_read_b64_tr_b16 v[180:181], v4 offset:4096
    ds_read_b64_tr_b16 v[182:183], v4 offset:5120
    buffer_load_dwordx4 v209, s[48:51], s84 offen offset:1024 sc1 lds
    v_mfma_f32_32x32x16_bf16 a[96:111], v[160:163], v[140:143], a[96:111]
    ds_read_b64_tr_b16 v[184:185], v4 offset:6144
    ds_read_b64_tr_b16 v[186:187], v4 offset:7168
    buffer_load_dwordx4 v209, s[48:51], s84 offen offset:2048 sc1 lds
    v_mfma_f32_32x32x16_bf16 a[112:127], v[164:167], v[140:143], a[112:127]
    ds_read_b64_tr_b16 v[160:161], v5 offset:0
    ds_read_b64_tr_b16 v[162:163], v5 offset:1024
    v_mfma_f32_32x32x16_bf16 a[128:143], v[168:171], v[140:143], a[128:143]
    ds_read_b64_tr_b16 v[164:165], v5 offset:2048
    ds_read_b64_tr_b16 v[166:167], v5 offset:3072
    buffer_load_dwordx4 v209, s[48:51], s84 offen offset:3072 sc1 lds
    s_add_u32 m0, s73, 45056
    s_add_u32 s84, s84, 4096
    s_waitcnt lgkmcnt(6)
    v_mfma_f32_32x32x16_bf16 a[80:95], v[172:175], v[144:147], a[80:95]
    ds_read_b64_tr_b16 v[168:169], v5 offset:4096
    ds_read_b64_tr_b16 v[170:171], v5 offset:5120
    buffer_load_dwordx4 v209, s[48:51], s84 offen offset:0 sc1 lds
    v_mfma_f32_32x32x16_bf16 a[80:95], v[176:179], v[148:151], a[80:95]
    ds_read_b64_tr_b16 v[172:173], v5 offset:6144
    ds_read_b64_tr_b16 v[174:175], v5 offset:7168
    v_mfma_f32_32x32x16_bf16 a[80:95], v[180:183], v[152:155], a[80:95]
    ds_read_b64_tr_b16 v[176:177], v6 offset:0
    ds_read_b64_tr_b16 v[178:179], v6 offset:1024
    buffer_load_dwordx4 v209, s[48:51], s84 offen offset:1024 sc1 lds
    s_waitcnt lgkmcnt(6)
    v_mfma_f32_32x32x16_bf16 a[80:95], v[184:187], v[156:159], a[80:95]
    ds_read_b64_tr_b16 v[180:181], v6 offset:2048
    ds_read_b64_tr_b16 v[182:183], v6 offset:3072
    v_mfma_f32_32x32x16_bf16 a[96:111], v[160:163], v[144:147], a[96:111]
    ds_read_b64_tr_b16 v[184:185], v6 offset:4096
    ds_read_b64_tr_b16 v[186:187], v6 offset:5120
    buffer_load_dwordx4 v209, s[48:51], s84 offen offset:2048 sc1 lds
    v_mfma_f32_32x32x16_bf16 a[96:111], v[164:167], v[148:151], a[96:111]
    ds_read_b64_tr_b16 v[160:161], v6 offset:6144
    ds_read_b64_tr_b16 v[162:163], v6 offset:7168
    buffer_load_dwordx4 v209, s[48:51], s84 offen offset:3072 sc1 lds
    s_waitcnt lgkmcnt(6)
    v_mfma_f32_32x32x16_bf16 a[96:111], v[168:171], v[152:155], a[96:111]
    ds_read_b64_tr_b16 v[164:165], v7 offset:0
    ds_read_b64_tr_b16 v[166:167], v7 offset:1024
    v_mfma_f32_32x32x16_bf16 a[96:111], v[172:175], v[156:159], a[96:111]
    ds_read_b64_tr_b16 v[168:169], v7 offset:2048
    ds_read_b64_tr_b16 v[170:171], v7 offset:3072
    buffer_load_dwordx4 v[32:35], v209, s[48:51], s92 offen offset:0 sc1
    v_mfma_f32_32x32x16_bf16 a[112:127], v[176:179], v[144:147], a[112:127]
    ds_read_b64_tr_b16 v[172:173], v7 offset:4096
    ds_read_b64_tr_b16 v[174:175], v7 offset:5120
    s_waitcnt lgkmcnt(6)
    v_mfma_f32_32x32x16_bf16 a[112:127], v[180:183], v[148:151], a[112:127]
    ds_read_b64_tr_b16 v[176:177], v7 offset:6144
    ds_read_b64_tr_b16 v[178:179], v7 offset:7168
    buffer_load_dwordx4 v[36:39], v209, s[48:51], s92 offen offset:1024 sc1
    s_add_u32 s92, s28, 0
    v_mfma_f32_32x32x16_bf16 a[112:127], v[184:187], v[152:155], a[112:127]
    s_waitcnt vmcnt(21)
    s_waitcnt lgkmcnt(0)
    s_barrier
    v_add_u32 v206, 0, v209
    ds_read_b128 v[180:183], v206 offset:0
    s_mov_b32 s84, s24
    s_add_u32 m0, s72, 81920
    s_nop 0
    buffer_load_dwordx4 v209, s[48:51], s84 offen offset:0 sc1 lds
    v_mfma_f32_32x32x16_bf16 a[112:127], v[160:163], v[156:159], a[112:127]
    ds_read_b128 v[184:187], v206 offset:1024
    v_mfma_f32_32x32x16_bf16 a[128:143], v[164:167], v[144:147], a[128:143]
    ds_read_b128 v[160:163], v206 offset:2048
    buffer_load_dwordx4 v209, s[48:51], s84 offen offset:1024 sc1 lds
    v_mfma_f32_32x32x16_bf16 a[128:143], v[168:171], v[148:151], a[128:143]
    ds_read_b128 v[164:167], v206 offset:30720
    buffer_load_dwordx4 v209, s[48:51], s84 offen offset:2048 sc1 lds
    v_mfma_f32_32x32x16_bf16 a[128:143], v[172:175], v[152:155], a[128:143]
    ds_read_b128 v[168:171], v206 offset:3072
    s_waitcnt lgkmcnt(3)
    v_mfma_f32_32x32x16_bf16 a[128:143], v[176:179], v[156:159], a[128:143]
    ds_read_b128 v[172:175], v206 offset:4096
    buffer_load_dwordx4 v209, s[48:51], s84 offen offset:3072 sc1 lds
    s_add_u32 m0, s72, 86016
    s_add_u32 s84, s84, 4096
    v_mfma_f32_32x32x16_bf16 a[48:63], v[180:183], a[0:3], 0
    ds_read_b128 v[176:179], v206 offset:5120
    s_waitcnt vmcnt(14)
    ds_read_b64 a[192:193], v220 offset:72
    ds_read_b64 a[194:195], v221 offset:104
    v_mfma_f32_32x32x16_bf16 a[64:79], v[184:187], a[0:3], 0
    ds_read_b128 v[180:183], v206 offset:31744
    ds_read_b64 a[196:197], v218 offset:72
    ds_read_b64 a[198:199], v219 offset:104
    v_accvgpr_read_b32 v136, a80
    v_accvgpr_read_b32 v137, a81
    v_accvgpr_read_b32 v138, a82
    s_waitcnt lgkmcnt(7)
    v_mfma_f32_32x32x16_bf16 a[224:239], v[160:163], a[0:3], 0
    ds_read_b128 v[184:187], v206 offset:6144
    ds_read_b64 v[224:225], v218 offset:0
    ds_read_b32 v226, v219 offset:32
    v_accvgpr_read_b32 v139, a83
    v_accvgpr_read_b32 v140, a84
    v_accvgpr_read_b32 v141, a85
    v_mfma_f32_32x32x16_bf16 a[240:255], v[164:167], a[0:3], 0
    ds_read_b128 v[160:163], v206 offset:7168
    buffer_load_dwordx4 v209, s[48:51], s84 offen offset:0 sc1 lds
    buffer_load_dwordx4 v209, s[48:51], s84 offen offset:1024 sc1 lds
    v_accvgpr_read_b32 v142, a86
    v_accvgpr_read_b32 v143, a87
    v_mfma_f32_32x32x16_bf16 a[48:63], v[168:171], a[4:7], a[48:63]
    ds_read_b128 v[164:167], v206 offset:8192
    buffer_load_dwordx4 v209, s[48:51], s84 offen offset:2048 sc1 lds
    v_mul_f32 v136, v136, |v136|
    v_mul_f32 v137, v137, |v137|
    v_mul_f32 v138, v138, |v138|
    v_mul_f32 v139, v139, |v139|
    s_waitcnt lgkmcnt(7)
    v_mfma_f32_32x32x16_bf16 a[64:79], v[172:175], a[4:7], a[64:79]
    ds_read_b128 v[168:171], v206 offset:32768
    v_mul_f32 v140, v140, |v140|
    v_mul_f32 v141, v141, |v141|
    v_mul_f32 v142, v142, |v142|
    v_mul_f32 v143, v143, |v143|
    v_mfma_f32_32x32x16_bf16 a[224:239], v[176:179], a[4:7], a[224:239]
    ds_read_b128 v[172:175], v206 offset:9216
    buffer_load_dwordx4 v209, s[48:51], s84 offen offset:3072 sc1 lds
    s_add_u32 m0, s72, 90112
    s_add_u32 s84, s84, 4096
    v_cvt_pk_bf16_f32 v144, v136, v137
    v_cvt_pk_bf16_f32 v145, v138, v139
    v_mfma_f32_32x32x16_bf16 a[240:255], v[180:183], a[4:7], a[240:255]
    ds_read_b128 v[176:179], v206 offset:10240
    buffer_load_dwordx4 v209, s[48:51], s84 offen offset:0 sc1 lds
    v_cvt_pk_bf16_f32 v146, v140, v141
    v_cvt_pk_bf16_f32 v147, v142, v143
    v_pk_max_i16 v144, v144, 0
    s_waitcnt lgkmcnt(3)
    v_mfma_f32_32x32x16_bf16 a[48:63], v[184:187], a[8:11], a[48:63]
    ds_read_b128 v[180:183], v206 offset:11264
    v_pk_max_i16 v145, v145, 0
    v_pk_max_i16 v146, v146, 0
    v_pk_max_i16 v147, v147, 0
    v_accvgpr_read_b32 v136, a88
    v_accvgpr_read_b32 v137, a89
    v_mfma_f32_32x32x16_bf16 a[64:79], v[160:163], a[8:11], a[64:79]
    ds_read_b128 v[184:187], v206 offset:33792
    buffer_load_dwordx4 v209, s[48:51], s84 offen offset:1024 sc1 lds
    v_accvgpr_read_b32 v138, a90
    v_accvgpr_read_b32 v139, a91
    v_accvgpr_read_b32 v140, a92
    v_mfma_f32_32x32x16_bf16 a[224:239], v[164:167], a[8:11], a[224:239]
    ds_read_b128 v[160:163], v206 offset:12288
    buffer_load_dwordx4 v[40:43], v209, s[48:51], s92 offen offset:0 sc1
    v_accvgpr_read_b32 v141, a93
    v_accvgpr_read_b32 v142, a94
    v_accvgpr_read_b32 v143, a95
    v_mul_f32 v136, v136, |v136|
    s_waitcnt lgkmcnt(3)
    v_mfma_f32_32x32x16_bf16 a[240:255], v[168:171], a[8:11], a[240:255]
    ds_read_b128 v[164:167], v206 offset:13312
    v_mul_f32 v137, v137, |v137|
    v_mul_f32 v138, v138, |v138|
    v_mul_f32 v139, v139, |v139|
    v_mul_f32 v140, v140, |v140|
    v_mfma_f32_32x32x16_bf16 a[48:63], v[172:175], a[12:15], a[48:63]
    ds_read_b128 v[168:171], v206 offset:14336
    buffer_load_dwordx4 v[44:47], v209, s[48:51], s92 offen offset:1024 sc1
    v_mul_f32 v141, v141, |v141|
    v_mul_f32 v142, v142, |v142|
    v_mul_f32 v143, v143, |v143|
    v_cvt_pk_bf16_f32 v148, v136, v137
    v_mfma_f32_32x32x16_bf16 a[64:79], v[176:179], a[12:15], a[64:79]
    ds_read_b128 v[172:175], v206 offset:34816
    v_cvt_pk_bf16_f32 v149, v138, v139
    v_cvt_pk_bf16_f32 v150, v140, v141
    v_cvt_pk_bf16_f32 v151, v142, v143
    v_pk_max_i16 v148, v148, 0
    s_waitcnt lgkmcnt(3)
    v_mfma_f32_32x32x16_bf16 a[224:239], v[180:183], a[12:15], a[224:239]
    ds_read_b128 v[176:179], v206 offset:15360
    buffer_load_dwordx4 v[48:51], v209, s[48:51], s92 offen offset:2048 sc1
    v_pk_max_i16 v149, v149, 0
    v_pk_max_i16 v150, v150, 0
    v_pk_max_i16 v151, v151, 0
    s_add_u32 s94, s14, 10240
    v_mfma_f32_32x32x16_bf16 a[240:255], v[184:187], a[12:15], a[240:255]
    ds_read_b128 v[180:183], v206 offset:16384
    buffer_store_dwordx4 v[144:147], v209, s[48:51], s94 offen sc1
    buffer_store_dwordx4 v[148:151], v209, s[48:51], s94 offen offset:1024 sc1
    v_accvgpr_write_b32 a80, v144
    v_accvgpr_write_b32 a81, v145
    v_mfma_f32_32x32x16_bf16 a[48:63], v[160:163], a[16:19], a[48:63]
    ds_read_b128 v[184:187], v206 offset:17408
    v_accvgpr_write_b32 a82, v146
    v_accvgpr_write_b32 a83, v147
    v_accvgpr_write_b32 a84, v148
    v_accvgpr_write_b32 a85, v149
    v_accvgpr_write_b32 a86, v150
    s_waitcnt lgkmcnt(3)
    v_mfma_f32_32x32x16_bf16 a[64:79], v[164:167], a[16:19], a[64:79]
    ds_read_b128 v[160:163], v206 offset:35840
    v_accvgpr_write_b32 a87, v151
    v_mov_b32 v227, 0
    v_mfma_f32_32x32x16_bf16 a[224:239], v[168:171], a[16:19], a[224:239]
    ds_read_b128 v[164:167], v206 offset:18432
    ds_read_b64 a[200:201], v220 offset:112
    ds_read_b64 a[202:203], v221 offset:104
    v_accvgpr_read_b32 v136, a96
    v_accvgpr_read_b32 v137, a97
    v_accvgpr_read_b32 v138, a98
    v_mfma_f32_32x32x16_bf16 a[240:255], v[172:175], a[16:19], a[240:255]
    ds_read_b128 v[168:171], v206 offset:19456
    ds_read_b64 a[204:205], v218 offset:112
    ds_read_b64 a[206:207], v219 offset:104
    v_accvgpr_read_b32 v139, a99
    v_accvgpr_read_b32 v140, a100
    v_accvgpr_read_b32 v141, a101
    s_waitcnt lgkmcnt(7)
    v_mfma_f32_32x32x16_bf16 a[48:63], v[176:179], a[20:23], a[48:63]
    ds_read_b128 v[172:175], v206 offset:20480
    ds_read_b64 v[228:229], v218 offset:40
    ds_read_b32 v231, v219 offset:36
    v_accvgpr_read_b32 v142, a102
    v_accvgpr_read_b32 v143, a103
    v_mfma_f32_32x32x16_bf16 a[64:79], v[180:183], a[20:23], a[64:79]
    ds_read_b128 v[176:179], v206 offset:36864
    buffer_load_dwordx4 v[52:55], v209, s[48:51], s92 offen offset:3072 sc1
    v_mul_f32 v136, v136, |v136|
    v_mul_f32 v137, v137, |v137|
    v_mul_f32 v138, v138, |v138|
    v_mul_f32 v139, v139, |v139|
    v_mfma_f32_32x32x16_bf16 a[224:239], v[184:187], a[20:23], a[224:239]
    ds_read_b128 v[180:183], v206 offset:21504
    v_mul_f32 v140, v140, |v140|
    v_mul_f32 v141, v141, |v141|
    v_mul_f32 v142, v142, |v142|
    v_mul_f32 v143, v143, |v143|
    s_waitcnt lgkmcnt(7)
    v_mfma_f32_32x32x16_bf16 a[240:255], v[160:163], a[20:23], a[240:255]
    ds_read_b128 v[184:187], v206 offset:22528
    v_cvt_pk_bf16_f32 v144, v136, v137
    v_cvt_pk_bf16_f32 v145, v138, v139
    v_cvt_pk_bf16_f32 v146, v140, v141
    v_cvt_pk_bf16_f32 v147, v142, v143
    v_pk_max_i16 v144, v144, 0
    v_mfma_f32_32x32x16_bf16 a[48:63], v[164:167], a[24:27], a[48:63]
    ds_read_b128 v[160:163], v206 offset:23552
    v_pk_max_i16 v145, v145, 0
    v_pk_max_i16 v146, v146, 0
    v_pk_max_i16 v147, v147, 0
    v_accvgpr_read_b32 v136, a104
    v_mfma_f32_32x32x16_bf16 a[64:79], v[168:171], a[24:27], a[64:79]
    ds_read_b128 v[164:167], v206 offset:37888
    v_accvgpr_read_b32 v137, a105
    v_accvgpr_read_b32 v138, a106
    v_accvgpr_read_b32 v139, a107
    v_accvgpr_read_b32 v140, a108
    v_accvgpr_read_b32 v141, a109
    s_waitcnt lgkmcnt(3)
    v_mfma_f32_32x32x16_bf16 a[224:239], v[172:175], a[24:27], a[224:239]
    ds_read_b128 v[168:171], v206 offset:24576
    v_accvgpr_read_b32 v142, a110
    v_accvgpr_read_b32 v143, a111
    v_mul_f32 v136, v136, |v136|
    v_mul_f32 v137, v137, |v137|
    v_mfma_f32_32x32x16_bf16 a[240:255], v[176:179], a[24:27], a[240:255]
    ds_read_b128 v[172:175], v206 offset:25600
    v_mul_f32 v138, v138, |v138|
    v_mul_f32 v139, v139, |v139|
    v_mul_f32 v140, v140, |v140|
    v_mul_f32 v141, v141, |v141|
    v_mul_f32 v142, v142, |v142|
    v_mfma_f32_32x32x16_bf16 a[48:63], v[180:183], a[28:31], a[48:63]
    ds_read_b128 v[176:179], v206 offset:26624
    v_mul_f32 v143, v143, |v143|
    v_cvt_pk_bf16_f32 v148, v136, v137
    v_cvt_pk_bf16_f32 v149, v138, v139
    v_cvt_pk_bf16_f32 v150, v140, v141
    s_waitcnt lgkmcnt(3)
    v_mfma_f32_32x32x16_bf16 a[64:79], v[184:187], a[28:31], a[64:79]
    ds_read_b128 v[180:183], v206 offset:38912
    v_cvt_pk_bf16_f32 v151, v142, v143
    v_pk_max_i16 v148, v148, 0
    v_pk_max_i16 v149, v149, 0
    v_pk_max_i16 v150, v150, 0
    v_pk_max_i16 v151, v151, 0
    v_mfma_f32_32x32x16_bf16 a[224:239], v[160:163], a[28:31], a[224:239]
    ds_read_b128 v[184:187], v206 offset:27648
    s_add_u32 s94, s14, 12288
    buffer_store_dwordx4 v[144:147], v209, s[48:51], s94 offen sc1
    buffer_store_dwordx4 v[148:151], v209, s[48:51], s94 offen offset:1024 sc1
    v_accvgpr_write_b32 a88, v144
    v_mfma_f32_32x32x16_bf16 a[240:255], v[164:167], a[28:31], a[240:255]
    ds_read_b128 v[160:163], v206 offset:28672
    v_accvgpr_write_b32 a89, v145
    v_accvgpr_write_b32 a90, v146
    v_accvgpr_write_b32 a91, v147
    v_accvgpr_write_b32 a92, v148
    v_accvgpr_write_b32 a93, v149
    s_waitcnt lgkmcnt(3)
    v_mfma_f32_32x32x16_bf16 a[48:63], v[168:171], a[32:35], a[48:63]
    ds_read_b128 v[164:167], v206 offset:29696
    v_accvgpr_write_b32 a94, v150
    v_accvgpr_write_b32 a95, v151
    v_mov_b32 v230, 0
    s_add_u32 s92, s28, 4096
    v_mfma_f32_32x32x16_bf16 a[64:79], v[172:175], a[32:35], a[64:79]
    ds_read_b128 v[168:171], v206 offset:39936
    ds_read_b64_tr_b16 a[208:209], v223 offset:144
    ds_read_b64_tr_b16 a[210:211], v222 offset:144
    v_accvgpr_read_b32 v136, a112
    v_accvgpr_read_b32 v137, a113
    v_accvgpr_read_b32 v138, a114
    v_mfma_f32_32x32x16_bf16 a[224:239], v[176:179], a[32:35], a[224:239]
    s_waitcnt vmcnt(20)
    s_waitcnt lgkmcnt(0)
    s_barrier
    v_add_u32 v206, 40960, v209
    ds_read_b128 v[172:175], v206 offset:0
    ds_read_b64_tr_b16 a[212:213], v223 offset:184
    ds_read_b64_tr_b16 a[214:215], v222 offset:184
    s_mov_b32 s84, s25
    s_add_u32 m0, s73, 0
    v_mfma_f32_32x32x16_bf16 a[240:255], v[180:183], a[32:35], a[240:255]
    ds_read_b128 v[176:179], v206 offset:1024
    ds_read_b64_tr_b16 a[216:217], v223 offset:176
    ds_read_b64_tr_b16 a[218:219], v222 offset:176
    v_accvgpr_read_b32 v139, a115
    v_accvgpr_read_b32 v140, a116
    v_accvgpr_read_b32 v141, a117
    v_mfma_f32_32x32x16_bf16 a[48:63], v[184:187], a[36:39], a[48:63]
    ds_read_b128 v[180:183], v206 offset:2048
    buffer_load_dwordx4 v209, s[48:51], s84 offen offset:0 sc1 lds
    buffer_load_dwordx4 v209, s[48:51], s84 offen offset:1024 sc1 lds
    v_accvgpr_read_b32 v142, a118
    v_accvgpr_read_b32 v143, a119
    v_mfma_f32_32x32x16_bf16 a[64:79], v[160:163], a[36:39], a[64:79]
    ds_read_b128 v[184:187], v206 offset:3072
    buffer_load_dwordx4 v209, s[48:51], s84 offen offset:2048 sc1 lds
    v_mul_f32 v136, v136, |v136|
    v_mul_f32 v137, v137, |v137|
    v_mul_f32 v138, v138, |v138|
    v_mul_f32 v139, v139, |v139|
    s_waitcnt lgkmcnt(7)
    v_mfma_f32_32x32x16_bf16 a[224:239], v[164:167], a[36:39], a[224:239]
    ds_read_b128 v[160:163], v206 offset:4096
    buffer_load_dwordx4 v209, s[48:51], s84 offen offset:3072 sc1 lds
    s_add_u32 m0, s73, 4096
    s_add_u32 s84, s84, 4096
    v_mul_f32 v140, v140, |v140|
    v_mfma_f32_32x32x16_bf16 a[240:255], v[168:171], a[36:39], a[240:255]
    ds_read_b128 v[164:167], v206 offset:5120
    v_mul_f32 v141, v141, |v141|
    v_mul_f32 v142, v142, |v142|
    v_mul_f32 v143, v143, |v143|
    v_cvt_pk_bf16_f32 v144, v136, v137
    v_cvt_pk_bf16_f32 v145, v138, v139
    v_mfma_f32_32x32x16_bf16 a[48:63], v[172:175], a[144:147], a[48:63]
    ds_read_b128 v[168:171], v206 offset:6144
    buffer_load_dwordx4 v209, s[48:51], s84 offen offset:0 sc1 lds
    v_cvt_pk_bf16_f32 v146, v140, v141
    v_cvt_pk_bf16_f32 v147, v142, v143
    v_pk_max_i16 v144, v144, 0
    s_waitcnt lgkmcnt(3)
    v_mfma_f32_32x32x16_bf16 a[64:79], v[176:179], a[144:147], a[64:79]
    ds_read_b128 v[172:175], v206 offset:7168
    buffer_load_dwordx4 v209, s[48:51], s84 offen offset:1024 sc1 lds
    v_pk_max_i16 v145, v145, 0
    v_pk_max_i16 v146, v146, 0
    v_pk_max_i16 v147, v147, 0
    v_accvgpr_read_b32 v136, a120
    v_mfma_f32_32x32x16_bf16 a[224:239], v[180:183], a[144:147], a[224:239]
    ds_read_b128 v[176:179], v206 offset:8192
    v_accvgpr_read_b32 v137, a121
    v_accvgpr_read_b32 v138, a122
    v_accvgpr_read_b32 v139, a123
    v_accvgpr_read_b32 v140, a124
    v_mfma_f32_32x32x16_bf16 a[48:63], v[184:187], a[148:151], a[48:63]
    ds_read_b128 v[180:183], v206 offset:9216
    buffer_load_dwordx4 v209, s[48:51], s84 offen offset:2048 sc1 lds
    v_accvgpr_read_b32 v141, a125
    v_accvgpr_read_b32 v142, a126
    v_accvgpr_read_b32 v143, a127
    v_mul_f32 v136, v136, |v136|
    s_waitcnt lgkmcnt(3)
    v_mfma_f32_32x32x16_bf16 a[64:79], v[160:163], a[148:151], a[64:79]
    ds_read_b128 v[184:187], v206 offset:10240
    v_mul_f32 v137, v137, |v137|
    v_mul_f32 v138, v138, |v138|
    v_mul_f32 v139, v139, |v139|
    v_mul_f32 v140, v140, |v140|
    v_mfma_f32_32x32x16_bf16 a[224:239], v[164:167], a[148:151], a[224:239]
    ds_read_b128 v[160:163], v206 offset:11264
    buffer_load_dwordx4 v209, s[48:51], s84 offen offset:3072 sc1 lds
    v_mul_f32 v141, v141, |v141|
    v_mul_f32 v142, v142, |v142|
    v_mul_f32 v143, v143, |v143|
    v_cvt_pk_bf16_f32 v148, v136, v137
    v_mfma_f32_32x32x16_bf16 a[48:63], v[168:171], a[152:155], a[48:63]
    ds_read_b128 v[164:167], v206 offset:12288
    buffer_load_dwordx4 v[56:59], v209, s[48:51], s92 offen offset:0 sc1
    v_cvt_pk_bf16_f32 v149, v138, v139
    v_cvt_pk_bf16_f32 v150, v140, v141
    v_cvt_pk_bf16_f32 v151, v142, v143
    s_waitcnt lgkmcnt(3)
    v_mfma_f32_32x32x16_bf16 a[64:79], v[172:175], a[152:155], a[64:79]
    ds_read_b128 v[168:171], v206 offset:13312
    v_pk_max_i16 v148, v148, 0
    v_pk_max_i16 v149, v149, 0
    v_pk_max_i16 v150, v150, 0
    v_pk_max_i16 v151, v151, 0
    s_add_u32 s94, s14, 14336
    v_mfma_f32_32x32x16_bf16 a[224:239], v[176:179], a[152:155], a[224:239]
    ds_read_b128 v[172:175], v206 offset:14336
    buffer_store_dwordx4 v[144:147], v209, s[48:51], s94 offen sc1
    buffer_store_dwordx4 v[148:151], v209, s[48:51], s94 offen offset:1024 sc1
    v_accvgpr_write_b32 a96, v144
    v_accvgpr_write_b32 a97, v145
    v_mfma_f32_32x32x16_bf16 a[48:63], v[180:183], a[156:159], a[48:63]
    ds_read_b128 v[176:179], v206 offset:15360
    v_accvgpr_write_b32 a98, v146
    v_accvgpr_write_b32 a99, v147
    v_accvgpr_write_b32 a100, v148
    v_accvgpr_write_b32 a101, v149
    v_accvgpr_write_b32 a102, v150
    s_waitcnt lgkmcnt(3)
    v_mfma_f32_32x32x16_bf16 a[64:79], v[184:187], a[156:159], a[64:79]
    ds_read_b128 v[180:183], v206 offset:16384
    v_accvgpr_write_b32 a103, v151
    v_cndmask_b32 v226, 0, v226, s[32:33]
    v_cndmask_b32 v231, 0, v231, s[32:33]
    v_and_b32 v252, v254, v252
    v_mfma_f32_32x32x16_bf16 a[224:239], v[160:163], a[156:159], a[224:239]
    ds_read_b128 v[184:187], v206 offset:17408
    buffer_load_dwordx4 v[60:63], v209, s[48:51], s92 offen offset:1024 sc1
    v_accvgpr_read_b32 v136, a128
    v_accvgpr_read_b32 v137, a129
    v_accvgpr_read_b32 v138, a130
    v_accvgpr_read_b32 v139, a131
    v_mfma_f32_32x32x16_bf16 a[48:63], v[164:167], a[160:163], a[48:63]
    ds_read_b128 v[160:163], v206 offset:18432
    v_accvgpr_read_b32 v140, a132
    v_accvgpr_read_b32 v141, a133
    v_accvgpr_read_b32 v142, a134
    v_accvgpr_read_b32 v143, a135
    s_waitcnt lgkmcnt(3)
    v_mfma_f32_32x32x16_bf16 a[64:79], v[168:171], a[160:163], a[64:79]
    ds_read_b128 v[164:167], v206 offset:19456
    buffer_load_dwordx4 v[64:67], v209, s[48:51], s92 offen offset:2048 sc1
    v_mul_f32 v136, v136, |v136|
    v_mul_f32 v137, v137, |v137|
    v_mul_f32 v138, v138, |v138|
    v_mul_f32 v139, v139, |v139|
    v_mfma_f32_32x32x16_bf16 a[224:239], v[172:175], a[160:163], a[224:239]
    ds_read_b128 v[168:171], v206 offset:20480
    buffer_load_dwordx4 v[68:71], v209, s[48:51], s92 offen offset:3072 sc1
    v_mul_f32 v140, v140, |v140|
    v_mul_f32 v141, v141, |v141|
    v_mul_f32 v142, v142, |v142|
    v_mfma_f32_32x32x16_bf16 a[48:63], v[176:179], a[164:167], a[48:63]
    ds_read_b128 v[172:175], v206 offset:21504
    v_mul_f32 v143, v143, |v143|
    v_cvt_pk_bf16_f32 v144, v136, v137
    v_cvt_pk_bf16_f32 v145, v138, v139
    v_cvt_pk_bf16_f32 v146, v140, v141
    v_cvt_pk_bf16_f32 v147, v142, v143
    s_waitcnt lgkmcnt(3)
    v_mfma_f32_32x32x16_bf16 a[64:79], v[180:183], a[164:167], a[64:79]
    ds_read_b128 v[176:179], v206 offset:22528
    v_pk_max_i16 v144, v144, 0
    v_pk_max_i16 v145, v145, 0
    v_pk_max_i16 v146, v146, 0
    v_pk_max_i16 v147, v147, 0
    v_mfma_f32_32x32x16_bf16 a[224:239], v[184:187], a[164:167], a[224:239]
    ds_read_b128 v[180:183], v206 offset:23552
    v_accvgpr_read_b32 v136, a136
    v_accvgpr_read_b32 v137, a137
    v_accvgpr_read_b32 v138, a138
    v_accvgpr_read_b32 v139, a139
    v_accvgpr_read_b32 v140, a140
    v_mfma_f32_32x32x16_bf16 a[48:63], v[160:163], a[168:171], a[48:63]
    ds_read_b128 v[184:187], v206 offset:24576
    v_accvgpr_read_b32 v141, a141
    v_accvgpr_read_b32 v142, a142
    v_accvgpr_read_b32 v143, a143
    v_mul_f32 v136, v136, |v136|
    s_waitcnt lgkmcnt(3)
    v_mfma_f32_32x32x16_bf16 a[64:79], v[164:167], a[168:171], a[64:79]
    ds_read_b128 v[160:163], v206 offset:25600
    v_mul_f32 v137, v137, |v137|
    v_mul_f32 v138, v138, |v138|
    v_mul_f32 v139, v139, |v139|
    v_mul_f32 v140, v140, |v140|
    v_mul_f32 v141, v141, |v141|
    v_mfma_f32_32x32x16_bf16 a[224:239], v[168:171], a[168:171], a[224:239]
    ds_read_b128 v[164:167], v206 offset:26624
    v_mul_f32 v142, v142, |v142|
    v_mul_f32 v143, v143, |v143|
    v_cvt_pk_bf16_f32 v148, v136, v137
    v_cvt_pk_bf16_f32 v149, v138, v139
    v_mfma_f32_32x32x16_bf16 a[48:63], v[172:175], a[172:175], a[48:63]
    ds_read_b128 v[168:171], v206 offset:27648
    v_cvt_pk_bf16_f32 v150, v140, v141
    v_cvt_pk_bf16_f32 v151, v142, v143
    v_pk_max_i16 v148, v148, 0
    v_pk_max_i16 v149, v149, 0
    v_pk_max_i16 v150, v150, 0
    s_waitcnt lgkmcnt(3)
    v_mfma_f32_32x32x16_bf16 a[64:79], v[176:179], a[172:175], a[64:79]
    ds_read_b128 v[172:175], v206 offset:28672
    v_pk_max_i16 v151, v151, 0
    s_add_u32 s94, s14, 16384
    v_mul_f32 v252, v252, v252
    v_mfma_f32_16x16x32_bf16 v[232:235], a[192:195], v[224:227], v[188:191]
    v_mfma_f32_16x16x32_bf16 v[236:239], a[196:199], v[224:227], v[192:195]
    v_mfma_f32_16x16x32_bf16 v[240:243], a[200:203], v[228:231], v[188:191]
    v_mfma_f32_16x16x32_bf16 v[244:247], a[204:207], v[228:231], v[192:195]
    s_add_u32 s92, s28, 8192
    v_mfma_f32_32x32x16_bf16 a[224:239], v[180:183], a[172:175], a[224:239]
    ds_read_b128 v[176:179], v206 offset:29696
    buffer_store_dwordx4 v[144:147], v209, s[48:51], s94 offen sc1
    buffer_store_dwordx4 v[148:151], v209, s[48:51], s94 offen offset:1024 sc1
    v_accvgpr_write_b32 a104, v144
    v_accvgpr_write_b32 a105, v145
    v_accvgpr_write_b32 a106, v146
    v_mfma_f32_32x32x16_bf16 a[48:63], v[184:187], a[176:179], a[48:63]
    s_waitcnt vmcnt(24)
    s_waitcnt lgkmcnt(0)
    s_barrier
    v_add_u32 v206, 81920, v209
    ds_read_b128 v[180:183], v206 offset:0
    s_add_u32 s84, s22, s75
    s_add_u32 m0, s73, 40960
    s_nop 0
    buffer_load_dwordx4 v209, s[48:51], s84 offen offset:0 sc1 lds
    v_accvgpr_write_b32 a107, v147
    v_mfma_f32_32x32x16_bf16 a[64:79], v[160:163], a[176:179], a[64:79]
    ds_read_b128 v[184:187], v206 offset:1024
    buffer_load_dwordx4 v209, s[48:51], s84 offen offset:1024 sc1 lds
    v_accvgpr_write_b32 a108, v148
    v_accvgpr_write_b32 a109, v149
    v_accvgpr_write_b32 a110, v150
    v_accvgpr_write_b32 a111, v151
    v_mfma_f32_32x32x16_bf16 a[224:239], v[164:167], a[176:179], a[224:239]
    ds_read_b128 v[160:163], v206 offset:2048
    v_max3_f32 v248, v232, v233, v234
    v_max3_f32 v200, v235, v236, v237
    v_max3_f32 v248, v248, v238, v239
    v_max_f32 v248, v248, v200
    v_mfma_f32_32x32x16_bf16 a[48:63], v[168:171], a[180:183], a[48:63]
    ds_read_b128 v[164:167], v206 offset:30720
    buffer_load_dwordx4 v209, s[48:51], s84 offen offset:2048 sc1 lds
    v_max3_f32 v249, v240, v241, v242
    v_max3_f32 v205, v243, v244, v245
    v_max3_f32 v249, v249, v246, v247
    v_max_f32 v249, v249, v205
    s_waitcnt lgkmcnt(3)
    v_mfma_f32_32x32x16_bf16 a[64:79], v[172:175], a[180:183], a[64:79]
    ds_read_b128 v[168:171], v206 offset:3072
    buffer_load_dwordx4 v209, s[48:51], s84 offen offset:3072 sc1 lds
    s_add_u32 m0, s73, 45056
    s_add_u32 s84, s84, 4096
    v_mov_b32 v205, 0x3eae1a93
    v_mfma_f32_32x32x16_bf16 a[224:239], v[176:179], a[180:183], a[224:239]
    ds_read_b128 v[172:175], v206 offset:4096
    v_permlane16_swap_b32 v248, v249
    v_max_f32 v248, v248, v249
    v_mov_b32 v249, v248
    v_mfma_f32_32x32x16_bf16 a[48:63], v[180:183], a[184:187], a[48:63]
    ds_read_b128 v[176:179], v206 offset:5120
    buffer_load_dwordx4 v209, s[48:51], s84 offen offset:0 sc1 lds
    v_permlane32_swap_b32 v248, v249
    v_max_f32 v248, v248, v249
    v_mul_f32 v248, 0xbeae1a93, v248
    s_waitcnt lgkmcnt(3)
    v_mfma_f32_32x32x16_bf16 a[64:79], v[184:187], a[184:187], a[64:79]
    ds_read_b128 v[180:183], v206 offset:31744
    v_mov_b32 v249, v248
    v_mfma_f32_32x32x16_bf16 a[224:239], v[160:163], a[184:187], a[224:239]
    ds_read_b128 v[184:187], v206 offset:6144
    buffer_load_dwordx4 v209, s[48:51], s84 offen offset:1024 sc1 lds
    v_permlane16_swap_b32 v248, v249
    v_fma_f32 v232, v232, v205, v248
    v_fma_f32 v233, v233, v205, v248
    v_mfma_f32_32x32x16_bf16 a[240:255], v[164:167], a[184:187], a[240:255]
    ds_read_b128 v[160:163], v206 offset:7168
    buffer_load_dwordx4 v209, s[48:51], s84 offen offset:2048 sc1 lds
    v_fma_f32 v234, v234, v205, v248
    v_fma_f32 v235, v235, v205, v248
    v_fma_f32 v236, v236, v205, v248
    v_fma_f32 v237, v237, v205, v248
    s_waitcnt lgkmcnt(3)
    v_mfma_f32_32x32x16_bf16 a[48:63], v[168:171], a[188:191], a[48:63]
    ds_read_b128 v[164:167], v206 offset:8192
    v_fma_f32 v238, v238, v205, v248
    v_fma_f32 v239, v239, v205, v248
    v_exp_f32 v232, v232
    v_mfma_f32_32x32x16_bf16 a[64:79], v[172:175], a[188:191], a[64:79]
    ds_read_b128 v[168:171], v206 offset:32768
    buffer_load_dwordx4 v209, s[48:51], s84 offen offset:3072 sc1 lds
    v_exp_f32 v233, v233
    v_exp_f32 v234, v234
    v_mfma_f32_32x32x16_bf16 a[224:239], v[176:179], a[188:191], a[224:239]
    ds_read_b128 v[172:175], v206 offset:9216
    buffer_load_dwordx4 v[72:75], v209, s[48:51], s92 offen offset:0 sc1
    v_exp_f32 v235, v235
    s_waitcnt lgkmcnt(3)
    v_mfma_f32_32x32x16_bf16 a[240:255], v[180:183], a[188:191], a[240:255]
    ds_read_b128 v[176:179], v206 offset:10240
    v_exp_f32 v236, v236
    v_exp_f32 v237, v237
    v_mfma_f32_32x32x16_bf16 a[48:63], v[184:187], a[40:43], a[48:63]
    ds_read_b128 v[180:183], v206 offset:11264
    buffer_load_dwordx4 v[76:79], v209, s[48:51], s92 offen offset:1024 sc1
    v_exp_f32 v238, v238
    v_exp_f32 v239, v239
    v_mfma_f32_32x32x16_bf16 a[64:79], v[160:163], a[40:43], a[64:79]
    ds_read_b128 v[184:187], v206 offset:33792
    v_fma_f32 v240, v240, v205, v249
    v_fma_f32 v241, v241, v205, v249
    v_fma_f32 v242, v242, v205, v249
    v_fma_f32 v243, v243, v205, v249
    v_fma_f32 v244, v244, v205, v249
    s_waitcnt lgkmcnt(3)
    v_mfma_f32_32x32x16_bf16 a[224:239], v[164:167], a[40:43], a[224:239]
    ds_read_b128 v[160:163], v206 offset:12288
    v_fma_f32 v245, v245, v205, v249
    v_fma_f32 v246, v246, v205, v249
    v_fma_f32 v247, v247, v205, v249
    v_mfma_f32_32x32x16_bf16 a[240:255], v[168:171], a[40:43], a[240:255]
    ds_read_b128 v[164:167], v206 offset:13312
    v_exp_f32 v240, v240
    v_exp_f32 v241, v241
    v_mfma_f32_32x32x16_bf16 a[48:63], v[172:175], a[44:47], a[48:63]
    ds_read_b128 v[168:171], v206 offset:14336
    v_exp_f32 v242, v242
    v_exp_f32 v243, v243
    s_waitcnt lgkmcnt(3)
    v_mfma_f32_32x32x16_bf16 a[64:79], v[176:179], a[44:47], a[64:79]
    ds_read_b128 v[172:175], v206 offset:34816
    v_exp_f32 v244, v244
    v_exp_f32 v245, v245
    v_mfma_f32_32x32x16_bf16 a[224:239], v[180:183], a[44:47], a[224:239]
    ds_read_b128 v[176:179], v206 offset:15360
    v_exp_f32 v246, v246
    v_exp_f32 v247, v247
    v_cvt_pk_bf16_f32 v196, v232, v233
    v_mfma_f32_32x32x16_bf16 a[240:255], v[184:187], a[44:47], a[240:255]
    ds_read_b128 v[180:183], v206 offset:16384
    v_cvt_pk_bf16_f32 v197, v234, v235
    v_cvt_pk_bf16_f32 v198, v236, v237
    v_cvt_pk_bf16_f32 v199, v238, v239
    v_cvt_pk_bf16_f32 v214, v240, v241
    v_cvt_pk_bf16_f32 v215, v242, v243
    s_waitcnt lgkmcnt(3)
    v_mfma_f32_32x32x16_bf16 a[48:63], v[160:163], v[16:19], a[48:63]
    ds_read_b128 v[184:187], v206 offset:17408
    v_cvt_pk_bf16_f32 v216, v244, v245
    v_cvt_pk_bf16_f32 v217, v246, v247
    v_mfma_f32_16x16x32_bf16 v[224:227], a[220:223], v[196:199], 0
    v_mfma_f32_16x16x32_bf16 v[232:235], a[208:211], v[196:199], 0
    v_mfma_f32_16x16x32_bf16 v[236:239], a[216:219], v[196:199], 0
    v_mfma_f32_16x16x32_bf16 v[228:231], a[220:223], v[214:217], 0
    v_mfma_f32_16x16x32_bf16 v[240:243], a[212:215], v[214:217], 0
    v_mfma_f32_16x16x32_bf16 v[244:247], a[216:219], v[214:217], 0
    v_mfma_f32_32x32x16_bf16 a[64:79], v[164:167], v[16:19], a[64:79]
    ds_read_b128 v[160:163], v206 offset:35840
    s_nop 0
    v_rcp_f32 v248, v224
    s_nop 1
    v_rcp_f32 v249, v228
    v_mul_f32 v248, v248, v252
    v_mfma_f32_32x32x16_bf16 a[224:239], v[168:171], v[16:19], a[224:239]
    ds_read_b128 v[164:167], v206 offset:18432
    v_mul_f32 v249, v249, v252
    v_mul_f32 v232, v232, v248
    v_mul_f32 v233, v233, v248
    v_mul_f32 v234, v234, v248
    v_mul_f32 v235, v235, v248
    s_waitcnt lgkmcnt(3)
    v_mfma_f32_32x32x16_bf16 a[240:255], v[172:175], v[16:19], a[240:255]
    ds_read_b128 v[168:171], v206 offset:19456
    v_mul_f32 v236, v236, v248
    v_mul_f32 v237, v237, v248
    v_mul_f32 v240, v240, v249
    v_mul_f32 v241, v241, v249
    v_mfma_f32_32x32x16_bf16 a[48:63], v[176:179], v[20:23], a[48:63]
    ds_read_b128 v[172:175], v206 offset:20480
    v_mul_f32 v242, v242, v249
    v_mul_f32 v243, v243, v249
    v_mul_f32 v246, v246, v249
    v_mul_f32 v247, v247, v249
    v_cvt_pk_bf16_f32 v224, v232, v233
    v_mfma_f32_32x32x16_bf16 a[64:79], v[180:183], v[20:23], a[64:79]
    ds_read_b128 v[176:179], v206 offset:36864
    v_cvt_pk_bf16_f32 v225, v234, v235
    v_cvt_pk_bf16_f32 v228, v236, v237
    v_cvt_pk_bf16_f32 v226, v240, v241
    v_cvt_pk_bf16_f32 v227, v242, v243
    s_waitcnt lgkmcnt(3)
    v_mfma_f32_32x32x16_bf16 a[224:239], v[184:187], v[20:23], a[224:239]
    ds_read_b128 v[180:183], v206 offset:21504
    v_cvt_pk_bf16_f32 v229, v246, v247
    v_mfma_f32_32x32x16_bf16 a[240:255], v[160:163], v[20:23], a[240:255]
    ds_read_b128 v[184:187], v206 offset:22528
    buffer_store_dwordx2 v[224:225], v2, s[48:51], s88 offen offset:0 sc1
    buffer_store_dwordx2 v[226:227], v2, s[48:51], s88 offen offset:1024 sc1
    v_mfma_f32_32x32x16_bf16 a[48:63], v[164:167], v[24:27], a[48:63]
    ds_read_b128 v[160:163], v206 offset:23552
    buffer_store_dwordx2 v[228:229], v213, s[48:51], s89 offen offset:0 sc1
    s_waitcnt lgkmcnt(3)
    v_mfma_f32_32x32x16_bf16 a[64:79], v[168:171], v[24:27], a[64:79]
    ds_read_b128 v[164:167], v206 offset:37888
    v_mfma_f32_32x32x16_bf16 a[224:239], v[172:175], v[24:27], a[224:239]
    ds_read_b128 v[168:171], v206 offset:24576
    v_mfma_f32_32x32x16_bf16 a[240:255], v[176:179], v[24:27], a[240:255]
    ds_read_b128 v[172:175], v206 offset:25600
    s_waitcnt lgkmcnt(3)
    v_mfma_f32_32x32x16_bf16 a[48:63], v[180:183], v[28:31], a[48:63]
    ds_read_b128 v[176:179], v206 offset:26624
    v_mfma_f32_32x32x16_bf16 a[64:79], v[184:187], v[28:31], a[64:79]
    ds_read_b128 v[180:183], v206 offset:38912
    v_mfma_f32_32x32x16_bf16 a[224:239], v[160:163], v[28:31], a[224:239]
    ds_read_b128 v[184:187], v206 offset:27648
    s_waitcnt lgkmcnt(3)
    v_mfma_f32_32x32x16_bf16 a[240:255], v[164:167], v[28:31], a[240:255]
    ds_read_b128 v[160:163], v206 offset:28672
    s_lshl_b32 s94, s7, 3
    s_add_u32 s94, s94, s10
    s_waitcnt vmcnt(13)
    buffer_store_dwordx2 v[12:13], v207, s[48:51], s94 offen offset:32 sc1
    v_mfma_f32_32x32x16_bf16 a[48:63], v[168:171], v[32:35], a[48:63]
    ds_read_b128 v[164:167], v206 offset:29696
    v_mfma_f32_32x32x16_bf16 a[64:79], v[172:175], v[32:35], a[64:79]
    ds_read_b128 v[168:171], v206 offset:39936
    s_waitcnt lgkmcnt(3)
    v_mfma_f32_32x32x16_bf16 a[224:239], v[176:179], v[32:35], a[224:239]
    s_waitcnt lgkmcnt(0)
    s_barrier
    v_add_u32 v206, 0, v209
    ds_read_b128 v[172:175], v206 offset:0
    s_add_u32 s84, s23, s76
    s_add_u32 m0, s0, 122880
    s_nop 0
    buffer_load_dwordx4 v209, s[48:51], s84 offen offset:0 sc1 lds
    buffer_load_dwordx4 v209, s[48:51], s84 offen offset:1024 sc1 lds
    v_mfma_f32_32x32x16_bf16 a[240:255], v[180:183], v[32:35], a[240:255]
    ds_read_b128 v[176:179], v206 offset:1024
    buffer_load_dwordx4 v209, s[48:51], s84 offen offset:2048 sc1 lds
    v_mfma_f32_32x32x16_bf16 a[48:63], v[184:187], v[36:39], a[48:63]
    ds_read_b128 v[180:183], v206 offset:2048
    buffer_load_dwordx4 v209, s[48:51], s84 offen offset:3072 sc1 lds
    s_add_u32 m0, s0, 126976
    s_add_u32 s84, s84, 4096
    v_mfma_f32_32x32x16_bf16 a[64:79], v[160:163], v[36:39], a[64:79]
    ds_read_b128 v[184:187], v206 offset:3072
    v_mfma_f32_32x32x16_bf16 a[224:239], v[164:167], v[36:39], a[224:239]
    ds_read_b128 v[160:163], v206 offset:4096
    buffer_load_dwordx4 v209, s[48:51], s84 offen offset:0 sc1 lds
    v_mfma_f32_32x32x16_bf16 a[240:255], v[168:171], v[36:39], a[240:255]
    ds_read_b128 v[164:167], v206 offset:5120
    buffer_load_dwordx4 v209, s[48:51], s84 offen offset:1024 sc1 lds
    s_add_u32 s84, s24, s75
    s_add_u32 m0, s73, 81920
    s_waitcnt lgkmcnt(3)
    v_mfma_f32_32x32x16_bf16 a[48:63], v[172:175], v[40:43], a[48:63]
    ds_read_b128 v[168:171], v206 offset:6144
    v_mfma_f32_32x32x16_bf16 a[64:79], v[176:179], v[40:43], a[64:79]
    ds_read_b128 v[172:175], v206 offset:7168
    buffer_load_dwordx4 v209, s[48:51], s84 offen offset:0 sc1 lds
    v_mfma_f32_32x32x16_bf16 a[224:239], v[180:183], v[40:43], a[224:239]
    ds_read_b128 v[176:179], v206 offset:8192
    s_waitcnt lgkmcnt(3)
    v_mfma_f32_32x32x16_bf16 a[48:63], v[184:187], v[44:47], a[48:63]
    ds_read_b128 v[180:183], v206 offset:9216
    buffer_load_dwordx4 v209, s[48:51], s84 offen offset:1024 sc1 lds
    v_mfma_f32_32x32x16_bf16 a[64:79], v[160:163], v[44:47], a[64:79]
    ds_read_b128 v[184:187], v206 offset:10240
    buffer_load_dwordx4 v209, s[48:51], s84 offen offset:2048 sc1 lds
    v_mfma_f32_32x32x16_bf16 a[224:239], v[164:167], v[44:47], a[224:239]
    ds_read_b128 v[160:163], v206 offset:11264
    s_waitcnt lgkmcnt(3)
    v_mfma_f32_32x32x16_bf16 a[48:63], v[168:171], v[48:51], a[48:63]
    ds_read_b128 v[164:167], v206 offset:12288
    buffer_load_dwordx4 v209, s[48:51], s84 offen offset:3072 sc1 lds
    s_add_u32 m0, s73, 86016
    s_add_u32 s84, s84, 4096
    v_mfma_f32_32x32x16_bf16 a[64:79], v[172:175], v[48:51], a[64:79]
    ds_read_b128 v[168:171], v206 offset:13312
    buffer_load_dwordx4 v209, s[48:51], s84 offen offset:0 sc1 lds
    v_mfma_f32_32x32x16_bf16 a[224:239], v[176:179], v[48:51], a[224:239]
    ds_read_b128 v[172:175], v206 offset:14336
    s_waitcnt lgkmcnt(3)
    v_mfma_f32_32x32x16_bf16 a[48:63], v[180:183], v[52:55], a[48:63]
    ds_read_b128 v[176:179], v206 offset:15360
    buffer_load_dwordx4 v209, s[48:51], s84 offen offset:1024 sc1 lds
    v_mfma_f32_32x32x16_bf16 a[64:79], v[184:187], v[52:55], a[64:79]
    ds_read_b128 v[180:183], v206 offset:16384
    v_mfma_f32_32x32x16_bf16 a[224:239], v[160:163], v[52:55], a[224:239]
    ds_read_b128 v[184:187], v206 offset:17408
    buffer_load_dwordx4 v209, s[48:51], s84 offen offset:2048 sc1 lds
    v_add_u32 v15, 32, v15
    s_waitcnt lgkmcnt(3)
    v_mfma_f32_32x32x16_bf16 a[48:63], v[164:167], v[56:59], a[48:63]
    ds_read_b128 v[160:163], v206 offset:18432
    buffer_load_dwordx2 v[8:9], v15, s[48:51], 0 offen sc1
    v_mfma_f32_32x32x16_bf16 a[64:79], v[168:171], v[56:59], a[64:79]
    ds_read_b128 v[164:167], v206 offset:19456
    buffer_load_dwordx4 v209, s[48:51], s84 offen offset:3072 sc1 lds
    v_mfma_f32_32x32x16_bf16 a[224:239], v[172:175], v[56:59], a[224:239]
    ds_read_b128 v[168:171], v206 offset:20480
    s_waitcnt lgkmcnt(3)
    v_mfma_f32_32x32x16_bf16 a[48:63], v[176:179], v[60:63], a[48:63]
    ds_read_b128 v[172:175], v206 offset:21504
    v_mfma_f32_32x32x16_bf16 a[64:79], v[180:183], v[60:63], a[64:79]
    ds_read_b128 v[176:179], v206 offset:22528
    v_mfma_f32_32x32x16_bf16 a[224:239], v[184:187], v[60:63], a[224:239]
    ds_read_b128 v[180:183], v206 offset:23552
    s_waitcnt lgkmcnt(3)
    v_mfma_f32_32x32x16_bf16 a[48:63], v[160:163], v[64:67], a[48:63]
    ds_read_b128 v[184:187], v206 offset:24576
    v_mfma_f32_32x32x16_bf16 a[64:79], v[164:167], v[64:67], a[64:79]
    ds_read_b128 v[160:163], v206 offset:25600
    s_lshl_b32 s88, s7, 3
    s_add_u32 s88, s88, s10
    s_waitcnt vmcnt(16)
    buffer_store_dwordx2 v[12:13], v207, s[48:51], s88 offen offset:64 sc1
    v_lshrrev_b32 v2, 2, v1
    v_mul_u32_u24 v2, 1152, v2
    v_mfma_f32_32x32x16_bf16 a[224:239], v[168:171], v[64:67], a[224:239]
    ds_read_b128 v[164:167], v206 offset:26624
    v_and_b32 v3, 3, v1
    v_lshlrev_b32 v3, 4, v3
    v_add_u32 v4, v2, v3
    s_lshr_b32 s86, s7, 1
    s_mul_i32 s86, s86, 576
    s_waitcnt lgkmcnt(3)
    v_mfma_f32_32x32x16_bf16 a[48:63], v[172:175], v[68:71], a[48:63]
    ds_read_b128 v[168:171], v206 offset:27648
    s_and_b32 s87, s7, 1
    s_mul_i32 s88, s87, 320
    s_add_u32 s88, s88, s86
    s_lshl_b32 s89, s6, 6
    v_mfma_f32_32x32x16_bf16 a[64:79], v[176:179], v[68:71], a[64:79]
    ds_read_b128 v[172:175], v206 offset:28672
    s_add_u32 s88, s88, s89
    s_add_u32 s20, s29, s88
    buffer_load_dwordx4 v[238:241], v4, s[40:43], s20 offen
    s_add_u32 s89, s20, 18432
    buffer_load_dwordx4 v[242:245], v4, s[40:43], s89 offen
    v_mfma_f32_32x32x16_bf16 a[224:239], v[180:183], v[68:71], a[224:239]
    ds_read_b128 v[176:179], v206 offset:29696
    buffer_load_dwordx4 v[246:249], v3, s[56:59], s88 offen
    v_and_b32 v2, 15, v1
    v_bfe_u32 v3, v1, 4, 1
    v_lshlrev_b32 v3, 3, v3
    s_waitcnt lgkmcnt(3)
    v_mfma_f32_32x32x16_bf16 a[48:63], v[184:187], v[72:75], a[48:63]
    s_waitcnt lgkmcnt(0)
    s_barrier
    v_add_u32 v206, 40960, v209
    ds_read_b128 v[180:183], v206 offset:0
    s_add_u32 s84, s25, s76
    s_add_u32 m0, s0, 0
    s_nop 0
    buffer_load_dwordx4 v209, s[48:51], s84 offen offset:0 sc1 lds
    v_mul_u32_u24 v7, 1152, v2
    v_add_u32 v7, v7, v3
    v_mfma_f32_32x32x16_bf16 a[64:79], v[160:163], v[72:75], a[64:79]
    ds_read_b128 v[184:187], v206 offset:1024
    v_mov_b32 v5, 0x40000000
    v_cmp_gt_u32 vcc, 32, v1
    s_nop 1
    v_cndmask_b32 v5, v5, v7, vcc
    s_lshl_b32 s88, s5, 2
    v_mfma_f32_32x32x16_bf16 a[224:239], v[164:167], v[72:75], a[224:239]
    ds_read_b128 v[160:163], v206 offset:2048
    buffer_load_dwordx4 v209, s[48:51], s84 offen offset:1024 sc1 lds
    s_add_u32 s88, s88, s6
    s_lshl_b32 s88, s88, 1
    s_add_u32 s88, s88, s87
    s_lshl_b32 s89, s88, 6
    v_mfma_f32_32x32x16_bf16 a[48:63], v[168:171], v[76:79], a[48:63]
    ds_read_b128 v[164:167], v206 offset:24576
    buffer_load_dwordx4 v209, s[48:51], s84 offen offset:2048 sc1 lds
    s_add_u32 s89, s89, 32768
    v_lshlrev_b32 v2, 2, v2
    v_mfma_f32_32x32x16_bf16 a[64:79], v[172:175], v[76:79], a[64:79]
    ds_read_b128 v[168:171], v206 offset:3072
    buffer_load_dword v6, v2, s[48:51], s89 offen sc1
    s_mul_i32 s88, s88, 18432
    s_lshl_b32 s89, s4, 4
    s_add_u32 s89, s89, s86
    s_add_u32 s89, s89, 256
    v_mfma_f32_32x32x16_bf16 a[224:239], v[176:179], v[76:79], a[224:239]
    ds_read_b128 v[172:175], v206 offset:4096
    buffer_load_dwordx4 v209, s[48:51], s84 offen offset:3072 sc1 lds
    s_add_u32 s21, s88, s89
    buffer_load_dwordx2 v[250:251], v5, s[40:43], s21 offen
    s_add_u32 m0, s0, 4096
    s_add_u32 s84, s84, 4096
    s_waitcnt lgkmcnt(3)
    v_mfma_f32_32x32x16_bf16 a[48:63], v[180:183], a[80:83], a[48:63]
    ds_read_b128 v[176:179], v206 offset:5120
    buffer_load_dwordx2 v[252:253], v3, s[56:59], s89 offen
    v_mfma_f32_32x32x16_bf16 a[64:79], v[184:187], a[80:83], a[64:79]
    ds_read_b128 v[180:183], v206 offset:25600
    v_mfma_f32_32x32x16_bf16 a[224:239], v[160:163], a[80:83], a[224:239]
    ds_read_b128 v[184:187], v206 offset:6144
    buffer_load_dwordx4 v209, s[48:51], s84 offen offset:0 sc1 lds
    s_waitcnt lgkmcnt(3)
    v_mfma_f32_32x32x16_bf16 a[240:255], v[164:167], a[80:83], a[240:255]
    ds_read_b128 v[160:163], v206 offset:7168
    v_mfma_f32_32x32x16_bf16 a[48:63], v[168:171], a[84:87], a[48:63]
    ds_read_b128 v[164:167], v206 offset:8192
    buffer_load_dwordx4 v209, s[48:51], s84 offen offset:1024 sc1 lds
    v_mfma_f32_32x32x16_bf16 a[64:79], v[172:175], a[84:87], a[64:79]
    ds_read_b128 v[168:171], v206 offset:26624
    s_waitcnt lgkmcnt(3)
    v_mfma_f32_32x32x16_bf16 a[224:239], v[176:179], a[84:87], a[224:239]
    ds_read_b128 v[172:175], v206 offset:9216
    s_waitcnt vmcnt(14)
L_PC4:
    v_cmp_ne_u64 s[78:79], s[82:83], v[8:9]
    s_nop 3
    s_cmp_lg_u64 s[78:79], 0
    s_cbranch_scc1 L_PS4
L_PR4:
    s_add_u32 s92, s26, 10240
    v_mfma_f32_32x32x16_bf16 a[240:255], v[180:183], a[84:87], a[240:255]
    ds_read_b128 v[176:179], v206 offset:10240
    buffer_load_dwordx4 v[80:83], v209, s[48:51], s92 offen offset:0 sc1
    buffer_load_dwordx4 v[84:87], v209, s[48:51], s92 offen offset:1024 sc1
    v_mfma_f32_32x32x16_bf16 a[48:63], v[184:187], a[88:91], a[48:63]
    ds_read_b128 v[180:183], v206 offset:11264
    buffer_load_dwordx4 v[88:91], v209, s[48:51], s92 offen offset:2048 sc1
    s_waitcnt lgkmcnt(3)
    v_mfma_f32_32x32x16_bf16 a[64:79], v[160:163], a[88:91], a[64:79]
    ds_read_b128 v[184:187], v206 offset:27648
    v_mfma_f32_32x32x16_bf16 a[224:239], v[164:167], a[88:91], a[224:239]
    ds_read_b128 v[160:163], v206 offset:12288
    buffer_load_dwordx4 v[92:95], v209, s[48:51], s92 offen offset:3072 sc1
    s_add_u32 s92, s26, 14336
    v_mfma_f32_32x32x16_bf16 a[240:255], v[168:171], a[88:91], a[240:255]
    ds_read_b128 v[164:167], v206 offset:13312
    s_waitcnt lgkmcnt(3)
    v_mfma_f32_32x32x16_bf16 a[48:63], v[172:175], a[92:95], a[48:63]
    ds_read_b128 v[168:171], v206 offset:14336
    buffer_load_dwordx4 v[96:99], v209, s[48:51], s92 offen offset:0 sc1
    v_mfma_f32_32x32x16_bf16 a[64:79], v[176:179], a[92:95], a[64:79]
    ds_read_b128 v[172:175], v206 offset:28672
    buffer_load_dwordx4 v[100:103], v209, s[48:51], s92 offen offset:1024 sc1
    v_mfma_f32_32x32x16_bf16 a[224:239], v[180:183], a[92:95], a[224:239]
    ds_read_b128 v[176:179], v206 offset:15360
    s_waitcnt lgkmcnt(3)
    v_mfma_f32_32x32x16_bf16 a[240:255], v[184:187], a[92:95], a[240:255]
    ds_read_b128 v[180:183], v206 offset:16384
    buffer_load_dwordx4 v[104:107], v209, s[48:51], s92 offen offset:2048 sc1
    v_mfma_f32_32x32x16_bf16 a[48:63], v[160:163], a[96:99], a[48:63]
    ds_read_b128 v[184:187], v206 offset:17408
    v_mfma_f32_32x32x16_bf16 a[64:79], v[164:167], a[96:99], a[64:79]
    ds_read_b128 v[160:163], v206 offset:29696
    buffer_load_dwordx4 v[108:111], v209, s[48:51], s92 offen offset:3072 sc1
    s_add_u32 s92, s27, 10240
    s_waitcnt lgkmcnt(3)
    v_mfma_f32_32x32x16_bf16 a[224:239], v[168:171], a[96:99], a[224:239]
    ds_read_b128 v[164:167], v206 offset:18432
    buffer_load_dwordx4 v[112:115], v209, s[48:51], s92 offen offset:0 sc1
    v_mfma_f32_32x32x16_bf16 a[240:255], v[172:175], a[96:99], a[240:255]
    ds_read_b128 v[168:171], v206 offset:19456
    v_mfma_f32_32x32x16_bf16 a[48:63], v[176:179], a[100:103], a[48:63]
    ds_read_b128 v[172:175], v206 offset:20480
    buffer_load_dwordx4 v[116:119], v209, s[48:51], s92 offen offset:1024 sc1
    s_waitcnt lgkmcnt(3)
    v_mfma_f32_32x32x16_bf16 a[64:79], v[180:183], a[100:103], a[64:79]
    ds_read_b128 v[176:179], v206 offset:30720
    buffer_load_dwordx4 v[120:123], v209, s[48:51], s92 offen offset:2048 sc1
    v_mfma_f32_32x32x16_bf16 a[224:239], v[184:187], a[100:103], a[224:239]
    ds_read_b128 v[180:183], v206 offset:21504
    v_mfma_f32_32x32x16_bf16 a[240:255], v[160:163], a[100:103], a[240:255]
    ds_read_b128 v[184:187], v206 offset:22528
    buffer_load_dwordx4 v[124:127], v209, s[48:51], s92 offen offset:3072 sc1
    s_add_u32 s92, s27, 14336
    s_waitcnt lgkmcnt(3)
    v_mfma_f32_32x32x16_bf16 a[48:63], v[164:167], a[104:107], a[48:63]
    ds_read_b128 v[160:163], v206 offset:23552
    v_mfma_f32_32x32x16_bf16 a[64:79], v[168:171], a[104:107], a[64:79]
    ds_read_b128 v[164:167], v206 offset:31744
    buffer_load_dwordx4 v[128:131], v209, s[48:51], s92 offen offset:0 sc1
    v_mfma_f32_32x32x16_bf16 a[224:239], v[172:175], a[104:107], a[224:239]
    s_waitcnt lgkmcnt(0)
    s_barrier
    v_add_u32 v206, 122880, v209
    ds_read_b128 v[168:171], v206 offset:0
    buffer_load_dwordx4 v[132:135], v209, s[48:51], s92 offen offset:1024 sc1
    s_add_u32 s84, s7, s4
    s_and_b32 s85, s84, 3
    s_mul_i32 s84, s85, 61440
    s_add_u32 s84, s84, s9
    v_mfma_f32_32x32x16_bf16 a[240:255], v[176:179], a[104:107], a[240:255]
    ds_read_b128 v[172:175], v206 offset:1024
    s_add_u32 s84, s84, 55296
    s_add_u32 m0, s0, 40960
    v_mfma_f32_32x32x16_bf16 a[48:63], v[180:183], a[108:111], a[48:63]
    ds_read_b128 v[176:179], v206 offset:2048
    buffer_load_dwordx4 v[136:139], v209, s[48:51], s92 offen offset:2048 sc1
    v_mfma_f32_32x32x16_bf16 a[64:79], v[184:187], a[108:111], a[64:79]
    ds_read_b128 v[180:183], v206 offset:3072
    v_and_b32 v216, 3, v1
    v_lshlrev_b32 v216, 3, v216
    s_add_u32 s90, s10, 64
    v_add_u32 v216, s90, v216
    s_waitcnt lgkmcnt(3)
    v_mfma_f32_32x32x16_bf16 a[224:239], v[160:163], a[108:111], a[224:239]
    ds_read_b128 v[184:187], v206 offset:4096
    buffer_load_dwordx4 v[140:143], v209, s[48:51], s92 offen offset:3072 sc1
    buffer_load_dwordx2 v[214:215], v216, s[48:51], 0 offen sc1
    s_add_u32 s92, s28, 10240
    v_mfma_f32_32x32x16_bf16 a[240:255], v[164:167], a[108:111], a[240:255]
    ds_read_b128 v[160:163], v206 offset:5120
    s_waitcnt vmcnt(16)
    v_mfma_f32_32x32x16_bf16 a[48:63], v[168:171], v[80:83], a[48:63]
    ds_read_b128 v[164:167], v206 offset:6144
    buffer_load_dwordx4 v209, s[48:51], s84 offen offset:0 sc1 lds
    s_waitcnt lgkmcnt(3)
    v_mfma_f32_32x32x16_bf16 a[64:79], v[172:175], v[80:83], a[64:79]
    ds_read_b128 v[168:171], v206 offset:7168
    buffer_load_dwordx4 v[144:147], v209, s[48:51], s92 offen offset:0 sc1
    v_mfma_f32_32x32x16_bf16 a[224:239], v[176:179], v[80:83], a[224:239]
    ds_read_b128 v[172:175], v206 offset:8192
    s_waitcnt vmcnt(17)
    v_mfma_f32_32x32x16_bf16 a[48:63], v[180:183], v[84:87], a[48:63]
    ds_read_b128 v[176:179], v206 offset:9216
    buffer_load_dwordx4 v209, s[48:51], s84 offen offset:1024 sc1 lds
    s_waitcnt lgkmcnt(3)
    v_mfma_f32_32x32x16_bf16 a[64:79], v[184:187], v[84:87], a[64:79]
    ds_read_b128 v[180:183], v206 offset:10240
    buffer_load_dwordx4 v[148:151], v209, s[48:51], s92 offen offset:1024 sc1
    v_mfma_f32_32x32x16_bf16 a[224:239], v[160:163], v[84:87], a[224:239]
    ds_read_b128 v[184:187], v206 offset:11264
    s_waitcnt vmcnt(18)
    v_mfma_f32_32x32x16_bf16 a[48:63], v[164:167], v[88:91], a[48:63]
    ds_read_b128 v[160:163], v206 offset:12288
    buffer_load_dwordx4 v209, s[48:51], s84 offen offset:2048 sc1 lds
    s_waitcnt lgkmcnt(3)
    v_mfma_f32_32x32x16_bf16 a[64:79], v[168:171], v[88:91], a[64:79]
    ds_read_b128 v[164:167], v206 offset:13312
    v_mfma_f32_32x32x16_bf16 a[224:239], v[172:175], v[88:91], a[224:239]
    ds_read_b128 v[168:171], v206 offset:14336
    buffer_load_dwordx4 v209, s[48:51], s84 offen offset:3072 sc1 lds
    s_add_u32 m0, s0, 45056
    s_add_u32 s84, s84, 4096
    v_lshlrev_b32 v2, 16, v246
    v_lshlrev_b32 v3, 16, v238
    s_waitcnt vmcnt(19)
    v_mfma_f32_32x32x16_bf16 a[48:63], v[176:179], v[92:95], a[48:63]
    ds_read_b128 v[172:175], v206 offset:15360
    buffer_load_dwordx4 v[152:155], v209, s[48:51], s92 offen offset:2048 sc1
    v_add_f32 v218, v2, v3
    v_lshlrev_b32 v3, 16, v242
    v_add_f32 v226, v2, v3
    v_and_b32 v2, v254, v246
    s_waitcnt lgkmcnt(3)
    v_mfma_f32_32x32x16_bf16 a[64:79], v[180:183], v[92:95], a[64:79]
    ds_read_b128 v[176:179], v206 offset:16384
    v_and_b32 v3, v254, v238
    v_add_f32 v219, v2, v3
    v_and_b32 v3, v254, v242
    v_add_f32 v227, v2, v3
    v_mfma_f32_32x32x16_bf16 a[224:239], v[184:187], v[92:95], a[224:239]
    ds_read_b128 v[180:183], v206 offset:17408
    buffer_load_dwordx4 v209, s[48:51], s84 offen offset:0 sc1 lds
    v_lshlrev_b32 v2, 16, v247
    v_lshlrev_b32 v3, 16, v239
    v_add_f32 v220, v2, v3
    v_lshlrev_b32 v3, 16, v243
    s_waitcnt vmcnt(20)
    v_mfma_f32_32x32x16_bf16 a[48:63], v[160:163], v[96:99], a[48:63]
    ds_read_b128 v[184:187], v206 offset:18432
    v_add_f32 v228, v2, v3
    v_and_b32 v2, v254, v247
    v_and_b32 v3, v254, v239
    v_add_f32 v221, v2, v3
    s_waitcnt lgkmcnt(3)
    v_mfma_f32_32x32x16_bf16 a[64:79], v[164:167], v[96:99], a[64:79]
    ds_read_b128 v[160:163], v206 offset:19456
    buffer_load_dwordx4 v[156:159], v209, s[48:51], s92 offen offset:3072 sc1
    s_add_u32 s92, s28, 14336
    v_and_b32 v3, v254, v243
    v_add_f32 v229, v2, v3
    v_lshlrev_b32 v2, 16, v248
    v_mfma_f32_32x32x16_bf16 a[224:239], v[168:171], v[96:99], a[224:239]
    ds_read_b128 v[164:167], v206 offset:20480
    buffer_load_dwordx4 v209, s[48:51], s84 offen offset:1024 sc1 lds
    s_lshr_b32 s84, s85, 1
    s_mul_i32 s84, s84, 20480
    s_add_u32 s84, s84, s9
    s_waitcnt vmcnt(21)
    v_mfma_f32_32x32x16_bf16 a[48:63], v[172:175], v[100:103], a[48:63]
    ds_read_b128 v[168:171], v206 offset:21504
    s_add_u32 s84, s84, 267264
    s_lshl_b32 s85, s4, 11
    s_add_u32 m0, s85, 65536
    v_lshlrev_b32 v3, 16, v240
    v_add_f32 v222, v2, v3
    s_waitcnt lgkmcnt(3)
    v_mfma_f32_32x32x16_bf16 a[64:79], v[176:179], v[100:103], a[64:79]
    ds_read_b128 v[172:175], v206 offset:22528
    buffer_load_dwordx4 v209, s[48:51], s84 offen offset:0 sc1 lds
    v_lshlrev_b32 v3, 16, v244
    v_add_f32 v230, v2, v3
    v_and_b32 v2, v254, v248
    v_mfma_f32_32x32x16_bf16 a[224:239], v[180:183], v[100:103], a[224:239]
    ds_read_b128 v[176:179], v206 offset:23552
    buffer_load_dwordx4 a[128:131], v209, s[48:51], s92 offen offset:0 sc1
    v_and_b32 v3, v254, v240
    v_add_f32 v223, v2, v3
    v_and_b32 v3, v254, v244
    v_add_f32 v231, v2, v3
    s_waitcnt vmcnt(22)
    v_mfma_f32_32x32x16_bf16 a[48:63], v[184:187], v[104:107], a[48:63]
    s_waitcnt lgkmcnt(0)
    s_barrier
    v_add_u32 v206, 81920, v209
    ds_read_b128 v[180:183], v206 offset:0
    v_lshlrev_b32 v2, 16, v249
    v_lshlrev_b32 v3, 16, v241
    v_add_f32 v224, v2, v3
    v_lshlrev_b32 v3, 16, v245
    v_mfma_f32_32x32x16_bf16 a[64:79], v[160:163], v[104:107], a[64:79]
    ds_read_b128 v[184:187], v206 offset:1024
    buffer_load_dwordx4 v209, s[48:51], s84 offen offset:1024 sc1 lds
    s_lshl_b32 s85, s4, 10
    s_add_u32 s84, s85, 245760
    s_cmp_eq_u32 s4, 3
    s_cselect_b32 s84, 289792, s84
    v_mfma_f32_32x32x16_bf16 a[224:239], v[164:167], v[104:107], a[224:239]
    ds_read_b128 v[160:163], v206 offset:2048
    s_add_u32 s84, s84, s9
    s_add_u32 m0, s85, 73728
    v_add_f32 v232, v2, v3
    v_and_b32 v2, v254, v249
    s_waitcnt vmcnt(22)
    v_mfma_f32_32x32x16_bf16 a[48:63], v[168:171], v[108:111], a[48:63]
    ds_read_b128 v[164:167], v206 offset:24576
    buffer_load_dwordx4 a[132:135], v209, s[48:51], s92 offen offset:1024 sc1
    v_and_b32 v3, v254, v241
    v_add_f32 v225, v2, v3
    v_and_b32 v3, v254, v245
    v_add_f32 v233, v2, v3
    s_waitcnt lgkmcnt(3)
    v_mfma_f32_32x32x16_bf16 a[64:79], v[172:175], v[108:111], a[64:79]
    ds_read_b128 v[168:171], v206 offset:3072
    buffer_load_dwordx4 v209, s[48:51], s84 offen offset:0 sc1 lds
    s_waitcnt vmcnt(15)
L_PC5:
    v_cmp_ne_u64 s[78:79], s[82:83], v[214:215]
    s_nop 3
    s_cmp_lg_u64 s[78:79], 0
    s_cbranch_scc1 L_PS5
L_PR5:
    s_add_u32 s84, s9, 372736
    s_mov_b32 m0, 77824
    s_sub_u32 s90, s10, 131072
    v_mfma_f32_32x32x16_bf16 a[224:239], v[176:179], v[108:111], a[224:239]
    ds_read_b128 v[172:175], v206 offset:4096
    s_lshl_b32 s90, s90, 3
    s_add_u32 s90, s90, 31457280
    v_lshlrev_b32 v2, 16, v250
    v_lshlrev_b32 v3, 16, v252
    v_add_f32 v234, v2, v3
    v_mfma_f32_32x32x16_bf16 a[48:63], v[180:183], v[112:115], a[48:63]
    ds_read_b128 v[176:179], v206 offset:5120
    buffer_load_dwordx4 v209, s[48:51], s84 offen offset:0 sc1 lds
    s_mov_b32 s84, s80
    s_add_u32 m0, s72, 122880
    v_and_b32 v2, v254, v250
    s_waitcnt lgkmcnt(3)
    v_mfma_f32_32x32x16_bf16 a[64:79], v[184:187], v[112:115], a[64:79]
    ds_read_b128 v[180:183], v206 offset:25600
    v_and_b32 v3, v254, v252
    v_add_f32 v235, v2, v3
    v_lshlrev_b32 v2, 16, v251
    v_lshlrev_b32 v3, 16, v253
    v_add_f32 v236, v2, v3
    v_mfma_f32_32x32x16_bf16 a[224:239], v[160:163], v[112:115], a[224:239]
    ds_read_b128 v[184:187], v206 offset:6144
    buffer_load_dwordx4 a[136:139], v209, s[48:51], s92 offen offset:2048 sc1
    v_and_b32 v2, v254, v251
    v_and_b32 v3, v254, v253
    v_add_f32 v237, v2, v3
    v_mfma_f32_32x32x16_bf16 a[240:255], v[164:167], v[112:115], a[240:255]
    ds_read_b128 v[160:163], v206 offset:7168
    buffer_load_dwordx4 a[140:143], v209, s[48:51], s92 offen offset:3072 sc1
    v_and_b32 v6, v254, v6
    v_mul_f32 v6, v6, v6
    v_rcp_f32 v6, v6
    s_waitcnt lgkmcnt(3)
    v_mfma_f32_32x32x16_bf16 a[48:63], v[168:171], v[116:119], a[48:63]
    ds_read_b128 v[164:167], v206 offset:8192
    v_mul_f32 v211, v211, v211
    s_lshl_b32 s86, s5, 2
    s_add_u32 s86, s86, s7
    s_lshl_b32 s86, s86, 18
    v_mfma_f32_32x32x16_bf16 a[64:79], v[172:175], v[116:119], a[64:79]
    ds_read_b128 v[168:171], v206 offset:26624
    buffer_load_dwordx4 v209, s[48:51], s84 offen offset:0 sc1 lds
    s_add_u32 s86, s86, 33554432
    s_lshl_b32 s88, s4, 12
    s_add_u32 s86, s86, s88
    s_lshl_b32 s88, s6, 14
    v_mfma_f32_32x32x16_bf16 a[224:239], v[176:179], v[116:119], a[224:239]
    ds_read_b128 v[172:175], v206 offset:9216
    buffer_load_dwordx4 v209, s[48:51], s84 offen offset:1024 sc1 lds
    s_add_u32 s88, s88, s86
    s_add_u32 s89, s6, 1
    s_and_b32 s89, s89, 3
    s_waitcnt lgkmcnt(3)
    v_mfma_f32_32x32x16_bf16 a[240:255], v[180:183], v[116:119], a[240:255]
    ds_read_b128 v[176:179], v206 offset:10240
    s_lshl_b32 s89, s89, 16
    s_add_u32 s17, s89, s88
    s_add_u32 s89, s6, 2
    s_and_b32 s89, s89, 3
    s_lshl_b32 s89, s89, 16
    v_mfma_f32_32x32x16_bf16 a[48:63], v[184:187], v[120:123], a[48:63]
    ds_read_b128 v[180:183], v206 offset:11264
    buffer_load_dwordx4 v209, s[48:51], s84 offen offset:2048 sc1 lds
    s_add_u32 s18, s89, s88
    s_add_u32 s89, s6, 3
    s_and_b32 s89, s89, 3
    v_mfma_f32_32x32x16_bf16 a[64:79], v[160:163], v[120:123], a[64:79]
    ds_read_b128 v[184:187], v206 offset:27648
    s_lshl_b32 s89, s89, 16
    s_add_u32 s19, s89, s88
    s_lshl_b32 s88, s5, 1
    s_lshr_b32 s89, s7, 1
    s_add_u32 s88, s88, s89
    s_waitcnt lgkmcnt(3)
    v_mfma_f32_32x32x16_bf16 a[224:239], v[164:167], v[120:123], a[224:239]
    ds_read_b128 v[160:163], v206 offset:12288
    buffer_load_dwordx4 v[188:191], v209, s[48:51], s90 offen offset:0 sc1
    s_add_u32 s90, s14, 18432
    s_lshl_b32 s97, s88, 17
    s_add_u32 s97, s97, 50331648
    v_mfma_f32_32x32x16_bf16 a[240:255], v[168:171], v[120:123], a[240:255]
    ds_read_b128 v[164:167], v206 offset:13312
    buffer_load_dwordx4 a[192:195], v209, s[48:51], s90 offen offset:0 sc1
    s_lshl_b32 s98, s6, 1
    s_add_u32 s98, s98, s87
    s_lshl_b32 s89, s98, 11
    s_add_u32 s16, s97, s89
    v_mfma_f32_32x32x16_bf16 a[48:63], v[172:175], v[124:127], a[48:63]
    ds_read_b128 v[168:171], v206 offset:14336
    s_lshl_b32 s89, s4, 15
    s_add_u32 s16, s16, s89
    s_lshl_b32 s89, s98, 14
    s_add_u32 s12, s97, s89
    s_waitcnt lgkmcnt(3)
    v_mfma_f32_32x32x16_bf16 a[64:79], v[176:179], v[124:127], a[64:79]
    ds_read_b128 v[172:175], v206 offset:28672
    buffer_load_dwordx4 a[196:199], v209, s[48:51], s90 offen offset:1024 sc1
    s_add_u32 s90, s27, 18432
    s_lshl_b32 s89, s4, 9
    s_add_u32 s12, s12, s89
    v_bfe_u32 v2, v1, 4, 1
    v_mfma_f32_32x32x16_bf16 a[224:239], v[180:183], v[124:127], a[224:239]
    ds_read_b128 v[176:179], v206 offset:15360
    buffer_load_dwordx4 a[208:211], v209, s[48:51], s90 offen offset:0 sc1
    v_lshlrev_b32 v2, 14, v2
    v_lshrrev_b32 v3, 5, v1
    v_lshl_add_u32 v2, v3, 8, v2
    v_mfma_f32_32x32x16_bf16 a[240:255], v[184:187], v[124:127], a[240:255]
    ds_read_b128 v[180:183], v206 offset:16384
    v_and_b32 v11, 15, v1
    v_lshl_add_u32 v7, v11, 4, v2
    v_lshlrev_b32 v3, 11, v3
    v_and_b32 v11, 31, v1
    v_lshl_add_u32 v3, v11, 4, v3
    s_waitcnt lgkmcnt(3)
    v_mfma_f32_32x32x16_bf16 a[48:63], v[160:163], v[128:131], a[48:63]
    ds_read_b128 v[184:187], v206 offset:17408
    buffer_load_dwordx4 a[212:215], v209, s[48:51], s90 offen offset:1024 sc1
    s_add_u32 s90, s26, 18432
    v_add_u32 v2, 8192, v3
    s_lshl_b32 s88, s6, 16
    v_mfma_f32_32x32x16_bf16 a[64:79], v[164:167], v[128:131], a[64:79]
    ds_read_b128 v[160:163], v206 offset:29696
    s_add_u32 s88, s88, s86
    s_add_u32 s89, s6, 1
    s_and_b32 s89, s89, 3
    s_lshl_b32 s89, s89, 14
    s_add_u32 s13, s89, s88
    v_mfma_f32_32x32x16_bf16 a[224:239], v[168:171], v[128:131], a[224:239]
    ds_read_b128 v[164:167], v206 offset:18432
    buffer_load_dwordx4 a[200:203], v209, s[48:51], s90 offen offset:0 sc1
    s_add_u32 s89, s6, 2
    s_and_b32 s89, s89, 3
    s_lshl_b32 s89, s89, 14
    s_waitcnt lgkmcnt(3)
    v_mfma_f32_32x32x16_bf16 a[240:255], v[172:175], v[128:131], a[240:255]
    ds_read_b128 v[168:171], v206 offset:19456
    buffer_load_dwordx4 a[204:207], v209, s[48:51], s90 offen offset:1024 sc1
    s_add_u32 s90, s28, 18432
    s_add_u32 s15, s89, s88
    s_add_u32 s89, s6, 3
    s_and_b32 s89, s89, 3
    v_mfma_f32_32x32x16_bf16 a[48:63], v[176:179], v[132:135], a[48:63]
    ds_read_b128 v[172:175], v206 offset:20480
    s_lshl_b32 s89, s89, 14
    s_add_u32 s38, s89, s88
    v_mov_b32 v199, v12
    v_mov_b32 v203, v12
    v_mfma_f32_32x32x16_bf16 a[64:79], v[180:183], v[132:135], a[64:79]
    ds_read_b128 v[176:179], v206 offset:30720
    buffer_load_dwordx4 a[216:219], v209, s[48:51], s90 offen offset:0 sc1
    v_mov_b32 v249, v12
    v_mov_b32 v253, v12
    s_waitcnt lgkmcnt(3)
    v_mfma_f32_32x32x16_bf16 a[224:239], v[184:187], v[132:135], a[224:239]
    ds_read_b128 v[180:183], v206 offset:21504
    v_mfma_f32_32x32x16_bf16 a[240:255], v[160:163], v[132:135], a[240:255]
    ds_read_b128 v[184:187], v206 offset:22528
    buffer_load_dwordx4 a[220:223], v209, s[48:51], s90 offen offset:1024 sc1
    v_mfma_f32_32x32x16_bf16 a[48:63], v[164:167], v[136:139], a[48:63]
    ds_read_b128 v[160:163], v206 offset:23552
    buffer_load_dwordx4 v209, s[48:51], s84 offen offset:3072 sc1 lds
    s_add_u32 m0, s72, 126976
    s_add_u32 s84, s84, 4096
    s_waitcnt lgkmcnt(3)
    v_mfma_f32_32x32x16_bf16 a[64:79], v[168:171], v[136:139], a[64:79]
    ds_read_b128 v[164:167], v206 offset:31744
    v_mfma_f32_32x32x16_bf16 a[224:239], v[172:175], v[136:139], a[224:239]
    s_waitcnt lgkmcnt(0)
    s_barrier
    v_add_u32 v206, 0, v209
    ds_read_b128 v[168:171], v206 offset:0
    buffer_load_dwordx4 v209, s[48:51], s84 offen offset:0 sc1 lds
    v_mfma_f32_32x32x16_bf16 a[240:255], v[176:179], v[136:139], a[240:255]
    ds_read_b128 v[172:175], v206 offset:1024
    buffer_load_dwordx4 v209, s[48:51], s84 offen offset:1024 sc1 lds
    v_mfma_f32_32x32x16_bf16 a[48:63], v[180:183], v[140:143], a[48:63]
    ds_read_b128 v[176:179], v206 offset:2048
    v_mfma_f32_32x32x16_bf16 a[64:79], v[184:187], v[140:143], a[64:79]
    ds_read_b128 v[180:183], v206 offset:3072
    buffer_load_dwordx4 v209, s[48:51], s84 offen offset:2048 sc1 lds
    v_mfma_f32_32x32x16_bf16 a[224:239], v[160:163], v[140:143], a[224:239]
    ds_read_b128 v[184:187], v206 offset:4096
    s_waitcnt lgkmcnt(3)
    v_mfma_f32_32x32x16_bf16 a[240:255], v[164:167], v[140:143], a[240:255]
    ds_read_b128 v[160:163], v206 offset:5120
    buffer_load_dwordx4 v209, s[48:51], s84 offen offset:3072 sc1 lds
    s_add_u32 m0, s72, 131072
    s_add_u32 s84, s84, 4096
    s_waitcnt vmcnt(33)
    v_mfma_f32_32x32x16_bf16 a[48:63], v[168:171], v[144:147], a[48:63]
    ds_read_b128 v[164:167], v206 offset:6144
    buffer_load_dwordx4 v209, s[48:51], s84 offen offset:0 sc1 lds
    v_mfma_f32_32x32x16_bf16 a[64:79], v[172:175], v[144:147], a[64:79]
    ds_read_b128 v[168:171], v206 offset:7168
    s_waitcnt lgkmcnt(3)
    v_mfma_f32_32x32x16_bf16 a[224:239], v[176:179], v[144:147], a[224:239]
    ds_read_b128 v[172:175], v206 offset:8192
    buffer_load_dwordx4 v209, s[48:51], s84 offen offset:1024 sc1 lds
    s_mov_b32 s84, s81
    s_add_u32 m0, s72, 81920
    s_waitcnt vmcnt(33)
    v_mfma_f32_32x32x16_bf16 a[48:63], v[180:183], v[148:151], a[48:63]
    ds_read_b128 v[176:179], v206 offset:9216
    buffer_load_dwordx4 v209, s[48:51], s84 offen offset:0 sc1 lds
    v_mfma_f32_32x32x16_bf16 a[64:79], v[184:187], v[148:151], a[64:79]
    ds_read_b128 v[180:183], v206 offset:10240
    s_waitcnt lgkmcnt(3)
    v_mfma_f32_32x32x16_bf16 a[224:239], v[160:163], v[148:151], a[224:239]
    ds_read_b128 v[184:187], v206 offset:11264
    buffer_load_dwordx4 v209, s[48:51], s84 offen offset:1024 sc1 lds
    s_waitcnt vmcnt(32)
    v_mfma_f32_32x32x16_bf16 a[48:63], v[164:167], v[152:155], a[48:63]
    ds_read_b128 v[160:163], v206 offset:12288
    s_and_b32 s90, s7, 1
    s_sub_u32 s90, s90, 1
    s_not_b32 s91, s90
    s_waitcnt vmcnt(17)
    v_cndmask_b32 v192, 0, v188, s[90:91]
    v_cndmask_b32 v193, 0, v189, s[90:91]
    v_mfma_f32_32x32x16_bf16 a[64:79], v[168:171], v[152:155], a[64:79]
    ds_read_b128 v[164:167], v206 offset:13312
    buffer_load_dwordx4 v209, s[48:51], s84 offen offset:2048 sc1 lds
    v_cndmask_b32 v194, 0, v190, s[90:91]
    v_cndmask_b32 v195, 0, v191, s[90:91]
    s_waitcnt lgkmcnt(3)
    v_mfma_f32_32x32x16_bf16 a[224:239], v[172:175], v[152:155], a[224:239]
    ds_read_b128 v[168:171], v206 offset:14336
    buffer_load_dwordx4 v209, s[48:51], s84 offen offset:3072 sc1 lds
    s_add_u32 m0, s72, 86016
    s_add_u32 s84, s84, 4096
    v_mfma_f32_32x32x16_bf16 a[48:63], v[176:179], v[156:159], a[48:63]
    ds_read_b128 v[172:175], v206 offset:15360
    v_mfma_f32_32x32x16_bf16 a[64:79], v[180:183], v[156:159], a[64:79]
    ds_read_b128 v[176:179], v206 offset:16384
    buffer_load_dwordx4 v209, s[48:51], s84 offen offset:0 sc1 lds
    s_waitcnt lgkmcnt(3)
    v_mfma_f32_32x32x16_bf16 a[224:239], v[184:187], v[156:159], a[224:239]
    ds_read_b128 v[180:183], v206 offset:17408
    v_mfma_f32_32x32x16_bf16 a[48:63], v[160:163], a[128:131], a[48:63]
    ds_read_b128 v[184:187], v206 offset:18432
    buffer_load_dwordx4 v209, s[48:51], s84 offen offset:1024 sc1 lds
    v_mfma_f32_32x32x16_bf16 a[64:79], v[164:167], a[128:131], a[64:79]
    ds_read_b128 v[160:163], v206 offset:19456
    buffer_load_dwordx4 v209, s[48:51], s84 offen offset:2048 sc1 lds
    s_waitcnt lgkmcnt(3)
    v_mfma_f32_32x32x16_bf16 a[224:239], v[168:171], a[128:131], a[224:239]
    ds_read_b128 v[164:167], v206 offset:20480
    v_mfma_f32_32x32x16_bf16 a[48:63], v[172:175], a[132:135], a[48:63]
    ds_read_b128 v[168:171], v206 offset:21504
    buffer_load_dwordx4 v209, s[48:51], s84 offen offset:3072 sc1 lds
    s_add_u32 m0, s72, 90112
    s_add_u32 s84, s84, 4096
    v_mfma_f32_32x32x16_bf16 a[64:79], v[176:179], a[132:135], a[64:79]
    ds_read_b128 v[172:175], v206 offset:22528
    buffer_load_dwordx4 v209, s[48:51], s84 offen offset:0 sc1 lds
    s_waitcnt lgkmcnt(3)
    v_mfma_f32_32x32x16_bf16 a[224:239], v[180:183], a[132:135], a[224:239]
    ds_read_b128 v[176:179], v206 offset:23552
    v_mfma_f32_32x32x16_bf16 a[48:63], v[184:187], a[136:139], a[48:63]
    s_waitcnt lgkmcnt(0)
    s_barrier
    v_add_u32 v206, 40960, v209
    ds_read_b128 v[180:183], v206 offset:24576
    buffer_load_dwordx4 v209, s[48:51], s84 offen offset:1024 sc1 lds
    v_mfma_f32_32x32x16_bf16 a[64:79], v[160:163], a[136:139], a[64:79]
    ds_read_b128 v[184:187], v206 offset:25600
    v_mfma_f32_32x32x16_bf16 a[224:239], v[164:167], a[136:139], a[224:239]
    ds_read_b128 v[160:163], v206 offset:28672
    v_mfma_f32_32x32x16_bf16 a[48:63], v[168:171], a[140:143], a[48:63]
    ds_read_b128 v[164:167], v206 offset:29696
    v_mfma_f32_32x32x16_bf16 a[64:79], v[172:175], a[140:143], a[64:79]
    ds_read_b128 v[168:171], v206 offset:35840
    s_waitcnt lgkmcnt(3)
    v_mfma_f32_32x32x16_bf16 a[224:239], v[176:179], a[140:143], a[224:239]
    ds_read_b128 v[172:175], v206 offset:0
    s_waitcnt vmcnt(24)
    v_mfma_f32_32x32x16_bf16 a[240:255], v[180:183], a[192:195], a[240:255]
    ds_read_b128 v[176:179], v206 offset:3072
    s_waitcnt vmcnt(23)
    v_mfma_f32_32x32x16_bf16 a[240:255], v[184:187], a[196:199], a[240:255]
    ds_read_b128 v[180:183], v206 offset:6144
    s_waitcnt lgkmcnt(3)
    s_waitcnt vmcnt(22)
    v_mfma_f32_32x32x16_bf16 a[240:255], v[160:163], a[208:211], a[240:255]
    ds_read_b128 v[184:187], v206 offset:9216
    s_waitcnt vmcnt(21)
    v_mfma_f32_32x32x16_bf16 a[240:255], v[164:167], a[212:215], a[240:255]
    ds_read_b128 v[160:163], v206 offset:12288
    v_mfma_f32_32x32x16_bf16 a[240:255], v[168:171], v[192:195], a[240:255]
    ds_read_b128 v[164:167], v206 offset:15360
    s_waitcnt lgkmcnt(3)
    v_mfma_f32_32x32x16_bf16 a[48:63], v[172:175], a[192:195], a[48:63]
    ds_read_b128 v[168:171], v206 offset:18432
    v_mfma_f32_32x32x16_bf16 a[48:63], v[176:179], a[196:199], a[48:63]
    ds_read_b128 v[172:175], v206 offset:21504
    s_waitcnt vmcnt(20)
    v_mfma_f32_32x32x16_bf16 a[48:63], v[180:183], a[200:203], a[48:63]
    ds_read_b128 v[176:179], v206 offset:32768
    s_nop 2
    v_accvgpr_read_b32 v238, a240
    v_accvgpr_read_b32 v239, a241
    v_accvgpr_read_b32 v240, a242
    v_accvgpr_read_b32 v241, a243
    v_accvgpr_read_b32 v242, a244
    s_waitcnt lgkmcnt(3)
    s_waitcnt vmcnt(19)
    v_mfma_f32_32x32x16_bf16 a[48:63], v[184:187], a[204:207], a[48:63]
    ds_read_b128 v[180:183], v206 offset:1024
    v_accvgpr_read_b32 v243, a245
    v_accvgpr_read_b32 v244, a246
    v_accvgpr_read_b32 v245, a247
    v_cvt_pk_bf16_f32 v196, v238, v239
    v_cvt_pk_bf16_f32 v197, v240, v241
    v_mfma_f32_32x32x16_bf16 a[48:63], v[160:163], a[208:211], a[48:63]
    ds_read_b128 v[184:187], v206 offset:4096
    v_cvt_pk_bf16_f32 v200, v242, v243
    v_cvt_pk_bf16_f32 v201, v244, v245
    v_accvgpr_read_b32 v238, a248
    v_accvgpr_read_b32 v239, a249
    v_mfma_f32_32x32x16_bf16 a[48:63], v[164:167], a[212:215], a[48:63]
    ds_read_b128 v[160:163], v206 offset:7168
    v_accvgpr_read_b32 v240, a250
    v_accvgpr_read_b32 v241, a251
    v_accvgpr_read_b32 v242, a252
    v_accvgpr_read_b32 v243, a253
    v_accvgpr_read_b32 v244, a254
    s_waitcnt lgkmcnt(3)
    s_waitcnt vmcnt(18)
    v_mfma_f32_32x32x16_bf16 a[48:63], v[168:171], a[216:219], a[48:63]
    ds_read_b128 v[164:167], v206 offset:10240
    v_accvgpr_read_b32 v245, a255
    v_cvt_pk_bf16_f32 v246, v238, v239
    v_cvt_pk_bf16_f32 v247, v240, v241
    v_cvt_pk_bf16_f32 v250, v242, v243
    s_waitcnt vmcnt(17)
    v_mfma_f32_32x32x16_bf16 a[48:63], v[172:175], a[220:223], a[48:63]
    ds_read_b128 v[168:171], v206 offset:13312
    v_cvt_pk_bf16_f32 v251, v244, v245
    v_mfma_f32_32x32x16_bf16 a[48:63], v[176:179], v[188:191], a[48:63]
    ds_read_b128 v[172:175], v206 offset:16384
    buffer_store_dwordx4 v[196:199], v7, s[48:51], s16 offen offset:0 sc1
    buffer_store_dwordx4 v[200:203], v7, s[48:51], s16 offen offset:512 sc1
    s_waitcnt lgkmcnt(3)
    v_mfma_f32_32x32x16_bf16 a[64:79], v[180:183], a[192:195], a[64:79]
    ds_read_b128 v[176:179], v206 offset:19456
    buffer_store_dwordx4 v[246:249], v7, s[48:51], s16 offen offset:1024 sc1
    buffer_store_dwordx4 v[250:253], v7, s[48:51], s16 offen offset:1536 sc1
    v_mfma_f32_32x32x16_bf16 a[64:79], v[184:187], a[196:199], a[64:79]
    ds_read_b128 v[180:183], v206 offset:22528
    v_mfma_f32_32x32x16_bf16 a[64:79], v[160:163], a[200:203], a[64:79]
    ds_read_b128 v[184:187], v206 offset:33792
    v_accvgpr_read_b32 v238, a48
    v_accvgpr_read_b32 v239, a49
    v_accvgpr_read_b32 v240, a50
    v_accvgpr_read_b32 v241, a51
    v_accvgpr_read_b32 v242, a52
    s_waitcnt lgkmcnt(3)
    v_mfma_f32_32x32x16_bf16 a[64:79], v[164:167], a[204:207], a[64:79]
    ds_read_b128 v[160:163], v206 offset:2048
    v_accvgpr_read_b32 v243, a53
    v_accvgpr_read_b32 v244, a54
    v_accvgpr_read_b32 v245, a55
    v_cvt_pk_bf16_f32 v196, v238, v239
    v_cvt_pk_bf16_f32 v197, v240, v241
    v_mfma_f32_32x32x16_bf16 a[64:79], v[168:171], a[208:211], a[64:79]
    ds_read_b128 v[164:167], v206 offset:5120
    v_cvt_pk_bf16_f32 v198, v242, v243
    v_cvt_pk_bf16_f32 v200, v244, v245
    v_accvgpr_read_b32 v238, a56
    v_accvgpr_read_b32 v239, a57
    v_mfma_f32_32x32x16_bf16 a[64:79], v[172:175], a[212:215], a[64:79]
    ds_read_b128 v[168:171], v206 offset:8192
    v_accvgpr_read_b32 v240, a58
    v_accvgpr_read_b32 v241, a59
    v_accvgpr_read_b32 v242, a60
    v_accvgpr_read_b32 v243, a61
    v_accvgpr_read_b32 v244, a62
    s_waitcnt lgkmcnt(3)
    v_mfma_f32_32x32x16_bf16 a[64:79], v[176:179], a[216:219], a[64:79]
    ds_read_b128 v[172:175], v206 offset:11264
    v_accvgpr_read_b32 v245, a63
    v_cvt_pk_bf16_f32 v201, v238, v239
    v_cvt_pk_bf16_f32 v202, v240, v241
    v_cvt_pk_bf16_f32 v246, v242, v243
    v_mfma_f32_32x32x16_bf16 a[64:79], v[180:183], a[220:223], a[64:79]
    ds_read_b128 v[176:179], v206 offset:14336
    v_cvt_pk_bf16_f32 v247, v244, v245
    v_mfma_f32_32x32x16_bf16 a[64:79], v[184:187], v[188:191], a[64:79]
    ds_read_b128 v[180:183], v206 offset:17408
    buffer_store_dwordx4 v[196:199], v209, s[48:51], s17 offen offset:0 sc1
    buffer_store_dwordx4 v[200:203], v209, s[48:51], s17 offen offset:1024 sc1
    s_waitcnt lgkmcnt(3)
    v_mfma_f32_32x32x16_bf16 a[224:239], v[160:163], a[192:195], a[224:239]
    ds_read_b128 v[184:187], v206 offset:20480
    buffer_store_dwordx4 v[246:249], v209, s[48:51], s17 offen offset:2048 sc1
    v_mfma_f32_32x32x16_bf16 a[224:239], v[164:167], a[196:199], a[224:239]
    ds_read_b128 v[160:163], v206 offset:23552
    v_mfma_f32_32x32x16_bf16 a[224:239], v[168:171], a[200:203], a[224:239]
    ds_read_b128 v[164:167], v206 offset:34816
    s_nop 0
    v_accvgpr_read_b32 v238, a64
    v_accvgpr_read_b32 v239, a65
    v_accvgpr_read_b32 v240, a66
    v_accvgpr_read_b32 v241, a67
    v_accvgpr_read_b32 v242, a68
    s_waitcnt lgkmcnt(3)
    v_mfma_f32_32x32x16_bf16 a[224:239], v[172:175], a[204:207], a[224:239]
    ds_read_b128 v[168:171], v206 offset:36864
    v_accvgpr_read_b32 v243, a69
    v_accvgpr_read_b32 v244, a70
    v_accvgpr_read_b32 v245, a71
    v_cvt_pk_bf16_f32 v196, v238, v239
    v_cvt_pk_bf16_f32 v197, v240, v241
    v_mfma_f32_32x32x16_bf16 a[224:239], v[176:179], a[208:211], a[224:239]
    s_waitcnt vmcnt(17)
    s_waitcnt lgkmcnt(0)
    s_barrier
    v_add_u32 v206, 122880, v209
    ds_read_b128 v[172:175], v206 offset:10240
    v_cvt_pk_bf16_f32 v198, v242, v243
    v_cvt_pk_bf16_f32 v200, v244, v245
    v_accvgpr_read_b32 v238, a72
    v_accvgpr_read_b32 v239, a73
    v_mfma_f32_32x32x16_bf16 a[224:239], v[180:183], a[212:215], a[224:239]
    ds_read_b128 v[176:179], v206 offset:11264
    v_accvgpr_read_b32 v240, a74
    v_accvgpr_read_b32 v241, a75
    v_accvgpr_read_b32 v242, a76
    v_accvgpr_read_b32 v243, a77
    v_accvgpr_read_b32 v244, a78
    v_mfma_f32_32x32x16_bf16 a[224:239], v[184:187], a[216:219], a[224:239]
    ds_read_b128 v[180:183], v206 offset:12288
    v_accvgpr_read_b32 v245, a79
    v_cvt_pk_bf16_f32 v201, v238, v239
    v_cvt_pk_bf16_f32 v202, v240, v241
    v_cvt_pk_bf16_f32 v246, v242, v243
    v_mfma_f32_32x32x16_bf16 a[224:239], v[160:163], a[220:223], a[224:239]
    ds_read_b128 v[184:187], v206 offset:13312
    v_cvt_pk_bf16_f32 v247, v244, v245
    v_mfma_f32_32x32x16_bf16 a[224:239], v[164:167], v[188:191], a[224:239]
    ds_read_b128 v[160:163], v206 offset:14336
    buffer_store_dwordx4 v[196:199], v209, s[48:51], s18 offen offset:0 sc1
    buffer_store_dwordx4 v[200:203], v209, s[48:51], s18 offen offset:1024 sc1
    s_waitcnt lgkmcnt(3)
    v_mfma_f32_32x32x16_bf16 a[112:127], v[168:171], v[188:191], 0
    ds_read_b128 v[164:167], v206 offset:15360
    buffer_store_dwordx4 v[246:249], v209, s[48:51], s18 offen offset:2048 sc1
    v_mfma_f32_32x32x16_bf16 a[112:127], v[172:175], v[112:115], a[112:127]
    ds_read_b128 v[168:171], v206 offset:16384
    v_mfma_f32_32x32x16_bf16 a[112:127], v[176:179], v[116:119], a[112:127]
    ds_read_b128 v[172:175], v206 offset:17408
    s_nop 0
    v_accvgpr_read_b32 v238, a224
    v_accvgpr_read_b32 v239, a225
    v_accvgpr_read_b32 v240, a226
    v_accvgpr_read_b32 v241, a227
    v_accvgpr_read_b32 v242, a228
    s_waitcnt lgkmcnt(3)
    v_mfma_f32_32x32x16_bf16 a[112:127], v[180:183], v[120:123], a[112:127]
    ds_read_b128 v[176:179], v206 offset:18432
    v_accvgpr_read_b32 v243, a229
    v_accvgpr_read_b32 v244, a230
    v_accvgpr_read_b32 v245, a231
    v_cvt_pk_bf16_f32 v196, v238, v239
    v_cvt_pk_bf16_f32 v197, v240, v241
    v_mfma_f32_32x32x16_bf16 a[112:127], v[184:187], v[124:127], a[112:127]
    ds_read_b128 v[180:183], v206 offset:19456
    v_cvt_pk_bf16_f32 v198, v242, v243
    v_cvt_pk_bf16_f32 v200, v244, v245
    v_accvgpr_read_b32 v238, a232
    v_accvgpr_read_b32 v239, a233
    v_mfma_f32_32x32x16_bf16 a[112:127], v[160:163], v[128:131], a[112:127]
    ds_read_b128 v[184:187], v206 offset:0
    v_accvgpr_read_b32 v240, a234
    v_accvgpr_read_b32 v241, a235
    v_accvgpr_read_b32 v242, a236
    v_accvgpr_read_b32 v243, a237
    v_accvgpr_read_b32 v244, a238
    s_waitcnt lgkmcnt(3)
    v_mfma_f32_32x32x16_bf16 a[112:127], v[164:167], v[132:135], a[112:127]
    ds_read_b128 v[160:163], v206 offset:1024
    v_accvgpr_read_b32 v245, a239
    v_cvt_pk_bf16_f32 v201, v238, v239
    v_cvt_pk_bf16_f32 v202, v240, v241
    v_cvt_pk_bf16_f32 v246, v242, v243
    v_mfma_f32_32x32x16_bf16 a[112:127], v[168:171], v[136:139], a[112:127]
    ds_read_b128 v[164:167], v206 offset:2048
    v_cvt_pk_bf16_f32 v247, v244, v245
    v_mfma_f32_32x32x16_bf16 a[112:127], v[172:175], v[140:143], a[112:127]
    ds_read_b128 v[168:171], v206 offset:3072
    buffer_store_dwordx4 v[196:199], v209, s[48:51], s19 offen offset:0 sc1
    buffer_store_dwordx4 v[200:203], v209, s[48:51], s19 offen offset:1024 sc1
    s_waitcnt lgkmcnt(3)
    v_mfma_f32_32x32x16_bf16 a[112:127], v[176:179], a[208:211], a[112:127]
    ds_read_b128 v[172:175], v206 offset:4096
    buffer_store_dwordx4 v[246:249], v209, s[48:51], s19 offen offset:2048 sc1
    s_add_u32 s39, s12, 4096
    v_mfma_f32_32x32x16_bf16 a[112:127], v[180:183], a[212:215], a[112:127]
    ds_read_b128 v[176:179], v206 offset:5120
    v_mfma_f32_32x32x16_bf16 a[112:127], v[184:187], a[184:187], a[112:127]
    ds_read_b128 v[180:183], v206 offset:6144
    s_waitcnt lgkmcnt(3)
    v_mfma_f32_32x32x16_bf16 a[112:127], v[160:163], a[188:191], a[112:127]
    ds_read_b128 v[184:187], v206 offset:7168
    v_mfma_f32_32x32x16_bf16 a[112:127], v[164:167], a[40:43], a[112:127]
    ds_read_b128 v[160:163], v206 offset:8192
    v_mfma_f32_32x32x16_bf16 a[112:127], v[168:171], a[44:47], a[112:127]
    ds_read_b128 v[164:167], v206 offset:9216
    s_waitcnt lgkmcnt(3)
    v_mfma_f32_32x32x16_bf16 a[112:127], v[172:175], v[16:19], a[112:127]
    ds_read_b128 v[168:171], v206 offset:30720
    v_mfma_f32_32x32x16_bf16 a[112:127], v[176:179], v[20:23], a[112:127]
    ds_read_b128 v[172:175], v206 offset:31744
    v_mfma_f32_32x32x16_bf16 a[112:127], v[180:183], v[24:27], a[112:127]
    ds_read_b128 v[176:179], v206 offset:32768
    s_waitcnt lgkmcnt(3)
    v_mfma_f32_32x32x16_bf16 a[112:127], v[184:187], v[28:31], a[112:127]
    ds_read_b128 v[180:183], v206 offset:33792
    v_mfma_f32_32x32x16_bf16 a[112:127], v[160:163], v[32:35], a[112:127]
    ds_read_b128 v[184:187], v206 offset:34816
    v_mfma_f32_32x32x16_bf16 a[112:127], v[164:167], v[36:39], a[112:127]
    ds_read_b128 v[160:163], v206 offset:35840
    s_waitcnt lgkmcnt(3)
    v_mfma_f32_32x32x16_bf16 a[112:127], v[168:171], v[144:147], a[112:127]
    ds_read_b128 v[164:167], v206 offset:36864
    v_mfma_f32_32x32x16_bf16 a[112:127], v[172:175], v[148:151], a[112:127]
    ds_read_b128 v[168:171], v206 offset:37888
    v_mfma_f32_32x32x16_bf16 a[112:127], v[176:179], v[152:155], a[112:127]
    ds_read_b128 v[172:175], v206 offset:38912
    s_waitcnt lgkmcnt(3)
    v_mfma_f32_32x32x16_bf16 a[112:127], v[180:183], v[156:159], a[112:127]
    ds_read_b128 v[176:179], v206 offset:39936
    v_mfma_f32_32x32x16_bf16 a[112:127], v[184:187], a[128:131], a[112:127]
    ds_read_b128 v[180:183], v206 offset:20480
    v_mfma_f32_32x32x16_bf16 a[112:127], v[160:163], a[132:135], a[112:127]
    ds_read_b128 v[184:187], v206 offset:21504
    s_waitcnt lgkmcnt(3)
    v_mfma_f32_32x32x16_bf16 a[112:127], v[164:167], a[136:139], a[112:127]
    ds_read_b128 v[160:163], v206 offset:22528
    v_mfma_f32_32x32x16_bf16 a[112:127], v[168:171], a[140:143], a[112:127]
    ds_read_b128 v[164:167], v206 offset:23552
    v_mfma_f32_32x32x16_bf16 a[112:127], v[172:175], a[216:219], a[112:127]
    ds_read_b128 v[168:171], v206 offset:24576
    s_waitcnt lgkmcnt(3)
    v_mfma_f32_32x32x16_bf16 a[112:127], v[176:179], a[220:223], a[112:127]
    ds_read_b128 v[172:175], v206 offset:25600
    v_mfma_f32_32x32x16_bf16 a[112:127], v[180:183], v[40:43], a[112:127]
    ds_read_b128 v[176:179], v206 offset:26624
    v_mfma_f32_32x32x16_bf16 a[112:127], v[184:187], v[44:47], a[112:127]
    ds_read_b128 v[180:183], v206 offset:27648
    s_waitcnt lgkmcnt(3)
    v_mfma_f32_32x32x16_bf16 a[112:127], v[160:163], v[48:51], a[112:127]
    ds_read_b128 v[184:187], v206 offset:28672
    v_mfma_f32_32x32x16_bf16 a[112:127], v[164:167], v[52:55], a[112:127]
    ds_read_b128 v[160:163], v206 offset:29696
    v_mfma_f32_32x32x16_bf16 a[112:127], v[168:171], v[56:59], a[112:127]
    s_waitcnt vmcnt(13)
    s_waitcnt lgkmcnt(0)
    s_barrier
    v_add_u32 v206, 81920, v209
    ds_read_b128 v[164:167], v206 offset:30720
    v_mfma_f32_32x32x16_bf16 a[112:127], v[172:175], v[60:63], a[112:127]
    ds_read_b128 v[168:171], v206 offset:31744
    v_mfma_f32_32x32x16_bf16 a[112:127], v[176:179], v[64:67], a[112:127]
    ds_read_b128 v[172:175], v206 offset:32768
    v_mfma_f32_32x32x16_bf16 a[112:127], v[180:183], v[68:71], a[112:127]
    ds_read_b128 v[176:179], v206 offset:33792
    s_waitcnt lgkmcnt(3)
    v_mfma_f32_32x32x16_bf16 a[112:127], v[184:187], v[72:75], a[112:127]
    ds_read_b128 v[180:183], v206 offset:34816
    v_mfma_f32_32x32x16_bf16 a[112:127], v[160:163], v[76:79], a[112:127]
    ds_read_b128 v[184:187], v206 offset:35840
    v_mfma_f32_32x32x16_bf16 a[112:127], v[164:167], v[80:83], a[112:127]
    ds_read_b128 v[160:163], v206 offset:36864
    s_waitcnt lgkmcnt(3)
    v_mfma_f32_32x32x16_bf16 a[112:127], v[168:171], v[84:87], a[112:127]
    ds_read_b128 v[164:167], v206 offset:37888
    v_mfma_f32_32x32x16_bf16 a[112:127], v[172:175], v[88:91], a[112:127]
    ds_read_b128 v[168:171], v206 offset:38912
    v_mfma_f32_32x32x16_bf16 a[112:127], v[176:179], v[92:95], a[112:127]
    ds_read_b128 v[172:175], v206 offset:39936
    s_waitcnt lgkmcnt(3)
    v_mfma_f32_32x32x16_bf16 a[112:127], v[180:183], v[96:99], a[112:127]
    ds_read_b128 v[176:179], v206 offset:20480
    v_mfma_f32_32x32x16_bf16 a[112:127], v[184:187], v[100:103], a[112:127]
    ds_read_b128 v[180:183], v206 offset:21504
    v_mfma_f32_32x32x16_bf16 a[112:127], v[160:163], v[104:107], a[112:127]
    ds_read_b128 v[184:187], v206 offset:22528
    s_waitcnt lgkmcnt(3)
    v_mfma_f32_32x32x16_bf16 a[112:127], v[164:167], v[108:111], a[112:127]
    ds_read_b128 v[160:163], v206 offset:23552
    v_mfma_f32_32x32x16_bf16 a[112:127], v[168:171], a[200:203], a[112:127]
    ds_read_b128 v[164:167], v206 offset:24576
    buffer_load_dwordx4 v[80:83], v209, s[48:51], s13 offen offset:0 sc1
    buffer_load_dwordx4 v[84:87], v209, s[48:51], s13 offen offset:1024 sc1
    v_mfma_f32_32x32x16_bf16 a[112:127], v[172:175], a[204:207], a[112:127]
    ds_read_b128 v[168:171], v206 offset:25600
    buffer_load_dwordx4 v[88:91], v209, s[48:51], s13 offen offset:2048 sc1
    buffer_load_dwordx4 v[92:95], v209, s[48:51], s15 offen offset:0 sc1
    s_waitcnt lgkmcnt(3)
    v_mfma_f32_32x32x16_bf16 a[112:127], v[176:179], a[144:147], a[112:127]
    ds_read_b128 v[172:175], v206 offset:26624
    buffer_load_dwordx4 v[96:99], v209, s[48:51], s15 offen offset:1024 sc1
    buffer_load_dwordx4 v[100:103], v209, s[48:51], s15 offen offset:2048 sc1
    v_mfma_f32_32x32x16_bf16 a[112:127], v[180:183], a[148:151], a[112:127]
    ds_read_b128 v[176:179], v206 offset:27648
    buffer_load_dwordx4 v[104:107], v209, s[48:51], s38 offen offset:0 sc1
    buffer_load_dwordx4 v[108:111], v209, s[48:51], s38 offen offset:1024 sc1
    v_mfma_f32_32x32x16_bf16 a[112:127], v[184:187], a[152:155], a[112:127]
    ds_read_b128 v[180:183], v206 offset:28672
    buffer_load_dwordx4 v[112:115], v209, s[48:51], s38 offen offset:2048 sc1
    buffer_load_dwordx4 v[116:119], v3, s[48:51], s12 offen sc1
    s_waitcnt lgkmcnt(3)
    v_mfma_f32_32x32x16_bf16 a[112:127], v[160:163], a[156:159], a[112:127]
    ds_read_b128 v[184:187], v206 offset:29696
    buffer_load_dwordx4 v[120:123], v3, s[48:51], s39 offen sc1
    buffer_load_dwordx4 v[124:127], v2, s[48:51], s12 offen sc1
    v_mfma_f32_32x32x16_bf16 a[112:127], v[164:167], a[160:163], a[112:127]
    ds_read_b128 v[160:163], v206 offset:10240
    buffer_load_dwordx4 v[128:131], v2, s[48:51], s39 offen sc1
    v_mfma_f32_32x32x16_bf16 a[112:127], v[168:171], a[164:167], a[112:127]
    ds_read_b128 v[164:167], v206 offset:11264
    s_waitcnt lgkmcnt(3)
    v_mfma_f32_32x32x16_bf16 a[112:127], v[172:175], a[168:171], a[112:127]
    ds_read_b128 v[168:171], v206 offset:12288
    v_mfma_f32_32x32x16_bf16 a[112:127], v[176:179], a[172:175], a[112:127]
    ds_read_b128 v[172:175], v206 offset:13312
    v_mfma_f32_32x32x16_bf16 a[112:127], v[180:183], a[176:179], a[112:127]
    ds_read_b128 v[176:179], v206 offset:14336
    s_waitcnt lgkmcnt(3)
    v_mfma_f32_32x32x16_bf16 a[112:127], v[184:187], a[180:183], a[112:127]
    ds_read_b128 v[180:183], v206 offset:15360
    v_mfma_f32_32x32x16_bf16 a[112:127], v[160:163], a[80:83], a[112:127]
    ds_read_b128 v[184:187], v206 offset:16384
    v_mfma_f32_32x32x16_bf16 a[112:127], v[164:167], a[84:87], a[112:127]
    ds_read_b128 v[160:163], v206 offset:17408
    s_waitcnt lgkmcnt(3)
    v_mfma_f32_32x32x16_bf16 a[112:127], v[168:171], a[88:91], a[112:127]
    ds_read_b128 v[164:167], v206 offset:18432
    v_mfma_f32_32x32x16_bf16 a[112:127], v[172:175], a[92:95], a[112:127]
    ds_read_b128 v[168:171], v206 offset:19456
    v_mfma_f32_32x32x16_bf16 a[112:127], v[176:179], a[96:99], a[112:127]
    ds_read_b128 v[172:175], v206 offset:0
    s_waitcnt lgkmcnt(3)
    v_mfma_f32_32x32x16_bf16 a[112:127], v[180:183], a[100:103], a[112:127]
    ds_read_b128 v[176:179], v206 offset:1024
    v_mfma_f32_32x32x16_bf16 a[112:127], v[184:187], a[104:107], a[112:127]
    ds_read_b128 v[180:183], v206 offset:2048
    v_mfma_f32_32x32x16_bf16 a[112:127], v[160:163], a[108:111], a[112:127]
    ds_read_b128 v[184:187], v206 offset:3072
    s_waitcnt lgkmcnt(3)
    v_mfma_f32_32x32x16_bf16 a[112:127], v[164:167], a[192:195], a[112:127]
    ds_read_b128 v[160:163], v206 offset:4096
    v_mfma_f32_32x32x16_bf16 a[112:127], v[168:171], a[196:199], a[112:127]
    ds_read_b128 v[164:167], v206 offset:5120
    v_mfma_f32_32x32x16_bf16 a[112:127], v[172:175], a[0:3], a[112:127]
    ds_read_b128 v[168:171], v206 offset:6144
    s_waitcnt lgkmcnt(3)
    v_mfma_f32_32x32x16_bf16 a[112:127], v[176:179], a[4:7], a[112:127]
    ds_read_b128 v[172:175], v206 offset:7168
    v_mfma_f32_32x32x16_bf16 a[112:127], v[180:183], a[8:11], a[112:127]
    ds_read_b128 v[176:179], v206 offset:8192
    v_mfma_f32_32x32x16_bf16 a[112:127], v[184:187], a[12:15], a[112:127]
    ds_read_b128 v[180:183], v206 offset:9216
    s_waitcnt lgkmcnt(3)
    v_mfma_f32_32x32x16_bf16 a[112:127], v[160:163], a[16:19], a[112:127]
    v_mfma_f32_32x32x16_bf16 a[112:127], v[164:167], a[20:23], a[112:127]
    v_mfma_f32_32x32x16_bf16 a[112:127], v[168:171], a[24:27], a[112:127]
    s_waitcnt lgkmcnt(0)
    v_mfma_f32_32x32x16_bf16 a[112:127], v[172:175], a[28:31], a[112:127]
    v_mfma_f32_32x32x16_bf16 a[112:127], v[176:179], a[32:35], a[112:127]
    v_mfma_f32_32x32x16_bf16 a[112:127], v[180:183], a[36:39], a[112:127]
    v_and_b32 v8, 31, v1
    v_mul_u32_u24 v8, 144, v8
    v_lshrrev_b32 v9, 5, v1
    v_lshl_add_u32 v8, v9, 4, v8
    s_mul_i32 s90, s4, 4608
    s_add_u32 s90, s90, 40960
    v_add_u32 v8, s90, v8
    v_lshrrev_b32 v11, 2, v1
    v_mul_u32_u24 v11, 144, v11
    v_and_b32 v15, 3, v1
    v_lshl_add_u32 v11, v15, 5, v11
    v_add_u32 v11, s90, v11
    v_accvgpr_read_b32 v16, a112
    v_accvgpr_read_b32 v17, a113
    v_accvgpr_read_b32 v18, a114
    v_accvgpr_read_b32 v19, a115
    v_accvgpr_read_b32 v20, a116
    v_accvgpr_read_b32 v21, a117
    v_accvgpr_read_b32 v22, a118
    v_accvgpr_read_b32 v23, a119
    v_accvgpr_read_b32 v24, a120
    v_accvgpr_read_b32 v25, a121
    v_accvgpr_read_b32 v26, a122
    v_accvgpr_read_b32 v27, a123
    v_accvgpr_read_b32 v28, a124
    v_accvgpr_read_b32 v29, a125
    v_accvgpr_read_b32 v30, a126
    v_accvgpr_read_b32 v31, a127
    s_waitcnt vmcnt(0)
L_RXC:
    v_xor_b32 v9, s82, v83
    v_xor_b32 v15, s82, v87
    v_xor_b32 v32, s82, v91
    v_or3_b32 v9, v9, v15, v32
    v_xor_b32 v15, s82, v95
    v_xor_b32 v32, s82, v99
    v_or3_b32 v9, v9, v15, v32
    v_xor_b32 v15, s82, v103
    v_xor_b32 v32, s82, v107
    v_or3_b32 v9, v9, v15, v32
    v_xor_b32 v15, s82, v111
    v_xor_b32 v32, s82, v115
    v_or3_b32 v9, v9, v15, v32
    v_xor_b32 v15, s82, v119
    v_xor_b32 v32, s82, v123
    v_or3_b32 v9, v9, v15, v32
    v_xor_b32 v15, s82, v127
    v_xor_b32 v32, s82, v131
    v_or3_b32 v9, v9, v15, v32
    v_cmp_ne_u32 s[78:79], 0, v9
    s_nop 3
    s_cmp_lg_u64 s[78:79], 0
    s_cbranch_scc1 L_RXS
L_RXR:
    v_lshlrev_b32 v32, 16, v80
    v_and_b32 v33, v254, v80
    v_add_f32 v16, v16, v32
    v_add_f32 v17, v17, v33
    v_lshlrev_b32 v32, 16, v81
    v_and_b32 v33, v254, v81
    v_add_f32 v18, v18, v32
    v_add_f32 v19, v19, v33
    v_lshlrev_b32 v32, 16, v82
    v_and_b32 v33, v254, v82
    v_add_f32 v20, v20, v32
    v_add_f32 v21, v21, v33
    v_lshlrev_b32 v32, 16, v84
    v_and_b32 v33, v254, v84
    v_add_f32 v22, v22, v32
    v_add_f32 v23, v23, v33
    v_lshlrev_b32 v32, 16, v85
    v_and_b32 v33, v254, v85
    v_add_f32 v24, v24, v32
    v_add_f32 v25, v25, v33
    v_lshlrev_b32 v32, 16, v86
    v_and_b32 v33, v254, v86
    v_add_f32 v26, v26, v32
    v_add_f32 v27, v27, v33
    v_lshlrev_b32 v32, 16, v88
    v_and_b32 v33, v254, v88
    v_add_f32 v28, v28, v32
    v_add_f32 v29, v29, v33
    v_lshlrev_b32 v32, 16, v89
    v_and_b32 v33, v254, v89
    v_add_f32 v30, v30, v32
    v_add_f32 v31, v31, v33
    v_lshlrev_b32 v32, 16, v92
    v_and_b32 v33, v254, v92
    v_add_f32 v16, v16, v32
    v_add_f32 v17, v17, v33
    v_lshlrev_b32 v32, 16, v93
    v_and_b32 v33, v254, v93
    v_add_f32 v18, v18, v32
    v_add_f32 v19, v19, v33
    v_lshlrev_b32 v32, 16, v94
    v_and_b32 v33, v254, v94
    v_add_f32 v20, v20, v32
    v_add_f32 v21, v21, v33
    v_lshlrev_b32 v32, 16, v96
    v_and_b32 v33, v254, v96
    v_add_f32 v22, v22, v32
    v_add_f32 v23, v23, v33
    v_lshlrev_b32 v32, 16, v97
    v_and_b32 v33, v254, v97
    v_add_f32 v24, v24, v32
    v_add_f32 v25, v25, v33
    v_lshlrev_b32 v32, 16, v98
    v_and_b32 v33, v254, v98
    v_add_f32 v26, v26, v32
    v_add_f32 v27, v27, v33
    v_lshlrev_b32 v32, 16, v100
    v_and_b32 v33, v254, v100
    v_add_f32 v28, v28, v32
    v_add_f32 v29, v29, v33
    v_lshlrev_b32 v32, 16, v101
    v_and_b32 v33, v254, v101
    v_add_f32 v30, v30, v32
    v_add_f32 v31, v31, v33
    v_lshlrev_b32 v32, 16, v104
    v_and_b32 v33, v254, v104
    v_add_f32 v16, v16, v32
    v_add_f32 v17, v17, v33
    v_lshlrev_b32 v32, 16, v105
    v_and_b32 v33, v254, v105
    v_add_f32 v18, v18, v32
    v_add_f32 v19, v19, v33
    v_lshlrev_b32 v32, 16, v106
    v_and_b32 v33, v254, v106
    v_add_f32 v20, v20, v32
    v_add_f32 v21, v21, v33
    v_lshlrev_b32 v32, 16, v108
    v_and_b32 v33, v254, v108
    v_add_f32 v22, v22, v32
    v_add_f32 v23, v23, v33
    v_lshlrev_b32 v32, 16, v109
    v_and_b32 v33, v254, v109
    v_add_f32 v24, v24, v32
    v_add_f32 v25, v25, v33
    v_lshlrev_b32 v32, 16, v110
    v_and_b32 v33, v254, v110
    v_add_f32 v26, v26, v32
    v_add_f32 v27, v27, v33
    v_lshlrev_b32 v32, 16, v112
    v_and_b32 v33, v254, v112
    v_add_f32 v28, v28, v32
    v_add_f32 v29, v29, v33
    v_lshlrev_b32 v32, 16, v113
    v_and_b32 v33, v254, v113
    v_add_f32 v30, v30, v32
    v_add_f32 v31, v31, v33
    v_mul_f32 v16, v16, v211
    v_mul_f32 v17, v17, v211
    v_mul_f32 v18, v18, v211
    v_mul_f32 v19, v19, v211
    ds_write_b128 v8, v[16:19] offset:0
    v_mul_f32 v20, v20, v211
    v_mul_f32 v21, v21, v211
    v_mul_f32 v22, v22, v211
    v_mul_f32 v23, v23, v211
    ds_write_b128 v8, v[20:23] offset:32
    v_mul_f32 v24, v24, v211
    v_mul_f32 v25, v25, v211
    v_mul_f32 v26, v26, v211
    v_mul_f32 v27, v27, v211
    ds_write_b128 v8, v[24:27] offset:64
    v_mul_f32 v28, v28, v211
    v_mul_f32 v29, v29, v211
    v_mul_f32 v30, v30, v211
    v_mul_f32 v31, v31, v211
    ds_write_b128 v8, v[28:31] offset:96
    v_lshlrev_b32 v40, 16, v116
    v_and_b32 v41, v254, v116
    v_lshlrev_b32 v42, 16, v117
    v_and_b32 v43, v254, v117
    v_lshlrev_b32 v32, 16, v120
    v_and_b32 v33, v254, v120
    v_add_f32 v40, v40, v32
    v_add_f32 v41, v41, v33
    v_lshlrev_b32 v32, 16, v121
    v_and_b32 v33, v254, v121
    v_add_f32 v42, v42, v32
    v_add_f32 v43, v43, v33
    s_waitcnt lgkmcnt(0)
    ds_read_b128 v[48:51], v11 offset:0
    ds_read_b128 v[52:55], v11 offset:16
    ds_read_b128 v[56:59], v11 offset:2304
    ds_read_b128 v[60:63], v11 offset:2320
    v_lshlrev_b32 v32, 16, v124
    v_and_b32 v33, v254, v124
    v_add_f32 v40, v40, v32
    v_add_f32 v41, v41, v33
    v_lshlrev_b32 v32, 16, v125
    v_and_b32 v33, v254, v125
    v_add_f32 v42, v42, v32
    v_add_f32 v43, v43, v33
    v_lshlrev_b32 v32, 16, v128
    v_and_b32 v33, v254, v128
    v_add_f32 v40, v40, v32
    v_add_f32 v41, v41, v33
    v_lshlrev_b32 v32, 16, v129
    v_and_b32 v33, v254, v129
    v_add_f32 v42, v42, v32
    v_add_f32 v43, v43, v33
    s_waitcnt lgkmcnt(3)
    v_add_f32 v48, v48, v218
    v_add_f32 v49, v49, v219
    v_add_f32 v50, v50, v220
    v_add_f32 v51, v51, v221
    s_waitcnt lgkmcnt(2)
    v_add_f32 v52, v52, v222
    v_add_f32 v53, v53, v223
    v_add_f32 v54, v54, v224
    v_add_f32 v55, v55, v225
    v_cvt_pk_bf16_f32 v64, v48, v49
    v_cvt_pk_bf16_f32 v65, v50, v51
    v_cvt_pk_bf16_f32 v66, v52, v53
    v_cvt_pk_bf16_f32 v67, v54, v55
    buffer_store_dwordx4 v[64:67], v4, s[60:63], s20 offen
    s_add_u32 s20, s20, 18432
    s_waitcnt lgkmcnt(1)
    v_add_f32 v56, v56, v226
    v_add_f32 v57, v57, v227
    v_add_f32 v58, v58, v228
    v_add_f32 v59, v59, v229
    s_waitcnt lgkmcnt(0)
    v_add_f32 v60, v60, v230
    v_add_f32 v61, v61, v231
    v_add_f32 v62, v62, v232
    v_add_f32 v63, v63, v233
    v_cvt_pk_bf16_f32 v68, v56, v57
    v_cvt_pk_bf16_f32 v69, v58, v59
    v_cvt_pk_bf16_f32 v70, v60, v61
    v_cvt_pk_bf16_f32 v71, v62, v63
    buffer_store_dwordx4 v[68:71], v4, s[60:63], s20 offen
    v_mov_b32 v44, v40
    v_mov_b32 v45, v41
    v_mov_b32 v46, v42
    v_mov_b32 v47, v43
    v_permlane32_swap_b32 v40, v44
    v_permlane32_swap_b32 v41, v45
    v_permlane32_swap_b32 v42, v46
    v_permlane32_swap_b32 v43, v47
    v_add_f32 v40, v40, v44
    v_fma_f32 v40, v40, v6, v234
    v_add_f32 v41, v41, v45
    v_fma_f32 v41, v41, v6, v235
    v_add_f32 v42, v42, v46
    v_fma_f32 v42, v42, v6, v236
    v_add_f32 v43, v43, v47
    v_fma_f32 v43, v43, v6, v237
    v_cvt_pk_bf16_f32 v72, v40, v41
    v_cvt_pk_bf16_f32 v73, v42, v43
    buffer_store_dwordx2 v[72:73], v5, s[60:63], s21 offen
L_END:
    s_endpgm
L_PS0:
    s_add_u32 s99, s99, 1
    s_cmp_gt_u32 s99, 400000
    s_cbranch_scc1 L_PR0
    s_sleep 1
    buffer_load_dwordx2 v[12:13], v14, s[64:67], 0 offen sc1
    s_waitcnt vmcnt(0)
    s_branch L_PC0
L_PS1:
    s_add_u32 s99, s99, 1
    s_cmp_gt_u32 s99, 400000
    s_cbranch_scc1 L_PR1
    s_sleep 1
    buffer_load_dwordx2 v[8:9], v15, s[48:51], 0 offen sc1
    s_waitcnt vmcnt(0)
    s_branch L_PC1
L_PS2:
    s_add_u32 s99, s99, 1
    s_cmp_gt_u32 s99, 400000
    s_cbranch_scc1 L_PR2
    s_sleep 1
    buffer_load_dwordx2 v[8:9], v15, s[48:51], 0 offen sc1
    s_waitcnt vmcnt(0)
    s_branch L_PC2
L_PS3:
    s_add_u32 s99, s99, 1
    s_cmp_gt_u32 s99, 400000
    s_cbranch_scc1 L_PR3
    s_sleep 1
    buffer_load_dwordx2 v[250:251], v3, s[48:51], 0 offen sc1
    s_waitcnt vmcnt(0)
    s_branch L_PC3
L_PS4:
    s_add_u32 s99, s99, 1
    s_cmp_gt_u32 s99, 400000
    s_cbranch_scc1 L_PR4
    s_sleep 1
    buffer_load_dwordx2 v[8:9], v15, s[48:51], 0 offen sc1
    s_waitcnt vmcnt(0)
    s_branch L_PC4
L_PS5:
    s_add_u32 s99, s99, 1
    s_cmp_gt_u32 s99, 400000
    s_cbranch_scc1 L_PR5
    s_sleep 1
    buffer_load_dwordx2 v[214:215], v216, s[48:51], 0 offen sc1
    s_waitcnt vmcnt(0)
    s_branch L_PC5
L_RXS:
    s_add_u32 s99, s99, 1
    s_cmp_gt_u32 s99, 400000
    s_cbranch_scc1 L_RXR
    s_sleep 1
    buffer_load_dwordx4 v[80:83], v209, s[48:51], s13 offen offset:0 sc1
    buffer_load_dwordx4 v[84:87], v209, s[48:51], s13 offen offset:1024 sc1
    buffer_load_dwordx4 v[88:91], v209, s[48:51], s13 offen offset:2048 sc1
    buffer_load_dwordx4 v[92:95], v209, s[48:51], s15 offen offset:0 sc1
    buffer_load_dwordx4 v[96:99], v209, s[48:51], s15 offen offset:1024 sc1
    buffer_load_dwordx4 v[100:103], v209, s[48:51], s15 offen offset:2048 sc1
    buffer_load_dwordx4 v[104:107], v209, s[48:51], s38 offen offset:0 sc1
    buffer_load_dwordx4 v[108:111], v209, s[48:51], s38 offen offset:1024 sc1
    buffer_load_dwordx4 v[112:115], v209, s[48:51], s38 offen offset:2048 sc1
    buffer_load_dwordx4 v[116:119], v3, s[48:51], s12 offen sc1
    buffer_load_dwordx4 v[120:123], v3, s[48:51], s39 offen sc1
    buffer_load_dwordx4 v[124:127], v2, s[48:51], s12 offen sc1
    buffer_load_dwordx4 v[128:131], v2, s[48:51], s39 offen sc1
    s_waitcnt vmcnt(0)
    s_branch L_RXC
L_CODE_END:
.section .rodata,"a"
.p2align 6
.amdhsa_kernel parallel_sum__sliding_local_dilated__dense_activation_squared_relu__prompt_kernel
  .amdhsa_next_free_vgpr 512
  .amdhsa_next_free_sgpr 102
  .amdhsa_accum_offset 256
  .amdhsa_group_segment_fixed_size 0
  .amdhsa_kernarg_size 88
  .amdhsa_user_sgpr_count 2
  .amdhsa_user_sgpr_kernarg_segment_ptr 1
  .amdhsa_system_sgpr_workgroup_id_x 1
.end_amdhsa_kernel
```
